```python
import torch

def _softmax(x, axis=-1):
    return torch.softmax(x, dim=axis)
def _gelu(x):
    return torch.nn.functional.gelu(x, approximate="tanh")
def _silu(x):
    return torch.nn.functional.silu(x)
def _sigmoid(x):
    return torch.sigmoid(x)
def _layernorm(x, axis=-1, eps=1e-5):
    m = x.mean(dim=axis, keepdim=True)
    v = x.var(dim=axis, keepdim=True, unbiased=False)
    return (x - m) / torch.sqrt(v + eps)
def _scatter_add(tgt, idx, src, axis=0):
    return tgt.clone().index_add_(axis, idx, src)
def _segment_sum(src, seg, n):
    out = torch.zeros((n,) + src.shape[1:], dtype=src.dtype)
    return out.index_add_(0, seg, src)
def _pad(x, pw):
    flat = tuple(v for pair in reversed(pw) for v in pair)
    return torch.nn.functional.pad(x, flat)

kernel_name = 'concat_heads__ssm_conv_s4d__linear_attn_block__prompt'

def setup_inputs():

    _w = (lambda a: (lambda t: t.to(torch.bfloat16) if t.is_floating_point() else t)(torch.as_tensor(a)))
    def _A_setup():
        Bsz, L, D, N = 1, 2048, 576, 128
        return {
            "u": _w((lambda *s: torch.randn(*s, dtype=torch.bfloat16) * 0.05)(Bsz, L, D)),
            "log_A_real": _w((lambda *s: torch.randn(*s, dtype=torch.bfloat16) * 6.4)(D, N) * 0.5),
            "A_imag": _w((lambda *s: torch.randn(*s, dtype=torch.bfloat16) * 0.05)(D, N) * 3.14),
            "C_real": _w((lambda *s: torch.randn(*s, dtype=torch.bfloat16) * 0.1)(D, N) / N ** 0.5),
            "C_imag": _w((lambda *s: torch.randn(*s, dtype=torch.bfloat16) * 0.1)(D, N) / N ** 0.5),
            "log_dt": _w((lambda *s: torch.randn(*s, dtype=torch.bfloat16) * 0.05)(D) * 0.5 - 4.0),
            "D_skip": _w((lambda *s: torch.randn(*s, dtype=torch.bfloat16) * 0.05)(D)),
        }
    _A_in = _A_setup()

    def _B_setup():
        B, S, D = 1, 2048, 576
        return {
            "x": _w((lambda *s: torch.randn(*s, dtype=torch.bfloat16) * 0.05)(B, S, D)),
            "wqkv": _w((lambda *s: torch.randn(*s, dtype=torch.bfloat16) * 0.4)(D, 3 * D)),
            "wo": _w((lambda *s: torch.randn(*s, dtype=torch.bfloat16) * 0.05)(D, D)),
        }
    _B_in = _B_setup()

    return {
        "A_u": _A_in["u"],
        "A_log_A_real": _A_in["log_A_real"],
        "A_A_imag": _A_in["A_imag"],
        "A_C_real": _A_in["C_real"],
        "A_C_imag": _A_in["C_imag"],
        "A_log_dt": _A_in["log_dt"],
        "A_D_skip": _A_in["D_skip"],
        "B_x": _B_in["x"],
        "B_wqkv": _B_in["wqkv"],
        "B_wo": _B_in["wo"],
    }

def reference(A_u, A_log_A_real, A_A_imag, A_C_real, A_C_imag, A_log_dt, A_D_skip, B_x, B_wqkv, B_wo):
    def _A_ref(u, log_A_real, A_imag, C_real, C_imag, log_dt, D_skip):
        L = u.shape[1]
        dt = torch.exp(log_dt)
        A = -torch.exp(log_A_real) + 1j * A_imag
        C = (C_real + 1j * C_imag) * dt[:, None]
        pos = (lambda x, dt: x.to(dt))(torch.arange(L), log_dt.dtype)
        P = torch.exp((A * dt[:, None])[:, :, None] * pos[None, None, :])
        K = 2.0 * torch.einsum("dn,dnl->dl", C, P).real
        L2 = 2 * L
        u_t = (lambda x, *d: x.permute(*d))(u, 0, 2, 1)
        Kf = (lambda x, *a, **k: torch.fft.rfft(x.float(), *a, **k))(K, L2)
        Uf = (lambda x, *a, **k: torch.fft.rfft(x.float(), *a, **k))(u_t, L2)
        y = (lambda x, *a, **k: torch.fft.irfft(x, *a, **k).to(torch.bfloat16))(Uf * Kf[None, :, :], L2)[:, :, :L]
        y = (lambda x, *d: x.permute(*d))(y, 0, 2, 1)
        return y + u * D_skip[None, None, :]

    def _B_ref(x, wqkv, wo):
        B, S, D = x.shape
        H = 32; Dh = D // H
        qkv = (lambda x, *d: x.permute(*d))((x @ wqkv).reshape(B, S, 3, H, Dh), 2, 0, 3, 1, 4)
        q, k, v = qkv[0], qkv[1], qkv[2]
        phi = lambda t: torch.where(t > 0, t + 1, torch.exp(t)) + 1e-6
        pq, pk = phi(q), phi(k)
        kv = torch.einsum("bhsd,bhse->bhde", pk, v)
        z = torch.einsum("bhsd->bhd", pk)
        num = torch.einsum("bhqd,bhde->bhqe", pq, kv)
        den = torch.einsum("bhqd,bhd->bhq", pq, z)[..., None] + 1e-6
        o = num / den
        return (lambda x, *d: x.permute(*d))(o, 0, 2, 1, 3).reshape(B, S, D) @ wo

    a = _A_ref(A_u, A_log_A_real, A_A_imag, A_C_real, A_C_imag, A_log_dt, A_D_skip)
    b = _B_ref(B_x, B_wqkv, B_wo)
    return torch.concatenate([a, b], axis=-1)
```

```asm
; @launch grid=(256,1,1) block=(512,1,1) lds=163840
.amdgcn_target "amdgcn-amd-amdhsa--gfx950"
.text
.globl concat_heads__ssm_conv_s4d__linear_attn_block__prompt_kernel
.p2align 8
.type concat_heads__ssm_conv_s4d__linear_attn_block__prompt_kernel,@function
concat_heads__ssm_conv_s4d__linear_attn_block__prompt_kernel:
    s_load_dwordx16 s[4:19], s[0:1], 0
    s_load_dwordx8 s[20:27], s[0:1], 64
    s_load_dwordx2 s[28:29], s[0:1], 96
    s_cmp_ge_u32 s2, 256
    s_cbranch_scc1 L_end
    v_and_b32 v1, 63, v0
    v_lshrrev_b32 v2, 6, v0
    s_and_b32 s42, s2, 7
    s_lshr_b32 s43, s2, 3
    v_readfirstlane_b32 s31, v2
    s_and_b32 s34, s43, 7
    s_cmp_lg_u32 s34, s31
    s_cbranch_scc1 L_nocpf
    s_getpc_b64 s[36:37]
L_pc:
    s_lshl_b32 s34, s34, 13
    v_lshl_add_u32 v4, v1, 7, s34
    v_min_u32 v4, L_code_end-L_pc-4, v4
    v_mov_b32 v5, s37
    v_add_co_u32 v4, vcc, s36, v4
    s_nop 1
    v_addc_co_u32 v5, vcc, 0, v5, vcc
    global_load_dword v255, v[4:5], off
L_nocpf:
    v_and_b32 v2, 15, v1
    v_lshrrev_b32 v3, 4, v1
    s_cmp_ge_u32 s43, 16
    s_cbranch_scc1 L_notkv
    s_and_b32 s34, s42, 3
    s_lshr_b32 s35, s43, 2
    s_and_b32 s36, s43, 3
    s_lshl_b32 s33, s34, 2
    s_add_u32 s33, s33, s35
    s_and_b32 s32, s42, 4
    s_add_u32 s32, s32, s36
    s_add_u32 s94, s35, s36
    s_and_b32 s94, s94, 3
    s_lshl_b32 s94, s94, 1
    s_cmp_lt_u32 s31, 4
    s_cbranch_scc1 L_kv_comp
    s_sub_u32 s35, s31, 4
    s_and_b32 s37, s35, 1
    s_mul_i32 s34, s33, 128
    s_mul_i32 s36, s35, 32
    s_add_u32 s36, s36, s34
    v_lshrrev_b32 v4, 3, v1
    v_add_u32 v4, s36, v4
    v_mul_u32_u24 v4, 1152, v4
    v_and_b32 v5, 7, v1
    v_xor_b32 v5, v5, v3
    v_lshl_add_u32 v10, v5, 4, v4
    v_xor_b32 v5, 4, v5
    v_lshl_add_u32 v11, v5, 4, v4
    s_mul_i32 s38, s35, 4096
    s_lshr_b32 s36, s35, 1
    s_lshl_b32 s36, s36, 3
    s_add_u32 s36, s36, s37
    s_mul_i32 s36, s36, 13824
    s_mul_i32 s39, s32, 144
    s_add_u32 s36, s36, s39
    s_add_u32 s36, s36, 1152
    s_mul_i32 s39, s35, 4608
    s_mov_b32 s50, 1990656
    s_mov_b32 s51, 0x20000
    s_mov_b32 s46, 2359296
    s_mov_b32 s47, 0x20000
    s_movk_i32 s34, 1152
    v_mul_u32_u24 v5, 7282, v1
    v_lshrrev_b32 v5, 16, v5
    v_lshl_add_u32 v6, v1, 4, s36
    v_mul_u32_u24 v7, 1008, v5
    v_lshrrev_b32 v5, 1, v5
    v_mad_u32_u24 v7, v5, s34, v7
    v_lshrrev_b32 v5, 2, v5
    v_mul_u32_u24 v5, 13824, v5
    v_add3_u32 v13, v5, v6, v7
    v_add_u32 v4, 64, v1
    v_mul_u32_u24 v5, 7282, v4
    v_lshrrev_b32 v5, 16, v5
    v_lshl_add_u32 v6, v4, 4, s36
    v_mul_u32_u24 v7, 1008, v5
    v_lshrrev_b32 v5, 1, v5
    v_mad_u32_u24 v7, v5, s34, v7
    v_lshrrev_b32 v5, 2, v5
    v_mul_u32_u24 v5, 13824, v5
    v_add3_u32 v14, v5, v6, v7
    s_waitcnt lgkmcnt(0)
    s_mov_b64 s[48:49], s[20:21]
    s_mov_b64 s[44:45], s[18:19]
    s_lshl_b32 s30, s94, 7
    s_add_u32 m0, s38, 0
    s_add_u32 s3, s30, 0
    buffer_load_dwordx4 v10, s[44:47], s3 offen lds
    s_add_u32 m0, s38, 1024
    s_add_u32 s3, s30, 9216
    buffer_load_dwordx4 v11, s[44:47], s3 offen lds
    s_add_u32 m0, s38, 2048
    s_add_u32 s3, s30, 18432
    buffer_load_dwordx4 v10, s[44:47], s3 offen lds
    s_add_u32 m0, s38, 3072
    s_add_u32 s3, s30, 27648
    buffer_load_dwordx4 v11, s[44:47], s3 offen lds
    s_mul_i32 s30, s94, 221184
    s_add_u32 s94, s94, 1
    s_and_b32 s94, s94, 7
    s_add_u32 m0, s39, 16384
    s_nop 0
    buffer_load_dwordx4 v13, s[48:51], s30 offen lds
    s_add_u32 m0, s39, 17408
    s_nop 0
    buffer_load_dwordx4 v14, s[48:51], s30 offen lds
    v_add_u32 v4, 128, v1
    v_mul_u32_u24 v5, 7282, v4
    v_lshrrev_b32 v5, 16, v5
    v_lshl_add_u32 v6, v4, 4, s36
    v_mul_u32_u24 v7, 1008, v5
    v_lshrrev_b32 v5, 1, v5
    v_mad_u32_u24 v7, v5, s34, v7
    v_lshrrev_b32 v5, 2, v5
    v_mul_u32_u24 v5, 13824, v5
    v_add3_u32 v15, v5, v6, v7
    s_add_u32 m0, s39, 18432
    s_nop 0
    buffer_load_dwordx4 v15, s[48:51], s30 offen lds
    v_add_u32 v4, 192, v1
    v_mul_u32_u24 v5, 7282, v4
    v_lshrrev_b32 v5, 16, v5
    v_lshl_add_u32 v6, v4, 4, s36
    v_mul_u32_u24 v7, 1008, v5
    v_lshrrev_b32 v5, 1, v5
    v_mad_u32_u24 v7, v5, s34, v7
    v_lshrrev_b32 v5, 2, v5
    v_mul_u32_u24 v5, 13824, v5
    v_add3_u32 v16, v5, v6, v7
    s_add_u32 m0, s39, 19456
    s_nop 0
    buffer_load_dwordx4 v16, s[48:51], s30 offen lds
    v_add_u32 v4, 256, v1
    v_mul_u32_u24 v5, 7282, v4
    v_lshrrev_b32 v5, 16, v5
    v_lshl_add_u32 v6, v4, 4, s36
    v_mul_u32_u24 v7, 1008, v5
    v_lshrrev_b32 v5, 1, v5
    v_mad_u32_u24 v7, v5, s34, v7
    v_lshrrev_b32 v5, 2, v5
    v_mul_u32_u24 v5, 13824, v5
    v_add3_u32 v17, v5, v6, v7
    s_mov_b32 exec_hi, 0
    s_add_u32 m0, s39, 20480
    s_nop 0
    buffer_load_dwordx4 v17, s[48:51], s30 offen lds
    s_mov_b32 exec_hi, -1
    s_lshl_b32 s30, s94, 7
    s_add_u32 m0, s38, 34816
    s_add_u32 s3, s30, 0
    buffer_load_dwordx4 v10, s[44:47], s3 offen lds
    s_add_u32 m0, s38, 35840
    s_add_u32 s3, s30, 9216
    buffer_load_dwordx4 v11, s[44:47], s3 offen lds
    s_add_u32 m0, s38, 36864
    s_add_u32 s3, s30, 18432
    buffer_load_dwordx4 v10, s[44:47], s3 offen lds
    s_add_u32 m0, s38, 37888
    s_add_u32 s3, s30, 27648
    buffer_load_dwordx4 v11, s[44:47], s3 offen lds
    s_mul_i32 s30, s94, 221184
    s_add_u32 s94, s94, 1
    s_and_b32 s94, s94, 7
    s_add_u32 m0, s39, 51200
    s_nop 0
    buffer_load_dwordx4 v13, s[48:51], s30 offen lds
    s_add_u32 m0, s39, 52224
    s_nop 0
    buffer_load_dwordx4 v14, s[48:51], s30 offen lds
    s_add_u32 m0, s39, 53248
    s_nop 0
    buffer_load_dwordx4 v15, s[48:51], s30 offen lds
    s_add_u32 m0, s39, 54272
    s_nop 0
    buffer_load_dwordx4 v16, s[48:51], s30 offen lds
    s_mov_b32 exec_hi, 0
    s_add_u32 m0, s39, 55296
    s_nop 0
    buffer_load_dwordx4 v17, s[48:51], s30 offen lds
    s_mov_b32 exec_hi, -1
    s_mov_b32 s56, s28
    s_mov_b32 s57, s29
    s_mov_b32 s58, 4194304
    s_mov_b32 s59, 0x20000
    s_mov_b32 s60, s26
    s_mov_b32 s61, s27
    s_mov_b32 s62, 256
    s_mov_b32 s63, 0x20000
    s_mov_b32 s52, s22
    s_mov_b32 s53, s23
    s_mov_b32 s54, 663552
    s_mov_b32 s55, 0x20000
    s_lshr_b32 s96, s43, 2
    s_and_b32 s97, s43, 3
    s_cmp_ge_u32 s43, 16
    s_cselect_b32 s96, s97, s96
    s_cselect_b32 s97, 4, s97
    s_and_b32 s30, s31, 1
    s_lshl_b32 s3, s30, 3
    v_lshl_add_u32 v23, v3, 1, s3
    v_xor_b32 v23, v23, v2
    s_lshl_b32 s3, s97, 8
    v_lshl_add_u32 v23, v23, 4, s3
    v_mov_b32 v21, 0x40000000
    v_cmp_gt_u32 vcc, 1152, v23
    s_nop 1
    v_cndmask_b32 v23, v21, v23, vcc
    s_and_b32 s3, s31, 3
    s_lshl_b32 s95, s3, 10
    v_lshl_add_u32 v21, v3, 2, s3
    v_mul_u32_u24 v21, 1152, v21
    v_add_u32 v21, v21, v23
    s_mul_i32 s3, s3, 18
    s_lshl_b32 s30, s30, 4
    s_sub_u32 s3, s3, s30
    s_add_u32 s3, s3, 16
    v_lshrrev_b32 v22, 1, v3
    v_mul_u32_u24 v22, 70, v22
    v_add3_u32 v22, v22, v3, s3
    v_mul_u32_u24 v22, 1152, v22
    v_add_u32 v22, v22, v23
    v_lshrrev_b32 v106, 2, v2
    v_lshl_add_u32 v106, v3, 2, v106
    v_and_b32 v107, 7, v106
    v_lshlrev_b32 v107, 1, v107
    v_bfe_u32 v108, v2, 1, 1
    s_lshr_b32 s3, s31, 1
    s_xor_b32 s3, s3, 2
    s_lshl_b32 s3, s3, 2
    v_add_u32 v108, s3, v108
    v_xor_b32 v107, v107, v108
    v_lshlrev_b32 v106, 8, v106
    v_lshl_add_u32 v106, v107, 4, v106
    v_and_b32 v107, 1, v2
    v_lshl_add_u32 v106, v107, 3, v106
    v_xor_b32 v107, 32, v106
    v_add_u32 v108, 0x10000, v106
    v_add_u32 v109, 0x10000, v107
    v_mov_b32 v4, 0
    s_waitcnt vmcnt(9)
    s_barrier
    s_lshl_b32 s30, s94, 7
    s_add_u32 m0, s38, 69632
    s_add_u32 s3, s30, 0
    buffer_load_dwordx4 v10, s[44:47], s3 offen lds
    s_add_u32 m0, s38, 70656
    s_add_u32 s3, s30, 9216
    buffer_load_dwordx4 v11, s[44:47], s3 offen lds
    s_add_u32 m0, s38, 71680
    s_add_u32 s3, s30, 18432
    buffer_load_dwordx4 v10, s[44:47], s3 offen lds
    s_add_u32 m0, s38, 72704
    s_add_u32 s3, s30, 27648
    buffer_load_dwordx4 v11, s[44:47], s3 offen lds
    s_mul_i32 s30, s94, 221184
    s_add_u32 s94, s94, 1
    s_and_b32 s94, s94, 7
    s_add_u32 m0, s39, 86016
    s_nop 0
    buffer_load_dwordx4 v13, s[48:51], s30 offen lds
    s_add_u32 m0, s39, 87040
    s_nop 0
    buffer_load_dwordx4 v14, s[48:51], s30 offen lds
    s_add_u32 m0, s39, 88064
    s_nop 0
    buffer_load_dwordx4 v15, s[48:51], s30 offen lds
    s_add_u32 m0, s39, 89088
    s_nop 0
    buffer_load_dwordx4 v16, s[48:51], s30 offen lds
    s_mov_b32 exec_hi, 0
    s_add_u32 m0, s39, 90112
    s_nop 0
    buffer_load_dwordx4 v17, s[48:51], s30 offen lds
    s_mov_b32 exec_hi, -1
    s_waitcnt vmcnt(9)
    s_barrier
    s_lshl_b32 s30, s94, 7
    s_add_u32 m0, s38, 104448
    s_add_u32 s3, s30, 0
    buffer_load_dwordx4 v10, s[44:47], s3 offen lds
    s_add_u32 m0, s38, 105472
    s_add_u32 s3, s30, 9216
    buffer_load_dwordx4 v11, s[44:47], s3 offen lds
    s_add_u32 m0, s38, 106496
    s_add_u32 s3, s30, 18432
    buffer_load_dwordx4 v10, s[44:47], s3 offen lds
    s_add_u32 m0, s38, 107520
    s_add_u32 s3, s30, 27648
    buffer_load_dwordx4 v11, s[44:47], s3 offen lds
    s_mul_i32 s30, s94, 221184
    s_add_u32 s94, s94, 1
    s_and_b32 s94, s94, 7
    s_add_u32 m0, s39, 120832
    s_nop 0
    buffer_load_dwordx4 v13, s[48:51], s30 offen lds
    s_add_u32 m0, s39, 121856
    s_nop 0
    buffer_load_dwordx4 v14, s[48:51], s30 offen lds
    s_add_u32 m0, s39, 122880
    s_nop 0
    buffer_load_dwordx4 v15, s[48:51], s30 offen lds
    s_add_u32 m0, s39, 123904
    s_nop 0
    buffer_load_dwordx4 v16, s[48:51], s30 offen lds
    s_mov_b32 exec_hi, 0
    s_add_u32 m0, s39, 124928
    s_nop 0
    buffer_load_dwordx4 v17, s[48:51], s30 offen lds
    s_mov_b32 exec_hi, -1
    s_waitcnt vmcnt(9)
    s_barrier
    s_lshl_b32 s30, s94, 7
    s_add_u32 m0, s38, 0
    s_add_u32 s3, s30, 0
    buffer_load_dwordx4 v10, s[44:47], s3 offen lds
    s_add_u32 m0, s38, 1024
    s_add_u32 s3, s30, 9216
    buffer_load_dwordx4 v11, s[44:47], s3 offen lds
    s_add_u32 m0, s38, 2048
    s_add_u32 s3, s30, 18432
    buffer_load_dwordx4 v10, s[44:47], s3 offen lds
    s_add_u32 m0, s38, 3072
    s_add_u32 s3, s30, 27648
    buffer_load_dwordx4 v11, s[44:47], s3 offen lds
    s_mul_i32 s30, s94, 221184
    s_add_u32 s94, s94, 1
    s_and_b32 s94, s94, 7
    s_add_u32 m0, s39, 16384
    s_nop 0
    buffer_load_dwordx4 v13, s[48:51], s30 offen lds
    s_add_u32 m0, s39, 17408
    s_nop 0
    buffer_load_dwordx4 v14, s[48:51], s30 offen lds
    s_add_u32 m0, s39, 18432
    s_nop 0
    buffer_load_dwordx4 v15, s[48:51], s30 offen lds
    s_add_u32 m0, s39, 19456
    s_nop 0
    buffer_load_dwordx4 v16, s[48:51], s30 offen lds
    s_mov_b32 exec_hi, 0
    s_add_u32 m0, s39, 20480
    s_nop 0
    buffer_load_dwordx4 v17, s[48:51], s30 offen lds
    s_mov_b32 exec_hi, -1
    s_waitcnt vmcnt(9)
    s_barrier
    s_lshl_b32 s30, s94, 7
    s_add_u32 m0, s38, 34816
    s_add_u32 s3, s30, 0
    buffer_load_dwordx4 v10, s[44:47], s3 offen lds
    s_add_u32 m0, s38, 35840
    s_add_u32 s3, s30, 9216
    buffer_load_dwordx4 v11, s[44:47], s3 offen lds
    s_add_u32 m0, s38, 36864
    s_add_u32 s3, s30, 18432
    buffer_load_dwordx4 v10, s[44:47], s3 offen lds
    s_add_u32 m0, s38, 37888
    s_add_u32 s3, s30, 27648
    buffer_load_dwordx4 v11, s[44:47], s3 offen lds
    s_mul_i32 s30, s94, 221184
    s_add_u32 s94, s94, 1
    s_and_b32 s94, s94, 7
    s_add_u32 m0, s39, 51200
    s_nop 0
    buffer_load_dwordx4 v13, s[48:51], s30 offen lds
    s_add_u32 m0, s39, 52224
    s_nop 0
    buffer_load_dwordx4 v14, s[48:51], s30 offen lds
    s_add_u32 m0, s39, 53248
    s_nop 0
    buffer_load_dwordx4 v15, s[48:51], s30 offen lds
    s_add_u32 m0, s39, 54272
    s_nop 0
    buffer_load_dwordx4 v16, s[48:51], s30 offen lds
    s_mov_b32 exec_hi, 0
    s_add_u32 m0, s39, 55296
    s_nop 0
    buffer_load_dwordx4 v17, s[48:51], s30 offen lds
    s_mov_b32 exec_hi, -1
    s_waitcnt vmcnt(9)
    s_barrier
    s_lshl_b32 s30, s94, 7
    s_add_u32 m0, s38, 69632
    s_add_u32 s3, s30, 0
    buffer_load_dwordx4 v10, s[44:47], s3 offen lds
    s_add_u32 m0, s38, 70656
    s_add_u32 s3, s30, 9216
    buffer_load_dwordx4 v11, s[44:47], s3 offen lds
    s_add_u32 m0, s38, 71680
    s_add_u32 s3, s30, 18432
    buffer_load_dwordx4 v10, s[44:47], s3 offen lds
    s_add_u32 m0, s38, 72704
    s_add_u32 s3, s30, 27648
    buffer_load_dwordx4 v11, s[44:47], s3 offen lds
    s_mul_i32 s30, s94, 221184
    s_add_u32 s94, s94, 1
    s_and_b32 s94, s94, 7
    s_add_u32 m0, s39, 86016
    s_nop 0
    buffer_load_dwordx4 v13, s[48:51], s30 offen lds
    s_add_u32 m0, s39, 87040
    s_nop 0
    buffer_load_dwordx4 v14, s[48:51], s30 offen lds
    s_add_u32 m0, s39, 88064
    s_nop 0
    buffer_load_dwordx4 v15, s[48:51], s30 offen lds
    s_add_u32 m0, s39, 89088
    s_nop 0
    buffer_load_dwordx4 v16, s[48:51], s30 offen lds
    s_mov_b32 exec_hi, 0
    s_add_u32 m0, s39, 90112
    s_nop 0
    buffer_load_dwordx4 v17, s[48:51], s30 offen lds
    s_mov_b32 exec_hi, -1
    s_waitcnt vmcnt(9)
    s_barrier
    buffer_load_dword v24, v4, s[60:63], 0 offen sc1
    s_lshl_b32 s30, s94, 7
    s_add_u32 m0, s38, 104448
    s_add_u32 s3, s30, 0
    buffer_load_dwordx4 v10, s[44:47], s3 offen lds
    s_add_u32 m0, s38, 105472
    s_add_u32 s3, s30, 9216
    buffer_load_dwordx4 v11, s[44:47], s3 offen lds
    s_add_u32 m0, s38, 106496
    s_add_u32 s3, s30, 18432
    buffer_load_dwordx4 v10, s[44:47], s3 offen lds
    s_add_u32 m0, s38, 107520
    s_add_u32 s3, s30, 27648
    buffer_load_dwordx4 v11, s[44:47], s3 offen lds
    s_mul_i32 s30, s94, 221184
    s_mov_b32 s94, 8
    s_add_u32 m0, s39, 120832
    s_nop 0
    buffer_load_dwordx4 v13, s[48:51], s30 offen lds
    s_add_u32 m0, s39, 121856
    s_nop 0
    buffer_load_dwordx4 v14, s[48:51], s30 offen lds
    s_add_u32 m0, s39, 122880
    s_nop 0
    buffer_load_dwordx4 v15, s[48:51], s30 offen lds
    s_add_u32 m0, s39, 123904
    s_nop 0
    buffer_load_dwordx4 v16, s[48:51], s30 offen lds
    s_mov_b32 exec_hi, 0
    s_add_u32 m0, s39, 124928
    s_nop 0
    buffer_load_dwordx4 v17, s[48:51], s30 offen lds
    s_mov_b32 exec_hi, -1
    s_waitcnt vmcnt(10)
    s_barrier
    s_lshl_b32 s30, s94, 7
    s_add_u32 m0, s38, 0
    s_add_u32 s3, s30, 0
    buffer_load_dwordx4 v10, s[44:47], s3 offen lds
    s_add_u32 m0, s38, 1024
    s_add_u32 s3, s30, 9216
    buffer_load_dwordx4 v11, s[44:47], s3 offen lds
    s_add_u32 m0, s38, 2048
    s_add_u32 s3, s30, 18432
    buffer_load_dwordx4 v10, s[44:47], s3 offen lds
    s_add_u32 m0, s38, 3072
    s_add_u32 s3, s30, 27648
    buffer_load_dwordx4 v11, s[44:47], s3 offen lds
    s_mul_i32 s30, s94, 221184
    s_add_u32 s94, s94, 1
    s_and_b32 s94, s94, 7
    s_add_u32 m0, s39, 16384
    s_nop 0
    buffer_load_dwordx4 v13, s[48:51], s30 offen lds
    s_add_u32 m0, s39, 17408
    s_nop 0
    buffer_load_dwordx4 v14, s[48:51], s30 offen lds
    s_add_u32 m0, s39, 18432
    s_nop 0
    buffer_load_dwordx4 v15, s[48:51], s30 offen lds
    s_add_u32 m0, s39, 19456
    s_nop 0
    buffer_load_dwordx4 v16, s[48:51], s30 offen lds
    s_mov_b32 exec_hi, 0
    s_add_u32 m0, s39, 20480
    s_nop 0
    buffer_load_dwordx4 v17, s[48:51], s30 offen lds
    s_mov_b32 exec_hi, -1
    s_waitcnt vmcnt(9)
    s_barrier
    s_add_u32 m0, s95, 40960
    s_mov_b32 s3, 207360
    buffer_load_dwordx4 v21, s[52:55], s3 offen lds
    s_add_u32 m0, s95, 45056
    s_mov_b32 s3, 230400
    buffer_load_dwordx4 v21, s[52:55], s3 offen lds
    s_add_u32 m0, s95, 49152
    s_mov_b32 s3, 248832
    buffer_load_dwordx4 v21, s[52:55], s3 offen lds
    s_add_u32 m0, s95, 53248
    s_mov_b32 s3, 271872
    buffer_load_dwordx4 v21, s[52:55], s3 offen lds
    s_add_u32 m0, s95, 57344
    s_mov_b32 s3, 290304
    buffer_load_dwordx4 v21, s[52:55], s3 offen lds
    s_add_u32 m0, s95, 61440
    s_mov_b32 s3, 313344
    buffer_load_dwordx4 v21, s[52:55], s3 offen lds
    s_add_u32 m0, s95, 65536
    s_mov_b32 s3, 331776
    buffer_load_dwordx4 v21, s[52:55], s3 offen lds
    s_add_u32 m0, s95, 69632
    s_mov_b32 s3, 354816
    buffer_load_dwordx4 v21, s[52:55], s3 offen lds
    s_waitcnt vmcnt(8)
    s_barrier
    s_add_u32 m0, s95, 73728
    s_mov_b32 s3, 373248
    buffer_load_dwordx4 v21, s[52:55], s3 offen lds
    s_add_u32 m0, s95, 77824
    s_mov_b32 s3, 396288
    buffer_load_dwordx4 v21, s[52:55], s3 offen lds
    s_add_u32 m0, s95, 81920
    s_mov_b32 s3, 414720
    buffer_load_dwordx4 v21, s[52:55], s3 offen lds
    s_add_u32 m0, s95, 86016
    s_mov_b32 s3, 437760
    buffer_load_dwordx4 v21, s[52:55], s3 offen lds
    v_readfirstlane_b32 s37, v24
    s_mov_b32 s36, 0
    s_cmp_lg_u32 s37, 0
    s_cbranch_scc1 L_kv_rdy2
L_kv_rdy:
    buffer_load_dword v5, v4, s[60:63], 0 offen sc1
    s_add_u32 s36, s36, 1
    s_waitcnt vmcnt(0)
    v_readfirstlane_b32 s37, v5
    s_cmp_ge_u32 s36, 0x10000
    s_cbranch_scc1 L_kv_rdy2
    s_cmp_eq_u32 s37, 0
    s_cbranch_scc1 L_kv_rdy
L_kv_rdy2:
    s_barrier
    s_add_u32 m0, s95, 90112
    s_mov_b32 s3, 456192
    buffer_load_dwordx4 v21, s[52:55], s3 offen lds
    s_add_u32 m0, s95, 94208
    s_mov_b32 s3, 479232
    buffer_load_dwordx4 v21, s[52:55], s3 offen lds
    s_add_u32 m0, s95, 98304
    s_mov_b32 s3, 497664
    buffer_load_dwordx4 v21, s[52:55], s3 offen lds
    s_add_u32 m0, s95, 102400
    s_mov_b32 s3, 520704
    buffer_load_dwordx4 v21, s[52:55], s3 offen lds
    s_add_u32 m0, s95, 106496
    s_mov_b32 s3, 539136
    buffer_load_dwordx4 v21, s[52:55], s3 offen lds
    s_add_u32 m0, s95, 110592
    s_mov_b32 s3, 562176
    buffer_load_dwordx4 v21, s[52:55], s3 offen lds
    s_add_u32 m0, s95, 0
    s_mov_b32 s3, 0
    buffer_load_dwordx4 v21, s[52:55], s3 offen lds
    s_add_u32 m0, s95, 4096
    s_mov_b32 s3, 23040
    buffer_load_dwordx4 v21, s[52:55], s3 offen lds
    s_add_u32 m0, s95, 8192
    s_mov_b32 s3, 41472
    buffer_load_dwordx4 v21, s[52:55], s3 offen lds
    s_add_u32 m0, s95, 12288
    s_mov_b32 s3, 64512
    buffer_load_dwordx4 v21, s[52:55], s3 offen lds
    s_add_u32 m0, s95, 16384
    s_mov_b32 s3, 82944
    buffer_load_dwordx4 v21, s[52:55], s3 offen lds
    s_add_u32 m0, s95, 20480
    s_mov_b32 s3, 105984
    buffer_load_dwordx4 v21, s[52:55], s3 offen lds
    s_add_u32 m0, s95, 24576
    s_mov_b32 s3, 124416
    buffer_load_dwordx4 v21, s[52:55], s3 offen lds
    s_add_u32 m0, s95, 28672
    s_mov_b32 s3, 147456
    buffer_load_dwordx4 v21, s[52:55], s3 offen lds
    s_add_u32 m0, s95, 32768
    s_mov_b32 s3, 165888
    buffer_load_dwordx4 v21, s[52:55], s3 offen lds
    s_add_u32 m0, s95, 36864
    s_mov_b32 s3, 188928
    buffer_load_dwordx4 v21, s[52:55], s3 offen lds
    s_mov_b32 s33, s97
    s_lshl_b32 s34, s42, 2
    s_add_u32 s32, s96, s34
    s_and_b32 s36, s31, 1
    s_lshr_b32 s35, s31, 1
    s_xor_b32 s35, s35, 2
    v_mov_b32 v8, 0x7ffffff0
    v_lshlrev_b32 v9, 4, v1
    s_add_u32 s40, s31, s43
    s_and_b32 s40, s40, 7
    s_and_b32 s41, s33, 3
    s_mul_i32 s37, s40, 5632
    v_and_b32 v6, 3, v2
    v_bfe_u32 v7, v2, 2, 1
    v_lshl_add_u32 v7, v7, 1, v6
    v_cmp_gt_u32 vcc, 2, v6
    s_nop 1
    v_cndmask_b32 v7, v7, v6, vcc
    v_lshlrev_b32 v12, 4, v3
    v_lshl_add_u32 v12, v7, 6, v12
    v_cmp_gt_u32 s[44:45], 8, v2
    s_nop 0
    s_or_b64 s[96:97], s[44:45], vcc
    s_orn2_b64 vcc, vcc, s[44:45]
    v_cndmask_b32 v13, v8, v12, vcc
    v_cndmask_b32 v12, v8, v12, s[96:97]
    v_lshlrev_b32 v10, 4, v2
    v_lshlrev_b32 v11, 4, v7
    v_add_u32 v11, 640, v11
    v_cmp_lt_u32 s[100:101], 1, v3
    s_nop 1
    v_cndmask_b32 v10, v10, v11, s[100:101]
    v_and_b32 v6, 1, v3
    v_mul_u32_u24 v11, 2816, v6
    v_add_u32 v10, v10, v11
    v_cmp_eq_u32 s[98:99], 1, v6
    v_cmp_eq_u32 s[44:45], 1, v7
    v_cmp_lt_u32 s[46:47], 3, v7
    s_nop 0
    s_or_b64 s[44:45], s[44:45], s[46:47]
    s_andn2_b64 s[46:47], s[100:101], s[98:99]
    s_and_b64 s[46:47], s[46:47], s[96:97]
    s_and_b64 s[96:97], s[100:101], s[98:99]
    s_and_b64 s[96:97], s[96:97], vcc
    v_lshlrev_b32 v7, 3, v2
    v_lshl_add_u32 v7, v6, 7, v7
    s_lshl_b32 s38, s32, 6
    s_lshl_b32 s39, s40, 1
    s_add_u32 s38, s38, s39
    s_lshl_b32 s39, s38, 7
    s_add_u32 s39, s39, 3145728
    s_lshl_b32 s38, s38, 10
    s_add_u32 s38, s38, 1048576
    s_barrier
    s_add_u32 m0, s95, 114688
    s_mov_b32 s3, 580608
    buffer_load_dwordx4 v21, s[52:55], s3 offen lds
    s_add_u32 m0, s95, 118784
    s_mov_b32 s3, 603648
    buffer_load_dwordx4 v21, s[52:55], s3 offen lds
    s_add_u32 m0, s95, 122880
    s_mov_b32 s3, 622080
    buffer_load_dwordx4 v21, s[52:55], s3 offen lds
    s_add_u32 m0, s95, 126976
    s_mov_b32 s3, 645120
    buffer_load_dwordx4 v21, s[52:55], s3 offen lds
    s_add_u32 m0, s95, 131072
    s_mov_b32 s3, 0
    buffer_load_dwordx4 v22, s[52:55], s3 offen lds
    s_add_u32 m0, s95, 135168
    s_mov_b32 s3, 165888
    buffer_load_dwordx4 v22, s[52:55], s3 offen lds
    s_add_u32 m0, s95, 139264
    s_mov_b32 s3, 331776
    buffer_load_dwordx4 v22, s[52:55], s3 offen lds
    s_add_u32 m0, s95, 143360
    s_mov_b32 s3, 497664
    buffer_load_dwordx4 v22, s[52:55], s3 offen lds
    v_mov_b32 v4, 163780
    v_mov_b32 v5, 1
    s_waitcnt vmcnt(0)
    s_mov_b64 exec, 1
    ds_add_u32 v4, v5
    s_mov_b64 exec, -1
    s_branch L_bjoin
L_kv_comp:
    s_lshr_b32 s96, s43, 2
    s_and_b32 s97, s43, 3
    s_cmp_ge_u32 s43, 16
    s_cselect_b32 s96, s97, s96
    s_cselect_b32 s97, 4, s97
    s_and_b32 s35, s31, 1
    s_lshr_b32 s36, s31, 1
    v_lshrrev_b32 v9, 1, v2
    v_xor_b32 v9, v9, v3
    v_lshlrev_b32 v10, 7, v2
    v_lshl_add_u32 v10, v9, 4, v10
    s_mul_i32 s37, s35, 8192
    v_add_u32 v4, s37, v10
    v_xor_b32 v5, 64, v4
    v_lshrrev_b32 v9, 2, v2
    v_and_b32 v10, 3, v2
    v_lshl_add_u32 v11, v3, 2, v9
    v_mul_u32_u24 v11, 288, v11
    s_mul_i32 s37, s36, 72
    s_add_u32 s37, s37, 16384
    v_add_u32 v11, s37, v11
    v_lshl_add_u32 v6, v10, 3, v11
    v_and_b32 v12, 1, v10
    v_mul_u32_u24 v12, 144, v12
    v_add3_u32 v7, v11, v12, 32
    v_mov_b32 v12, 163776
    v_mov_b32 v14, 0
    v_mov_b32 v15, 0
    ds_write_b64 v12, v[14:15]
    v_mov_b32 v8, 0x3f800008
    v_mov_b32 v9, v8
    v_lshrrev_b32 v10, 2, v2
    v_cmp_eq_u32 s[98:99], 1, v10
    v_cmp_eq_u32 s[100:101], 3, v10
    s_nop 0
    v_cndmask_b32 v10, v8, 0, s[98:99]
    v_mov_b32 v11, v10
    v_mov_b64 v[16:17], v[8:9]
    v_mov_b64 v[18:19], v[8:9]
    v_mov_b64 v[20:21], v[8:9]
    v_mov_b64 v[22:23], v[8:9]
    v_mov_b64 v[24:25], v[14:15]
    v_mov_b64 v[26:27], v[14:15]
    v_mov_b64 v[28:29], v[14:15]
    v_mov_b64 v[30:31], v[14:15]
    v_mov_b64 v[32:33], v[10:11]
    v_mov_b64 v[34:35], v[10:11]
    v_mov_b64 v[36:37], v[8:9]
    v_mov_b64 v[38:39], v[8:9]
    v_mov_b64 v[40:41], v[8:9]
    v_mov_b64 v[42:43], v[8:9]
    v_mov_b64 v[44:45], v[14:15]
    v_mov_b64 v[46:47], v[14:15]
    v_mov_b64 v[48:49], v[14:15]
    v_mov_b64 v[50:51], v[14:15]
    v_mov_b64 v[52:53], v[10:11]
    v_mov_b64 v[54:55], v[10:11]
    v_mov_b64 v[56:57], v[8:9]
    v_mov_b64 v[58:59], v[8:9]
    v_mov_b64 v[60:61], v[8:9]
    v_mov_b64 v[62:63], v[8:9]
    v_mov_b64 v[64:65], v[14:15]
    v_mov_b64 v[66:67], v[14:15]
    v_mov_b64 v[68:69], v[14:15]
    v_mov_b64 v[70:71], v[14:15]
    v_mov_b64 v[72:73], v[10:11]
    v_mov_b64 v[74:75], v[10:11]
    v_mov_b64 v[76:77], v[8:9]
    v_mov_b64 v[78:79], v[8:9]
    v_mov_b64 v[80:81], v[8:9]
    v_mov_b64 v[82:83], v[8:9]
    v_mov_b64 v[84:85], v[14:15]
    v_mov_b64 v[86:87], v[14:15]
    v_mov_b64 v[88:89], v[14:15]
    v_mov_b64 v[90:91], v[14:15]
    v_mov_b64 v[92:93], v[10:11]
    v_mov_b64 v[94:95], v[10:11]
    s_mov_b32 s40, 0x3fb8aa3b
    s_mov_b32 s41, s40
    v_mov_b32 v250, 0xbfb8aa47
    v_mov_b32 v251, v250
    v_mov_b32 v252, 0x358637bd
    v_mov_b32 v253, v252
    s_waitcnt lgkmcnt(0)
    s_mov_b32 s56, s28
    s_mov_b32 s57, s29
    s_mov_b32 s58, 4194304
    s_mov_b32 s59, 0x20000
    s_mov_b32 s52, s22
    s_mov_b32 s53, s23
    s_mov_b32 s54, 663552
    s_mov_b32 s55, 0x20000
    s_mul_i32 s38, s33, 8
    s_mul_i32 s39, s35, 4
    v_mov_b32 v13, 0x3f803f80
    s_add_u32 s38, s38, s39
    s_lshl_b32 s51, s32, 1
    s_add_u32 s51, s51, s36
    s_mul_i32 s51, s51, 2816
    s_lshl_b32 s50, s33, 3
    s_add_u32 s50, s50, s32
    s_and_b32 s50, s50, 15
    s_lshl_b32 s50, s50, 7
    s_add_u32 s50, s50, 49152
    v_lshlrev_b32 v243, 11, v1
    v_mov_b32 v8, 0x7ffffff0
    v_lshrrev_b32 v9, 2, v2
    v_and_b32 v10, 3, v2
    v_lshlrev_b32 v11, 8, v9
    v_lshl_add_u32 v11, v3, 4, v11
    v_lshl_add_u32 v236, v10, 2, v11
    v_cmp_gt_u32 s[44:45], 4, v2
    v_cmp_gt_u32 s[46:47], 2, v2
    s_nop 0
    v_cndmask_b32 v237, v8, v236, s[44:45]
    v_cmp_eq_u32 vcc, 1, v3
    v_cmp_eq_u32 s[48:49], 3, v3
    v_lshlrev_b32 v9, 2, v2
    v_cndmask_b32 v240, v8, v9, vcc
    v_add_u32 v10, 128, v240
    v_cndmask_b32 v238, v10, v9, s[48:49]
    v_add_u32 v10, 256, v240
    v_add_u32 v11, 64, v9
    v_cndmask_b32 v239, v10, v11, s[48:49]
    v_and_b32 v9, 1, v2
    v_lshlrev_b32 v9, 2, v9
    v_bfe_u32 v10, v2, 1, 1
    v_lshl_add_u32 v11, v10, 4, v9
    v_lshl_add_u32 v9, v10, 5, v9
    v_add_u32 v9, 32, v9
    v_cndmask_b32 v9, v8, v9, vcc
    v_cndmask_b32 v242, v8, v9, s[44:45]
    v_cndmask_b32 v9, v9, v11, s[48:49]
    v_cndmask_b32 v241, v8, v9, s[44:45]
    s_lshl_b32 s3, s31, 11
    s_add_u32 s3, s3, 147456
    v_lshl_add_u32 v248, v1, 4, s3
    v_xor_b32 v249, 0x800, v248
    s_lshl_b32 s3, s31, 9
    s_add_u32 s3, s3, 157696
    v_lshl_add_u32 v14, v1, 3, s3
    v_xor_b32 v15, 0x200, v14
    v_mov_b64 v[8:9], 0
    ds_write_b64 v14, v[8:9]
    s_waitcnt lgkmcnt(0)
    v_lshrrev_b32 v244, 2, v2
    v_lshl_add_u32 v244, v3, 2, v244
    v_and_b32 v245, 7, v244
    v_lshlrev_b32 v245, 1, v245
    v_bfe_u32 v246, v2, 1, 1
    s_lshr_b32 s3, s31, 1
    s_xor_b32 s3, s3, 2
    s_lshl_b32 s3, s3, 2
    v_add_u32 v246, s3, v246
    v_xor_b32 v245, v245, v246
    v_lshlrev_b32 v244, 8, v244
    v_lshl_add_u32 v244, v245, 4, v244
    v_and_b32 v245, 1, v2
    v_lshl_add_u32 v244, v245, 3, v244
    v_xor_b32 v245, 32, v244
    v_add_u32 v246, 0x10000, v244
    v_add_u32 v247, 0x10000, v245
    s_barrier
    ds_read_b64_tr_b16 v[140:141], v6 offset:0
    ds_read_b64_tr_b16 v[142:143], v6 offset:4608
    ds_read_b128 v[120:123], v4 offset:0
    ds_read_b128 v[124:127], v4 offset:2048
    ds_read_b128 v[128:131], v4 offset:4096
    ds_read_b128 v[132:135], v4 offset:6144
    ds_read_b64_tr_b16 v[144:145], v6 offset:40
    ds_read_b64_tr_b16 v[146:147], v6 offset:4648
    ds_read_b64_tr_b16 v[156:157], v7 offset:0
    ds_read_b64_tr_b16 v[158:159], v7 offset:4608
    ds_read_b64_tr_b16 v[148:149], v6 offset:144
    ds_read_b64_tr_b16 v[150:151], v6 offset:4752
    ds_read_b64_tr_b16 v[152:153], v6 offset:184
    ds_read_b64_tr_b16 v[154:155], v6 offset:4792
    s_waitcnt lgkmcnt(0)
    ds_read_b64_tr_b16 v[180:181], v6 offset:9216
    v_mfma_f32_16x16x32_bf16 v[16:19], v[120:123], v[140:143], v[16:19]
    ds_read_b64_tr_b16 v[182:183], v6 offset:13824
    v_mfma_f32_16x16x32_bf16 v[36:39], v[124:127], v[140:143], v[36:39]
    ds_read_b128 v[160:163], v5 offset:0
    v_mfma_f32_16x16x32_bf16 v[56:59], v[128:131], v[140:143], v[56:59]
    ds_read_b128 v[164:167], v5 offset:2048
    v_mfma_f32_16x16x32_bf16 v[76:79], v[132:135], v[140:143], v[76:79]
    ds_read_b128 v[168:171], v5 offset:4096
    v_mfma_f32_16x16x32_bf16 v[20:23], v[120:123], v[144:147], v[20:23]
    ds_read_b128 v[172:175], v5 offset:6144
    v_mfma_f32_16x16x32_bf16 v[40:43], v[124:127], v[144:147], v[40:43]
    ds_read_b64_tr_b16 v[184:185], v6 offset:9256
    v_mfma_f32_16x16x32_bf16 v[60:63], v[128:131], v[144:147], v[60:63]
    ds_read_b64_tr_b16 v[186:187], v6 offset:13864
    v_mfma_f32_16x16x32_bf16 v[80:83], v[132:135], v[144:147], v[80:83]
    ds_read_b64_tr_b16 v[196:197], v7 offset:9216
    v_mfma_f32_16x16x32_bf16 v[32:35], v[120:123], v[156:159], v[32:35]
    ds_read_b64_tr_b16 v[198:199], v7 offset:13824
    v_mfma_f32_16x16x32_bf16 v[52:55], v[124:127], v[156:159], v[52:55]
    ds_read_b64_tr_b16 v[188:189], v6 offset:9360
    v_mfma_f32_16x16x32_bf16 v[72:75], v[128:131], v[156:159], v[72:75]
    ds_read_b64_tr_b16 v[190:191], v6 offset:13968
    v_mfma_f32_16x16x32_bf16 v[92:95], v[132:135], v[156:159], v[92:95]
    ds_read_b64_tr_b16 v[192:193], v6 offset:9400
    v_mfma_f32_16x16x32_bf16 v[24:27], v[120:123], v[148:151], v[24:27]
    ds_read_b64_tr_b16 v[194:195], v6 offset:14008
    v_mfma_f32_16x16x32_bf16 v[44:47], v[124:127], v[148:151], v[44:47]
    v_add_u32 v4, 0x8800, v4
    v_mfma_f32_16x16x32_bf16 v[64:67], v[128:131], v[148:151], v[64:67]
    v_add_u32 v5, 0x8800, v5
    v_mfma_f32_16x16x32_bf16 v[84:87], v[132:135], v[148:151], v[84:87]
    v_add_u32 v6, 0x8800, v6
    v_mfma_f32_16x16x32_bf16 v[28:31], v[120:123], v[152:155], v[28:31]
    v_add_u32 v7, 0x8800, v7
    v_mfma_f32_16x16x32_bf16 v[48:51], v[124:127], v[152:155], v[48:51]
    v_mfma_f32_16x16x32_bf16 v[68:71], v[128:131], v[152:155], v[68:71]
    v_mfma_f32_16x16x32_bf16 v[88:91], v[132:135], v[152:155], v[88:91]
    s_waitcnt lgkmcnt(0)
    s_barrier
    ds_read_b64_tr_b16 v[140:141], v6 offset:0
    v_mfma_f32_16x16x32_bf16 v[16:19], v[160:163], v[180:183], v[16:19]
    ds_read_b64_tr_b16 v[142:143], v6 offset:4608
    v_mfma_f32_16x16x32_bf16 v[36:39], v[164:167], v[180:183], v[36:39]
    ds_read_b128 v[120:123], v4 offset:0
    v_mfma_f32_16x16x32_bf16 v[56:59], v[168:171], v[180:183], v[56:59]
    ds_read_b128 v[124:127], v4 offset:2048
    v_mfma_f32_16x16x32_bf16 v[76:79], v[172:175], v[180:183], v[76:79]
    ds_read_b128 v[128:131], v4 offset:4096
    v_mfma_f32_16x16x32_bf16 v[20:23], v[160:163], v[184:187], v[20:23]
    ds_read_b128 v[132:135], v4 offset:6144
    v_mfma_f32_16x16x32_bf16 v[40:43], v[164:167], v[184:187], v[40:43]
    ds_read_b64_tr_b16 v[144:145], v6 offset:40
    v_mfma_f32_16x16x32_bf16 v[60:63], v[168:171], v[184:187], v[60:63]
    ds_read_b64_tr_b16 v[146:147], v6 offset:4648
    v_mfma_f32_16x16x32_bf16 v[80:83], v[172:175], v[184:187], v[80:83]
    ds_read_b64_tr_b16 v[156:157], v7 offset:0
    v_mfma_f32_16x16x32_bf16 v[32:35], v[160:163], v[196:199], v[32:35]
    ds_read_b64_tr_b16 v[158:159], v7 offset:4608
    v_mfma_f32_16x16x32_bf16 v[52:55], v[164:167], v[196:199], v[52:55]
    ds_read_b64_tr_b16 v[148:149], v6 offset:144
    v_mfma_f32_16x16x32_bf16 v[72:75], v[168:171], v[196:199], v[72:75]
    ds_read_b64_tr_b16 v[150:151], v6 offset:4752
    v_mfma_f32_16x16x32_bf16 v[92:95], v[172:175], v[196:199], v[92:95]
    ds_read_b64_tr_b16 v[152:153], v6 offset:184
    v_mfma_f32_16x16x32_bf16 v[24:27], v[160:163], v[188:191], v[24:27]
    ds_read_b64_tr_b16 v[154:155], v6 offset:4792
    v_mfma_f32_16x16x32_bf16 v[44:47], v[164:167], v[188:191], v[44:47]
    v_mfma_f32_16x16x32_bf16 v[64:67], v[168:171], v[188:191], v[64:67]
    v_mfma_f32_16x16x32_bf16 v[84:87], v[172:175], v[188:191], v[84:87]
    v_mfma_f32_16x16x32_bf16 v[28:31], v[160:163], v[192:195], v[28:31]
    v_mfma_f32_16x16x32_bf16 v[48:51], v[164:167], v[192:195], v[48:51]
    v_mfma_f32_16x16x32_bf16 v[68:71], v[168:171], v[192:195], v[68:71]
    v_mfma_f32_16x16x32_bf16 v[88:91], v[172:175], v[192:195], v[88:91]
    s_waitcnt lgkmcnt(0)
    ds_read_b64_tr_b16 v[180:181], v6 offset:9216
    v_mfma_f32_16x16x32_bf16 v[16:19], v[120:123], v[140:143], v[16:19]
    ds_read_b64_tr_b16 v[182:183], v6 offset:13824
    v_mfma_f32_16x16x32_bf16 v[36:39], v[124:127], v[140:143], v[36:39]
    ds_read_b128 v[160:163], v5 offset:0
    v_mfma_f32_16x16x32_bf16 v[56:59], v[128:131], v[140:143], v[56:59]
    ds_read_b128 v[164:167], v5 offset:2048
    v_mfma_f32_16x16x32_bf16 v[76:79], v[132:135], v[140:143], v[76:79]
    ds_read_b128 v[168:171], v5 offset:4096
    v_mfma_f32_16x16x32_bf16 v[20:23], v[120:123], v[144:147], v[20:23]
    ds_read_b128 v[172:175], v5 offset:6144
    v_mfma_f32_16x16x32_bf16 v[40:43], v[124:127], v[144:147], v[40:43]
    ds_read_b64_tr_b16 v[184:185], v6 offset:9256
    v_mfma_f32_16x16x32_bf16 v[60:63], v[128:131], v[144:147], v[60:63]
    ds_read_b64_tr_b16 v[186:187], v6 offset:13864
    v_mfma_f32_16x16x32_bf16 v[80:83], v[132:135], v[144:147], v[80:83]
    ds_read_b64_tr_b16 v[196:197], v7 offset:9216
    v_mfma_f32_16x16x32_bf16 v[32:35], v[120:123], v[156:159], v[32:35]
    ds_read_b64_tr_b16 v[198:199], v7 offset:13824
    v_mfma_f32_16x16x32_bf16 v[52:55], v[124:127], v[156:159], v[52:55]
    ds_read_b64_tr_b16 v[188:189], v6 offset:9360
    v_mfma_f32_16x16x32_bf16 v[72:75], v[128:131], v[156:159], v[72:75]
    ds_read_b64_tr_b16 v[190:191], v6 offset:13968
    v_mfma_f32_16x16x32_bf16 v[92:95], v[132:135], v[156:159], v[92:95]
    ds_read_b64_tr_b16 v[192:193], v6 offset:9400
    v_mfma_f32_16x16x32_bf16 v[24:27], v[120:123], v[148:151], v[24:27]
    ds_read_b64_tr_b16 v[194:195], v6 offset:14008
    v_mfma_f32_16x16x32_bf16 v[44:47], v[124:127], v[148:151], v[44:47]
    v_add_u32 v4, 0x8800, v4
    v_mfma_f32_16x16x32_bf16 v[64:67], v[128:131], v[148:151], v[64:67]
    v_add_u32 v5, 0x8800, v5
    v_mfma_f32_16x16x32_bf16 v[84:87], v[132:135], v[148:151], v[84:87]
    v_add_u32 v6, 0x8800, v6
    v_mfma_f32_16x16x32_bf16 v[28:31], v[120:123], v[152:155], v[28:31]
    v_add_u32 v7, 0x8800, v7
    v_mfma_f32_16x16x32_bf16 v[48:51], v[124:127], v[152:155], v[48:51]
    v_mfma_f32_16x16x32_bf16 v[68:71], v[128:131], v[152:155], v[68:71]
    v_mfma_f32_16x16x32_bf16 v[88:91], v[132:135], v[152:155], v[88:91]
    s_waitcnt lgkmcnt(0)
    s_barrier
    ds_read_b64_tr_b16 v[140:141], v6 offset:0
    v_mfma_f32_16x16x32_bf16 v[16:19], v[160:163], v[180:183], v[16:19]
    ds_read_b64_tr_b16 v[142:143], v6 offset:4608
    v_mfma_f32_16x16x32_bf16 v[36:39], v[164:167], v[180:183], v[36:39]
    ds_read_b128 v[120:123], v4 offset:0
    v_mfma_f32_16x16x32_bf16 v[56:59], v[168:171], v[180:183], v[56:59]
    ds_read_b128 v[124:127], v4 offset:2048
    v_mfma_f32_16x16x32_bf16 v[76:79], v[172:175], v[180:183], v[76:79]
    ds_read_b128 v[128:131], v4 offset:4096
    v_mfma_f32_16x16x32_bf16 v[20:23], v[160:163], v[184:187], v[20:23]
    ds_read_b128 v[132:135], v4 offset:6144
    v_mfma_f32_16x16x32_bf16 v[40:43], v[164:167], v[184:187], v[40:43]
    ds_read_b64_tr_b16 v[144:145], v6 offset:40
    v_mfma_f32_16x16x32_bf16 v[60:63], v[168:171], v[184:187], v[60:63]
    ds_read_b64_tr_b16 v[146:147], v6 offset:4648
    v_mfma_f32_16x16x32_bf16 v[80:83], v[172:175], v[184:187], v[80:83]
    ds_read_b64_tr_b16 v[156:157], v7 offset:0
    v_mfma_f32_16x16x32_bf16 v[32:35], v[160:163], v[196:199], v[32:35]
    ds_read_b64_tr_b16 v[158:159], v7 offset:4608
    v_mfma_f32_16x16x32_bf16 v[52:55], v[164:167], v[196:199], v[52:55]
    ds_read_b64_tr_b16 v[148:149], v6 offset:144
    v_mfma_f32_16x16x32_bf16 v[72:75], v[168:171], v[196:199], v[72:75]
    ds_read_b64_tr_b16 v[150:151], v6 offset:4752
    v_mfma_f32_16x16x32_bf16 v[92:95], v[172:175], v[196:199], v[92:95]
    ds_read_b64_tr_b16 v[152:153], v6 offset:184
    v_mfma_f32_16x16x32_bf16 v[24:27], v[160:163], v[188:191], v[24:27]
    ds_read_b64_tr_b16 v[154:155], v6 offset:4792
    v_mfma_f32_16x16x32_bf16 v[44:47], v[164:167], v[188:191], v[44:47]
    v_mfma_f32_16x16x32_bf16 v[64:67], v[168:171], v[188:191], v[64:67]
    v_mfma_f32_16x16x32_bf16 v[84:87], v[172:175], v[188:191], v[84:87]
    v_mfma_f32_16x16x32_bf16 v[28:31], v[160:163], v[192:195], v[28:31]
    v_mfma_f32_16x16x32_bf16 v[48:51], v[164:167], v[192:195], v[48:51]
    v_mfma_f32_16x16x32_bf16 v[68:71], v[168:171], v[192:195], v[68:71]
    v_mfma_f32_16x16x32_bf16 v[88:91], v[172:175], v[192:195], v[88:91]
    s_waitcnt lgkmcnt(0)
    ds_read_b64_tr_b16 v[180:181], v6 offset:9216
    v_mfma_f32_16x16x32_bf16 v[16:19], v[120:123], v[140:143], v[16:19]
    ds_read_b64_tr_b16 v[182:183], v6 offset:13824
    v_mfma_f32_16x16x32_bf16 v[36:39], v[124:127], v[140:143], v[36:39]
    ds_read_b128 v[160:163], v5 offset:0
    v_mfma_f32_16x16x32_bf16 v[56:59], v[128:131], v[140:143], v[56:59]
    ds_read_b128 v[164:167], v5 offset:2048
    v_mfma_f32_16x16x32_bf16 v[76:79], v[132:135], v[140:143], v[76:79]
    ds_read_b128 v[168:171], v5 offset:4096
    v_mfma_f32_16x16x32_bf16 v[20:23], v[120:123], v[144:147], v[20:23]
    ds_read_b128 v[172:175], v5 offset:6144
    v_mfma_f32_16x16x32_bf16 v[40:43], v[124:127], v[144:147], v[40:43]
    ds_read_b64_tr_b16 v[184:185], v6 offset:9256
    v_mfma_f32_16x16x32_bf16 v[60:63], v[128:131], v[144:147], v[60:63]
    ds_read_b64_tr_b16 v[186:187], v6 offset:13864
    v_mfma_f32_16x16x32_bf16 v[80:83], v[132:135], v[144:147], v[80:83]
    ds_read_b64_tr_b16 v[196:197], v7 offset:9216
    v_mfma_f32_16x16x32_bf16 v[32:35], v[120:123], v[156:159], v[32:35]
    ds_read_b64_tr_b16 v[198:199], v7 offset:13824
    v_mfma_f32_16x16x32_bf16 v[52:55], v[124:127], v[156:159], v[52:55]
    ds_read_b64_tr_b16 v[188:189], v6 offset:9360
    v_mfma_f32_16x16x32_bf16 v[72:75], v[128:131], v[156:159], v[72:75]
    ds_read_b64_tr_b16 v[190:191], v6 offset:13968
    v_mfma_f32_16x16x32_bf16 v[92:95], v[132:135], v[156:159], v[92:95]
    ds_read_b64_tr_b16 v[192:193], v6 offset:9400
    v_mfma_f32_16x16x32_bf16 v[24:27], v[120:123], v[148:151], v[24:27]
    ds_read_b64_tr_b16 v[194:195], v6 offset:14008
    v_mfma_f32_16x16x32_bf16 v[44:47], v[124:127], v[148:151], v[44:47]
    v_add_u32 v4, 0x8800, v4
    v_mfma_f32_16x16x32_bf16 v[64:67], v[128:131], v[148:151], v[64:67]
    v_add_u32 v5, 0x8800, v5
    v_mfma_f32_16x16x32_bf16 v[84:87], v[132:135], v[148:151], v[84:87]
    v_add_u32 v6, 0x8800, v6
    v_mfma_f32_16x16x32_bf16 v[28:31], v[120:123], v[152:155], v[28:31]
    v_add_u32 v7, 0x8800, v7
    v_mfma_f32_16x16x32_bf16 v[48:51], v[124:127], v[152:155], v[48:51]
    v_mfma_f32_16x16x32_bf16 v[68:71], v[128:131], v[152:155], v[68:71]
    v_mfma_f32_16x16x32_bf16 v[88:91], v[132:135], v[152:155], v[88:91]
    s_waitcnt lgkmcnt(0)
    s_barrier
    ds_read_b64_tr_b16 v[140:141], v6 offset:0
    v_mfma_f32_16x16x32_bf16 v[16:19], v[160:163], v[180:183], v[16:19]
    ds_read_b64_tr_b16 v[142:143], v6 offset:4608
    v_mfma_f32_16x16x32_bf16 v[36:39], v[164:167], v[180:183], v[36:39]
    ds_read_b128 v[120:123], v4 offset:0
    v_mfma_f32_16x16x32_bf16 v[56:59], v[168:171], v[180:183], v[56:59]
    ds_read_b128 v[124:127], v4 offset:2048
    v_mfma_f32_16x16x32_bf16 v[76:79], v[172:175], v[180:183], v[76:79]
    ds_read_b128 v[128:131], v4 offset:4096
    v_mfma_f32_16x16x32_bf16 v[20:23], v[160:163], v[184:187], v[20:23]
    ds_read_b128 v[132:135], v4 offset:6144
    v_mfma_f32_16x16x32_bf16 v[40:43], v[164:167], v[184:187], v[40:43]
    ds_read_b64_tr_b16 v[144:145], v6 offset:40
    v_mfma_f32_16x16x32_bf16 v[60:63], v[168:171], v[184:187], v[60:63]
    ds_read_b64_tr_b16 v[146:147], v6 offset:4648
    v_mfma_f32_16x16x32_bf16 v[80:83], v[172:175], v[184:187], v[80:83]
    ds_read_b64_tr_b16 v[156:157], v7 offset:0
    v_mfma_f32_16x16x32_bf16 v[32:35], v[160:163], v[196:199], v[32:35]
    ds_read_b64_tr_b16 v[158:159], v7 offset:4608
    v_mfma_f32_16x16x32_bf16 v[52:55], v[164:167], v[196:199], v[52:55]
    ds_read_b64_tr_b16 v[148:149], v6 offset:144
    v_mfma_f32_16x16x32_bf16 v[72:75], v[168:171], v[196:199], v[72:75]
    ds_read_b64_tr_b16 v[150:151], v6 offset:4752
    v_mfma_f32_16x16x32_bf16 v[92:95], v[172:175], v[196:199], v[92:95]
    ds_read_b64_tr_b16 v[152:153], v6 offset:184
    v_mfma_f32_16x16x32_bf16 v[24:27], v[160:163], v[188:191], v[24:27]
    ds_read_b64_tr_b16 v[154:155], v6 offset:4792
    v_mfma_f32_16x16x32_bf16 v[44:47], v[164:167], v[188:191], v[44:47]
    v_mfma_f32_16x16x32_bf16 v[64:67], v[168:171], v[188:191], v[64:67]
    v_mfma_f32_16x16x32_bf16 v[84:87], v[172:175], v[188:191], v[84:87]
    v_mfma_f32_16x16x32_bf16 v[28:31], v[160:163], v[192:195], v[28:31]
    v_mfma_f32_16x16x32_bf16 v[48:51], v[164:167], v[192:195], v[48:51]
    v_mfma_f32_16x16x32_bf16 v[68:71], v[168:171], v[192:195], v[68:71]
    v_mfma_f32_16x16x32_bf16 v[88:91], v[172:175], v[192:195], v[88:91]
    s_waitcnt lgkmcnt(0)
    ds_read_b64_tr_b16 v[180:181], v6 offset:9216
    v_mfma_f32_16x16x32_bf16 v[16:19], v[120:123], v[140:143], v[16:19]
    ds_read_b64_tr_b16 v[182:183], v6 offset:13824
    v_mfma_f32_16x16x32_bf16 v[36:39], v[124:127], v[140:143], v[36:39]
    ds_read_b128 v[160:163], v5 offset:0
    v_mfma_f32_16x16x32_bf16 v[56:59], v[128:131], v[140:143], v[56:59]
    ds_read_b128 v[164:167], v5 offset:2048
    v_mfma_f32_16x16x32_bf16 v[76:79], v[132:135], v[140:143], v[76:79]
    ds_read_b128 v[168:171], v5 offset:4096
    v_mfma_f32_16x16x32_bf16 v[20:23], v[120:123], v[144:147], v[20:23]
    ds_read_b128 v[172:175], v5 offset:6144
    v_mfma_f32_16x16x32_bf16 v[40:43], v[124:127], v[144:147], v[40:43]
    ds_read_b64_tr_b16 v[184:185], v6 offset:9256
    v_mfma_f32_16x16x32_bf16 v[60:63], v[128:131], v[144:147], v[60:63]
    ds_read_b64_tr_b16 v[186:187], v6 offset:13864
    v_mfma_f32_16x16x32_bf16 v[80:83], v[132:135], v[144:147], v[80:83]
    ds_read_b64_tr_b16 v[196:197], v7 offset:9216
    v_mfma_f32_16x16x32_bf16 v[32:35], v[120:123], v[156:159], v[32:35]
    ds_read_b64_tr_b16 v[198:199], v7 offset:13824
    v_mfma_f32_16x16x32_bf16 v[52:55], v[124:127], v[156:159], v[52:55]
    ds_read_b64_tr_b16 v[188:189], v6 offset:9360
    v_mfma_f32_16x16x32_bf16 v[72:75], v[128:131], v[156:159], v[72:75]
    ds_read_b64_tr_b16 v[190:191], v6 offset:13968
    v_mfma_f32_16x16x32_bf16 v[92:95], v[132:135], v[156:159], v[92:95]
    ds_read_b64_tr_b16 v[192:193], v6 offset:9400
    v_mfma_f32_16x16x32_bf16 v[24:27], v[120:123], v[148:151], v[24:27]
    ds_read_b64_tr_b16 v[194:195], v6 offset:14008
    v_mfma_f32_16x16x32_bf16 v[44:47], v[124:127], v[148:151], v[44:47]
    v_add_u32 v4, 0xfffe6800, v4
    v_mfma_f32_16x16x32_bf16 v[64:67], v[128:131], v[148:151], v[64:67]
    v_add_u32 v5, 0xfffe6800, v5
    v_mfma_f32_16x16x32_bf16 v[84:87], v[132:135], v[148:151], v[84:87]
    v_add_u32 v6, 0xfffe6800, v6
    v_mfma_f32_16x16x32_bf16 v[28:31], v[120:123], v[152:155], v[28:31]
    v_add_u32 v7, 0xfffe6800, v7
    v_mfma_f32_16x16x32_bf16 v[48:51], v[124:127], v[152:155], v[48:51]
    v_mfma_f32_16x16x32_bf16 v[68:71], v[128:131], v[152:155], v[68:71]
    v_mfma_f32_16x16x32_bf16 v[88:91], v[132:135], v[152:155], v[88:91]
    s_waitcnt lgkmcnt(0)
    s_barrier
    ds_read_b64_tr_b16 v[140:141], v6 offset:0
    v_mfma_f32_16x16x32_bf16 v[16:19], v[160:163], v[180:183], v[16:19]
    ds_read_b64_tr_b16 v[142:143], v6 offset:4608
    v_mfma_f32_16x16x32_bf16 v[36:39], v[164:167], v[180:183], v[36:39]
    ds_read_b128 v[120:123], v4 offset:0
    v_mfma_f32_16x16x32_bf16 v[56:59], v[168:171], v[180:183], v[56:59]
    ds_read_b128 v[124:127], v4 offset:2048
    v_mfma_f32_16x16x32_bf16 v[76:79], v[172:175], v[180:183], v[76:79]
    ds_read_b128 v[128:131], v4 offset:4096
    v_mfma_f32_16x16x32_bf16 v[20:23], v[160:163], v[184:187], v[20:23]
    ds_read_b128 v[132:135], v4 offset:6144
    v_mfma_f32_16x16x32_bf16 v[40:43], v[164:167], v[184:187], v[40:43]
    ds_read_b64_tr_b16 v[144:145], v6 offset:40
    v_mfma_f32_16x16x32_bf16 v[60:63], v[168:171], v[184:187], v[60:63]
    ds_read_b64_tr_b16 v[146:147], v6 offset:4648
    v_mfma_f32_16x16x32_bf16 v[80:83], v[172:175], v[184:187], v[80:83]
    ds_read_b64_tr_b16 v[156:157], v7 offset:0
    v_mfma_f32_16x16x32_bf16 v[32:35], v[160:163], v[196:199], v[32:35]
    ds_read_b64_tr_b16 v[158:159], v7 offset:4608
    v_mfma_f32_16x16x32_bf16 v[52:55], v[164:167], v[196:199], v[52:55]
    ds_read_b64_tr_b16 v[148:149], v6 offset:144
    v_mfma_f32_16x16x32_bf16 v[72:75], v[168:171], v[196:199], v[72:75]
    ds_read_b64_tr_b16 v[150:151], v6 offset:4752
    v_mfma_f32_16x16x32_bf16 v[92:95], v[172:175], v[196:199], v[92:95]
    ds_read_b64_tr_b16 v[152:153], v6 offset:184
    v_mfma_f32_16x16x32_bf16 v[24:27], v[160:163], v[188:191], v[24:27]
    ds_read_b64_tr_b16 v[154:155], v6 offset:4792
    v_mfma_f32_16x16x32_bf16 v[44:47], v[164:167], v[188:191], v[44:47]
    v_mfma_f32_16x16x32_bf16 v[64:67], v[168:171], v[188:191], v[64:67]
    v_mfma_f32_16x16x32_bf16 v[84:87], v[172:175], v[188:191], v[84:87]
    v_mfma_f32_16x16x32_bf16 v[28:31], v[160:163], v[192:195], v[28:31]
    v_mfma_f32_16x16x32_bf16 v[48:51], v[164:167], v[192:195], v[48:51]
    v_mfma_f32_16x16x32_bf16 v[68:71], v[168:171], v[192:195], v[68:71]
    v_mfma_f32_16x16x32_bf16 v[88:91], v[172:175], v[192:195], v[88:91]
    s_waitcnt lgkmcnt(0)
    ds_read_b64_tr_b16 v[180:181], v6 offset:9216
    v_mfma_f32_16x16x32_bf16 v[16:19], v[120:123], v[140:143], v[16:19]
    ds_read_b64_tr_b16 v[182:183], v6 offset:13824
    v_mfma_f32_16x16x32_bf16 v[36:39], v[124:127], v[140:143], v[36:39]
    ds_read_b128 v[160:163], v5 offset:0
    v_mfma_f32_16x16x32_bf16 v[56:59], v[128:131], v[140:143], v[56:59]
    ds_read_b128 v[164:167], v5 offset:2048
    v_mfma_f32_16x16x32_bf16 v[76:79], v[132:135], v[140:143], v[76:79]
    ds_read_b128 v[168:171], v5 offset:4096
    v_mfma_f32_16x16x32_bf16 v[20:23], v[120:123], v[144:147], v[20:23]
    ds_read_b128 v[172:175], v5 offset:6144
    v_mfma_f32_16x16x32_bf16 v[40:43], v[124:127], v[144:147], v[40:43]
    ds_read_b64_tr_b16 v[184:185], v6 offset:9256
    v_mfma_f32_16x16x32_bf16 v[60:63], v[128:131], v[144:147], v[60:63]
    ds_read_b64_tr_b16 v[186:187], v6 offset:13864
    v_mfma_f32_16x16x32_bf16 v[80:83], v[132:135], v[144:147], v[80:83]
    ds_read_b64_tr_b16 v[196:197], v7 offset:9216
    v_mfma_f32_16x16x32_bf16 v[32:35], v[120:123], v[156:159], v[32:35]
    ds_read_b64_tr_b16 v[198:199], v7 offset:13824
    v_mfma_f32_16x16x32_bf16 v[52:55], v[124:127], v[156:159], v[52:55]
    ds_read_b64_tr_b16 v[188:189], v6 offset:9360
    v_mfma_f32_16x16x32_bf16 v[72:75], v[128:131], v[156:159], v[72:75]
    ds_read_b64_tr_b16 v[190:191], v6 offset:13968
    v_mfma_f32_16x16x32_bf16 v[92:95], v[132:135], v[156:159], v[92:95]
    ds_read_b64_tr_b16 v[192:193], v6 offset:9400
    v_mfma_f32_16x16x32_bf16 v[24:27], v[120:123], v[148:151], v[24:27]
    ds_read_b64_tr_b16 v[194:195], v6 offset:14008
    v_mfma_f32_16x16x32_bf16 v[44:47], v[124:127], v[148:151], v[44:47]
    v_add_u32 v4, 0x8800, v4
    v_mfma_f32_16x16x32_bf16 v[64:67], v[128:131], v[148:151], v[64:67]
    v_add_u32 v5, 0x8800, v5
    v_mfma_f32_16x16x32_bf16 v[84:87], v[132:135], v[148:151], v[84:87]
    v_add_u32 v6, 0x8800, v6
    v_mfma_f32_16x16x32_bf16 v[28:31], v[120:123], v[152:155], v[28:31]
    v_add_u32 v7, 0x8800, v7
    v_mfma_f32_16x16x32_bf16 v[48:51], v[124:127], v[152:155], v[48:51]
    v_mfma_f32_16x16x32_bf16 v[68:71], v[128:131], v[152:155], v[68:71]
    v_mfma_f32_16x16x32_bf16 v[88:91], v[132:135], v[152:155], v[88:91]
    s_waitcnt lgkmcnt(0)
    s_barrier
    ds_read_b64_tr_b16 v[140:141], v6 offset:0
    v_mfma_f32_16x16x32_bf16 v[16:19], v[160:163], v[180:183], v[16:19]
    ds_read_b64_tr_b16 v[142:143], v6 offset:4608
    v_mfma_f32_16x16x32_bf16 v[36:39], v[164:167], v[180:183], v[36:39]
    ds_read_b128 v[120:123], v4 offset:0
    v_mfma_f32_16x16x32_bf16 v[56:59], v[168:171], v[180:183], v[56:59]
    ds_read_b128 v[124:127], v4 offset:2048
    v_mfma_f32_16x16x32_bf16 v[76:79], v[172:175], v[180:183], v[76:79]
    ds_read_b128 v[128:131], v4 offset:4096
    v_mfma_f32_16x16x32_bf16 v[20:23], v[160:163], v[184:187], v[20:23]
    ds_read_b128 v[132:135], v4 offset:6144
    v_mfma_f32_16x16x32_bf16 v[40:43], v[164:167], v[184:187], v[40:43]
    ds_read_b64_tr_b16 v[144:145], v6 offset:40
    v_mfma_f32_16x16x32_bf16 v[60:63], v[168:171], v[184:187], v[60:63]
    ds_read_b64_tr_b16 v[146:147], v6 offset:4648
    v_mfma_f32_16x16x32_bf16 v[80:83], v[172:175], v[184:187], v[80:83]
    ds_read_b64_tr_b16 v[156:157], v7 offset:0
    v_mfma_f32_16x16x32_bf16 v[32:35], v[160:163], v[196:199], v[32:35]
    ds_read_b64_tr_b16 v[158:159], v7 offset:4608
    v_mfma_f32_16x16x32_bf16 v[52:55], v[164:167], v[196:199], v[52:55]
    ds_read_b64_tr_b16 v[148:149], v6 offset:144
    v_mfma_f32_16x16x32_bf16 v[72:75], v[168:171], v[196:199], v[72:75]
    ds_read_b64_tr_b16 v[150:151], v6 offset:4752
    v_mfma_f32_16x16x32_bf16 v[92:95], v[172:175], v[196:199], v[92:95]
    ds_read_b64_tr_b16 v[152:153], v6 offset:184
    v_mfma_f32_16x16x32_bf16 v[24:27], v[160:163], v[188:191], v[24:27]
    ds_read_b64_tr_b16 v[154:155], v6 offset:4792
    v_mfma_f32_16x16x32_bf16 v[44:47], v[164:167], v[188:191], v[44:47]
    v_mfma_f32_16x16x32_bf16 v[64:67], v[168:171], v[188:191], v[64:67]
    v_mfma_f32_16x16x32_bf16 v[84:87], v[172:175], v[188:191], v[84:87]
    v_mfma_f32_16x16x32_bf16 v[28:31], v[160:163], v[192:195], v[28:31]
    v_mfma_f32_16x16x32_bf16 v[48:51], v[164:167], v[192:195], v[48:51]
    v_mfma_f32_16x16x32_bf16 v[68:71], v[168:171], v[192:195], v[68:71]
    v_mfma_f32_16x16x32_bf16 v[88:91], v[172:175], v[192:195], v[88:91]
    s_waitcnt lgkmcnt(0)
    ds_read_b64_tr_b16 v[180:181], v6 offset:9216
    v_mfma_f32_16x16x32_bf16 v[16:19], v[120:123], v[140:143], v[16:19]
    ds_read_b64_tr_b16 v[182:183], v6 offset:13824
    v_mfma_f32_16x16x32_bf16 v[36:39], v[124:127], v[140:143], v[36:39]
    ds_read_b128 v[160:163], v5 offset:0
    v_mfma_f32_16x16x32_bf16 v[56:59], v[128:131], v[140:143], v[56:59]
    ds_read_b128 v[164:167], v5 offset:2048
    v_mfma_f32_16x16x32_bf16 v[76:79], v[132:135], v[140:143], v[76:79]
    ds_read_b128 v[168:171], v5 offset:4096
    v_mfma_f32_16x16x32_bf16 v[20:23], v[120:123], v[144:147], v[20:23]
    ds_read_b128 v[172:175], v5 offset:6144
    v_mfma_f32_16x16x32_bf16 v[40:43], v[124:127], v[144:147], v[40:43]
    ds_read_b64_tr_b16 v[184:185], v6 offset:9256
    v_mfma_f32_16x16x32_bf16 v[60:63], v[128:131], v[144:147], v[60:63]
    ds_read_b64_tr_b16 v[186:187], v6 offset:13864
    v_mfma_f32_16x16x32_bf16 v[80:83], v[132:135], v[144:147], v[80:83]
    ds_read_b64_tr_b16 v[196:197], v7 offset:9216
    v_mfma_f32_16x16x32_bf16 v[32:35], v[120:123], v[156:159], v[32:35]
    ds_read_b64_tr_b16 v[198:199], v7 offset:13824
    v_mfma_f32_16x16x32_bf16 v[52:55], v[124:127], v[156:159], v[52:55]
    ds_read_b64_tr_b16 v[188:189], v6 offset:9360
    v_mfma_f32_16x16x32_bf16 v[72:75], v[128:131], v[156:159], v[72:75]
    ds_read_b64_tr_b16 v[190:191], v6 offset:13968
    v_mfma_f32_16x16x32_bf16 v[92:95], v[132:135], v[156:159], v[92:95]
    ds_read_b64_tr_b16 v[192:193], v6 offset:9400
    v_mfma_f32_16x16x32_bf16 v[24:27], v[120:123], v[148:151], v[24:27]
    ds_read_b64_tr_b16 v[194:195], v6 offset:14008
    v_mfma_f32_16x16x32_bf16 v[44:47], v[124:127], v[148:151], v[44:47]
    v_add_u32 v4, 0x8800, v4
    v_mfma_f32_16x16x32_bf16 v[64:67], v[128:131], v[148:151], v[64:67]
    v_add_u32 v5, 0x8800, v5
    v_mfma_f32_16x16x32_bf16 v[84:87], v[132:135], v[148:151], v[84:87]
    v_add_u32 v6, 0x8800, v6
    v_mfma_f32_16x16x32_bf16 v[28:31], v[120:123], v[152:155], v[28:31]
    v_add_u32 v7, 0x8800, v7
    v_mfma_f32_16x16x32_bf16 v[48:51], v[124:127], v[152:155], v[48:51]
    v_mfma_f32_16x16x32_bf16 v[68:71], v[128:131], v[152:155], v[68:71]
    v_mfma_f32_16x16x32_bf16 v[88:91], v[132:135], v[152:155], v[88:91]
    s_waitcnt lgkmcnt(0)
    s_barrier
    ds_read_b64_tr_b16 v[140:141], v6 offset:0
    v_mfma_f32_16x16x32_bf16 v[16:19], v[160:163], v[180:183], v[16:19]
    ds_read_b64_tr_b16 v[142:143], v6 offset:4608
    v_mfma_f32_16x16x32_bf16 v[36:39], v[164:167], v[180:183], v[36:39]
    ds_read_b128 v[120:123], v4 offset:0
    v_mfma_f32_16x16x32_bf16 v[56:59], v[168:171], v[180:183], v[56:59]
    ds_read_b128 v[124:127], v4 offset:2048
    v_mfma_f32_16x16x32_bf16 v[76:79], v[172:175], v[180:183], v[76:79]
    ds_read_b128 v[128:131], v4 offset:4096
    v_mfma_f32_16x16x32_bf16 v[20:23], v[160:163], v[184:187], v[20:23]
    ds_read_b128 v[132:135], v4 offset:6144
    v_mfma_f32_16x16x32_bf16 v[40:43], v[164:167], v[184:187], v[40:43]
    ds_read_b64_tr_b16 v[144:145], v6 offset:40
    v_mfma_f32_16x16x32_bf16 v[60:63], v[168:171], v[184:187], v[60:63]
    ds_read_b64_tr_b16 v[146:147], v6 offset:4648
    v_mfma_f32_16x16x32_bf16 v[80:83], v[172:175], v[184:187], v[80:83]
    ds_read_b64_tr_b16 v[156:157], v7 offset:0
    v_mfma_f32_16x16x32_bf16 v[32:35], v[160:163], v[196:199], v[32:35]
    ds_read_b64_tr_b16 v[158:159], v7 offset:4608
    v_mfma_f32_16x16x32_bf16 v[52:55], v[164:167], v[196:199], v[52:55]
    ds_read_b64_tr_b16 v[148:149], v6 offset:144
    v_mfma_f32_16x16x32_bf16 v[72:75], v[168:171], v[196:199], v[72:75]
    ds_read_b64_tr_b16 v[150:151], v6 offset:4752
    v_mfma_f32_16x16x32_bf16 v[92:95], v[172:175], v[196:199], v[92:95]
    ds_read_b64_tr_b16 v[152:153], v6 offset:184
    v_mfma_f32_16x16x32_bf16 v[24:27], v[160:163], v[188:191], v[24:27]
    ds_read_b64_tr_b16 v[154:155], v6 offset:4792
    v_mfma_f32_16x16x32_bf16 v[44:47], v[164:167], v[188:191], v[44:47]
    v_mfma_f32_16x16x32_bf16 v[64:67], v[168:171], v[188:191], v[64:67]
    v_mfma_f32_16x16x32_bf16 v[84:87], v[172:175], v[188:191], v[84:87]
    v_mfma_f32_16x16x32_bf16 v[28:31], v[160:163], v[192:195], v[28:31]
    v_mfma_f32_16x16x32_bf16 v[48:51], v[164:167], v[192:195], v[48:51]
    v_mfma_f32_16x16x32_bf16 v[68:71], v[168:171], v[192:195], v[68:71]
    v_mfma_f32_16x16x32_bf16 v[88:91], v[172:175], v[192:195], v[88:91]
    s_waitcnt lgkmcnt(0)
    ds_read_b64_tr_b16 v[180:181], v6 offset:9216
    v_mfma_f32_16x16x32_bf16 v[16:19], v[120:123], v[140:143], v[16:19]
    ds_read_b64_tr_b16 v[182:183], v6 offset:13824
    v_mfma_f32_16x16x32_bf16 v[36:39], v[124:127], v[140:143], v[36:39]
    ds_read_b128 v[160:163], v5 offset:0
    v_mfma_f32_16x16x32_bf16 v[56:59], v[128:131], v[140:143], v[56:59]
    ds_read_b128 v[164:167], v5 offset:2048
    v_mfma_f32_16x16x32_bf16 v[76:79], v[132:135], v[140:143], v[76:79]
    ds_read_b128 v[168:171], v5 offset:4096
    v_mfma_f32_16x16x32_bf16 v[20:23], v[120:123], v[144:147], v[20:23]
    ds_read_b128 v[172:175], v5 offset:6144
    v_mfma_f32_16x16x32_bf16 v[40:43], v[124:127], v[144:147], v[40:43]
    ds_read_b64_tr_b16 v[184:185], v6 offset:9256
    v_mfma_f32_16x16x32_bf16 v[60:63], v[128:131], v[144:147], v[60:63]
    ds_read_b64_tr_b16 v[186:187], v6 offset:13864
    v_mfma_f32_16x16x32_bf16 v[80:83], v[132:135], v[144:147], v[80:83]
    ds_read_b64_tr_b16 v[196:197], v7 offset:9216
    v_mfma_f32_16x16x32_bf16 v[32:35], v[120:123], v[156:159], v[32:35]
    ds_read_b64_tr_b16 v[198:199], v7 offset:13824
    v_mfma_f32_16x16x32_bf16 v[52:55], v[124:127], v[156:159], v[52:55]
    ds_read_b64_tr_b16 v[188:189], v6 offset:9360
    v_mfma_f32_16x16x32_bf16 v[72:75], v[128:131], v[156:159], v[72:75]
    ds_read_b64_tr_b16 v[190:191], v6 offset:13968
    v_mfma_f32_16x16x32_bf16 v[92:95], v[132:135], v[156:159], v[92:95]
    ds_read_b64_tr_b16 v[192:193], v6 offset:9400
    v_mfma_f32_16x16x32_bf16 v[24:27], v[120:123], v[148:151], v[24:27]
    ds_read_b64_tr_b16 v[194:195], v6 offset:14008
    v_mfma_f32_16x16x32_bf16 v[44:47], v[124:127], v[148:151], v[44:47]
    v_add_u32 v4, 0x8800, v4
    v_mfma_f32_16x16x32_bf16 v[64:67], v[128:131], v[148:151], v[64:67]
    v_add_u32 v5, 0x8800, v5
    v_mfma_f32_16x16x32_bf16 v[84:87], v[132:135], v[148:151], v[84:87]
    v_add_u32 v6, 0x8800, v6
    v_mfma_f32_16x16x32_bf16 v[28:31], v[120:123], v[152:155], v[28:31]
    v_add_u32 v7, 0x8800, v7
    v_mfma_f32_16x16x32_bf16 v[48:51], v[124:127], v[152:155], v[48:51]
    v_mfma_f32_16x16x32_bf16 v[68:71], v[128:131], v[152:155], v[68:71]
    v_mfma_f32_16x16x32_bf16 v[88:91], v[132:135], v[152:155], v[88:91]
    s_waitcnt lgkmcnt(0)
    s_barrier
    ds_read_b64_tr_b16 v[140:141], v6 offset:0
    v_mfma_f32_16x16x32_bf16 v[16:19], v[160:163], v[180:183], v[16:19]
    ds_read_b64_tr_b16 v[142:143], v6 offset:4608
    v_mfma_f32_16x16x32_bf16 v[36:39], v[164:167], v[180:183], v[36:39]
    ds_read_b128 v[120:123], v4 offset:0
    v_mfma_f32_16x16x32_bf16 v[56:59], v[168:171], v[180:183], v[56:59]
    ds_read_b128 v[124:127], v4 offset:2048
    v_mfma_f32_16x16x32_bf16 v[76:79], v[172:175], v[180:183], v[76:79]
    ds_read_b128 v[128:131], v4 offset:4096
    v_mfma_f32_16x16x32_bf16 v[20:23], v[160:163], v[184:187], v[20:23]
    ds_read_b128 v[132:135], v4 offset:6144
    v_mfma_f32_16x16x32_bf16 v[40:43], v[164:167], v[184:187], v[40:43]
    ds_read_b64_tr_b16 v[144:145], v6 offset:40
    v_mfma_f32_16x16x32_bf16 v[60:63], v[168:171], v[184:187], v[60:63]
    ds_read_b64_tr_b16 v[146:147], v6 offset:4648
    v_mfma_f32_16x16x32_bf16 v[80:83], v[172:175], v[184:187], v[80:83]
    ds_read_b64_tr_b16 v[156:157], v7 offset:0
    v_mfma_f32_16x16x32_bf16 v[32:35], v[160:163], v[196:199], v[32:35]
    ds_read_b64_tr_b16 v[158:159], v7 offset:4608
    v_mfma_f32_16x16x32_bf16 v[52:55], v[164:167], v[196:199], v[52:55]
    ds_read_b64_tr_b16 v[148:149], v6 offset:144
    v_mfma_f32_16x16x32_bf16 v[72:75], v[168:171], v[196:199], v[72:75]
    ds_read_b64_tr_b16 v[150:151], v6 offset:4752
    v_mfma_f32_16x16x32_bf16 v[92:95], v[172:175], v[196:199], v[92:95]
    ds_read_b64_tr_b16 v[152:153], v6 offset:184
    v_mfma_f32_16x16x32_bf16 v[24:27], v[160:163], v[188:191], v[24:27]
    ds_read_b64_tr_b16 v[154:155], v6 offset:4792
    v_mfma_f32_16x16x32_bf16 v[44:47], v[164:167], v[188:191], v[44:47]
    v_mfma_f32_16x16x32_bf16 v[64:67], v[168:171], v[188:191], v[64:67]
    v_mfma_f32_16x16x32_bf16 v[84:87], v[172:175], v[188:191], v[84:87]
    v_mfma_f32_16x16x32_bf16 v[28:31], v[160:163], v[192:195], v[28:31]
    v_mfma_f32_16x16x32_bf16 v[48:51], v[164:167], v[192:195], v[48:51]
    v_mfma_f32_16x16x32_bf16 v[68:71], v[168:171], v[192:195], v[68:71]
    v_mfma_f32_16x16x32_bf16 v[88:91], v[172:175], v[192:195], v[88:91]
    s_waitcnt lgkmcnt(0)
    ds_read_b64_tr_b16 v[180:181], v6 offset:9216
    v_mfma_f32_16x16x32_bf16 v[16:19], v[120:123], v[140:143], v[16:19]
    ds_read_b64_tr_b16 v[182:183], v6 offset:13824
    v_mfma_f32_16x16x32_bf16 v[36:39], v[124:127], v[140:143], v[36:39]
    ds_read_b128 v[160:163], v5 offset:0
    v_mfma_f32_16x16x32_bf16 v[56:59], v[128:131], v[140:143], v[56:59]
    ds_read_b128 v[164:167], v5 offset:2048
    v_mfma_f32_16x16x32_bf16 v[76:79], v[132:135], v[140:143], v[76:79]
    ds_read_b128 v[168:171], v5 offset:4096
    v_mfma_f32_16x16x32_bf16 v[20:23], v[120:123], v[144:147], v[20:23]
    ds_read_b128 v[172:175], v5 offset:6144
    v_mfma_f32_16x16x32_bf16 v[40:43], v[124:127], v[144:147], v[40:43]
    ds_read_b64_tr_b16 v[184:185], v6 offset:9256
    v_mfma_f32_16x16x32_bf16 v[60:63], v[128:131], v[144:147], v[60:63]
    ds_read_b64_tr_b16 v[186:187], v6 offset:13864
    v_mfma_f32_16x16x32_bf16 v[80:83], v[132:135], v[144:147], v[80:83]
    ds_read_b64_tr_b16 v[196:197], v7 offset:9216
    v_mfma_f32_16x16x32_bf16 v[32:35], v[120:123], v[156:159], v[32:35]
    ds_read_b64_tr_b16 v[198:199], v7 offset:13824
    v_mfma_f32_16x16x32_bf16 v[52:55], v[124:127], v[156:159], v[52:55]
    ds_read_b64_tr_b16 v[188:189], v6 offset:9360
    v_mfma_f32_16x16x32_bf16 v[72:75], v[128:131], v[156:159], v[72:75]
    ds_read_b64_tr_b16 v[190:191], v6 offset:13968
    v_mfma_f32_16x16x32_bf16 v[92:95], v[132:135], v[156:159], v[92:95]
    ds_read_b64_tr_b16 v[192:193], v6 offset:9400
    v_mfma_f32_16x16x32_bf16 v[24:27], v[120:123], v[148:151], v[24:27]
    ds_read_b64_tr_b16 v[194:195], v6 offset:14008
    v_mfma_f32_16x16x32_bf16 v[44:47], v[124:127], v[148:151], v[44:47]
    v_add_u32 v4, 0xfffe6800, v4
    v_mfma_f32_16x16x32_bf16 v[64:67], v[128:131], v[148:151], v[64:67]
    v_add_u32 v5, 0xfffe6800, v5
    v_mfma_f32_16x16x32_bf16 v[84:87], v[132:135], v[148:151], v[84:87]
    v_add_u32 v6, 0xfffe6800, v6
    v_mfma_f32_16x16x32_bf16 v[28:31], v[120:123], v[152:155], v[28:31]
    v_add_u32 v7, 0xfffe6800, v7
    v_mfma_f32_16x16x32_bf16 v[48:51], v[124:127], v[152:155], v[48:51]
    v_mfma_f32_16x16x32_bf16 v[68:71], v[128:131], v[152:155], v[68:71]
    v_mfma_f32_16x16x32_bf16 v[88:91], v[132:135], v[152:155], v[88:91]
    s_waitcnt lgkmcnt(0)
    s_barrier
    ds_read_b64_tr_b16 v[140:141], v6 offset:0
    v_mfma_f32_16x16x32_bf16 v[16:19], v[160:163], v[180:183], v[16:19]
    ds_read_b64_tr_b16 v[142:143], v6 offset:4608
    v_mfma_f32_16x16x32_bf16 v[36:39], v[164:167], v[180:183], v[36:39]
    ds_read_b128 v[120:123], v4 offset:0
    v_mfma_f32_16x16x32_bf16 v[56:59], v[168:171], v[180:183], v[56:59]
    ds_read_b128 v[124:127], v4 offset:2048
    v_mfma_f32_16x16x32_bf16 v[76:79], v[172:175], v[180:183], v[76:79]
    ds_read_b128 v[128:131], v4 offset:4096
    v_mfma_f32_16x16x32_bf16 v[20:23], v[160:163], v[184:187], v[20:23]
    ds_read_b128 v[132:135], v4 offset:6144
    v_mfma_f32_16x16x32_bf16 v[40:43], v[164:167], v[184:187], v[40:43]
    ds_read_b64_tr_b16 v[144:145], v6 offset:40
    v_mfma_f32_16x16x32_bf16 v[60:63], v[168:171], v[184:187], v[60:63]
    ds_read_b64_tr_b16 v[146:147], v6 offset:4648
    v_mfma_f32_16x16x32_bf16 v[80:83], v[172:175], v[184:187], v[80:83]
    ds_read_b64_tr_b16 v[156:157], v7 offset:0
    v_mfma_f32_16x16x32_bf16 v[32:35], v[160:163], v[196:199], v[32:35]
    ds_read_b64_tr_b16 v[158:159], v7 offset:4608
    v_mfma_f32_16x16x32_bf16 v[52:55], v[164:167], v[196:199], v[52:55]
    ds_read_b64_tr_b16 v[148:149], v6 offset:144
    v_mfma_f32_16x16x32_bf16 v[72:75], v[168:171], v[196:199], v[72:75]
    ds_read_b64_tr_b16 v[150:151], v6 offset:4752
    v_mfma_f32_16x16x32_bf16 v[92:95], v[172:175], v[196:199], v[92:95]
    ds_read_b64_tr_b16 v[152:153], v6 offset:184
    v_mfma_f32_16x16x32_bf16 v[24:27], v[160:163], v[188:191], v[24:27]
    ds_read_b64_tr_b16 v[154:155], v6 offset:4792
    v_mfma_f32_16x16x32_bf16 v[44:47], v[164:167], v[188:191], v[44:47]
    v_mfma_f32_16x16x32_bf16 v[64:67], v[168:171], v[188:191], v[64:67]
    v_mfma_f32_16x16x32_bf16 v[84:87], v[172:175], v[188:191], v[84:87]
    v_mfma_f32_16x16x32_bf16 v[28:31], v[160:163], v[192:195], v[28:31]
    v_mfma_f32_16x16x32_bf16 v[48:51], v[164:167], v[192:195], v[48:51]
    v_mfma_f32_16x16x32_bf16 v[68:71], v[168:171], v[192:195], v[68:71]
    v_mfma_f32_16x16x32_bf16 v[88:91], v[172:175], v[192:195], v[88:91]
    s_waitcnt lgkmcnt(0)
    ds_read_b64_tr_b16 v[180:181], v6 offset:9216
    ds_read_b64_tr_b16 v[182:183], v6 offset:13824
    v_mfma_f32_16x16x32_bf16 v[16:19], v[120:123], v[140:143], v[16:19]
    ds_read_b128 v[160:163], v5 offset:0
    ds_read_b128 v[164:167], v5 offset:2048
    v_mfma_f32_16x16x32_bf16 v[20:23], v[120:123], v[144:147], v[20:23]
    ds_read_b128 v[168:171], v5 offset:4096
    ds_read_b128 v[172:175], v5 offset:6144
    v_mfma_f32_16x16x32_bf16 v[32:35], v[120:123], v[156:159], v[32:35]
    ds_read_b64_tr_b16 v[184:185], v6 offset:9256
    ds_read_b64_tr_b16 v[186:187], v6 offset:13864
    v_mfma_f32_16x16x32_bf16 v[24:27], v[120:123], v[148:151], v[24:27]
    ds_read_b64_tr_b16 v[196:197], v7 offset:9216
    ds_read_b64_tr_b16 v[198:199], v7 offset:13824
    v_mfma_f32_16x16x32_bf16 v[28:31], v[120:123], v[152:155], v[28:31]
    ds_read_b64_tr_b16 v[188:189], v6 offset:9360
    ds_read_b64_tr_b16 v[190:191], v6 offset:13968
    v_mfma_f32_16x16x32_bf16 v[36:39], v[124:127], v[140:143], v[36:39]
    ds_read_b64_tr_b16 v[192:193], v6 offset:9400
    ds_read_b64_tr_b16 v[194:195], v6 offset:14008
    v_mfma_f32_16x16x32_bf16 v[40:43], v[124:127], v[144:147], v[40:43]
    v_mfma_f32_16x16x32_bf16 v[52:55], v[124:127], v[156:159], v[52:55]
    v_mfma_f32_16x16x32_bf16 v[44:47], v[124:127], v[148:151], v[44:47]
    v_mfma_f32_16x16x32_bf16 v[48:51], v[124:127], v[152:155], v[48:51]
    s_waitcnt lgkmcnt(0)
    s_barrier
    v_mfma_f32_16x16x32_bf16 v[16:19], v[160:163], v[180:183], v[16:19]
    v_mfma_f32_16x16x32_bf16 v[20:23], v[160:163], v[184:187], v[20:23]
    v_mfma_f32_16x16x32_bf16 v[32:35], v[160:163], v[196:199], v[32:35]
    v_mfma_f32_16x16x32_bf16 v[24:27], v[160:163], v[188:191], v[24:27]
    v_mfma_f32_16x16x32_bf16 v[28:31], v[160:163], v[192:195], v[28:31]
    v_mfma_f32_16x16x32_bf16 v[36:39], v[164:167], v[180:183], v[36:39]
    v_mfma_f32_16x16x32_bf16 v[40:43], v[164:167], v[184:187], v[40:43]
    v_mfma_f32_16x16x32_bf16 v[52:55], v[164:167], v[196:199], v[52:55]
    s_nop 0
    v_fma_f32 v200, v16, s40, v250
    v_fma_f32 v201, v17, s40, v250
    v_mfma_f32_16x16x32_bf16 v[44:47], v[164:167], v[188:191], v[44:47]
    v_fma_f32 v202, v18, s40, v250
    v_fma_f32 v203, v19, s40, v250
    v_mfma_f32_16x16x32_bf16 v[48:51], v[164:167], v[192:195], v[48:51]
    v_exp_f32_e64 v200, v200 clamp
    v_mfma_f32_16x16x32_bf16 v[56:59], v[128:131], v[140:143], v[56:59]
    v_exp_f32_e64 v201, v201 clamp
    v_mfma_f32_16x16x32_bf16 v[60:63], v[128:131], v[144:147], v[60:63]
    v_exp_f32_e64 v202, v202 clamp
    v_mfma_f32_16x16x32_bf16 v[72:75], v[128:131], v[156:159], v[72:75]
    v_exp_f32_e64 v203, v203 clamp
    v_mfma_f32_16x16x32_bf16 v[64:67], v[128:131], v[148:151], v[64:67]
    v_add_f32 v200, v252, v200
    v_add_f32 v201, v252, v201
    v_mfma_f32_16x16x32_bf16 v[68:71], v[128:131], v[152:155], v[68:71]
    v_add_f32 v202, v252, v202
    v_add_f32 v203, v252, v203
    v_mfma_f32_16x16x32_bf16 v[56:59], v[168:171], v[180:183], v[56:59]
    v_max_f32 v200, v200, v16
    v_max_f32 v201, v201, v17
    v_mfma_f32_16x16x32_bf16 v[60:63], v[168:171], v[184:187], v[60:63]
    v_max_f32 v202, v202, v18
    v_max_f32 v203, v203, v19
    v_mfma_f32_16x16x32_bf16 v[72:75], v[168:171], v[196:199], v[72:75]
    v_cvt_pk_bf16_f32 v16, v200, v201
    v_cvt_pk_bf16_f32 v17, v202, v203
    v_mfma_f32_16x16x32_bf16 v[64:67], v[168:171], v[188:191], v[64:67]
    v_fma_f32 v204, v20, s40, v250
    v_fma_f32 v205, v21, s40, v250
    v_mfma_f32_16x16x32_bf16 v[68:71], v[168:171], v[192:195], v[68:71]
    v_fma_f32 v206, v22, s40, v250
    v_fma_f32 v207, v23, s40, v250
    v_mfma_f32_16x16x32_bf16 v[76:79], v[132:135], v[140:143], v[76:79]
    v_exp_f32_e64 v204, v204 clamp
    v_mfma_f32_16x16x32_bf16 v[80:83], v[132:135], v[144:147], v[80:83]
    v_exp_f32_e64 v205, v205 clamp
    v_mfma_f32_16x16x32_bf16 v[92:95], v[132:135], v[156:159], v[92:95]
    v_exp_f32_e64 v206, v206 clamp
    v_mfma_f32_16x16x32_bf16 v[84:87], v[132:135], v[148:151], v[84:87]
    v_exp_f32_e64 v207, v207 clamp
    v_mfma_f32_16x16x32_bf16 v[88:91], v[132:135], v[152:155], v[88:91]
    v_add_f32 v204, v252, v204
    v_add_f32 v205, v252, v205
    v_mfma_f32_16x16x32_bf16 v[76:79], v[172:175], v[180:183], v[76:79]
    v_add_f32 v206, v252, v206
    v_add_f32 v207, v252, v207
    v_mfma_f32_16x16x32_bf16 v[80:83], v[172:175], v[184:187], v[80:83]
    v_max_f32 v204, v204, v20
    v_max_f32 v205, v205, v21
    v_mfma_f32_16x16x32_bf16 v[92:95], v[172:175], v[196:199], v[92:95]
    v_max_f32 v206, v206, v22
    v_max_f32 v207, v207, v23
    v_mfma_f32_16x16x32_bf16 v[84:87], v[172:175], v[188:191], v[84:87]
    v_cvt_pk_bf16_f32 v20, v204, v205
    v_cvt_pk_bf16_f32 v21, v206, v207
    v_mfma_f32_16x16x32_bf16 v[88:91], v[172:175], v[192:195], v[88:91]
    v_pk_fma_f32 v[200:201], v[32:33], s[40:41], v[250:251]
    v_pk_fma_f32 v[202:203], v[34:35], s[40:41], v[250:251]
    v_exp_f32_e64 v200, v200 clamp
    v_exp_f32_e64 v201, v201 clamp
    v_exp_f32_e64 v202, v202 clamp
    v_exp_f32_e64 v203, v203 clamp
    v_pk_add_f32 v[200:201], v[200:201], v[252:253]
    v_pk_add_f32 v[202:203], v[202:203], v[252:253]
    v_max_f32 v200, v200, v32
    v_max_f32 v201, v201, v33
    v_max_f32 v202, v202, v34
    v_max_f32 v203, v203, v35
    v_cndmask_b32 v200, v200, v32, s[98:99]
    v_cndmask_b32 v201, v201, v33, s[98:99]
    v_cndmask_b32 v202, v202, v34, s[98:99]
    v_cndmask_b32 v203, v203, v35, s[98:99]
    v_cvt_pk_bf16_f32 v32, v200, v201
    v_cvt_pk_bf16_f32 v33, v202, v203
    v_cndmask_b32 v32, v32, v13, s[100:101]
    v_cndmask_b32 v33, v33, v13, s[100:101]
    v_cvt_pk_bf16_f32 v24, v24, v25
    v_cvt_pk_bf16_f32 v25, v26, v27
    v_cvt_pk_bf16_f32 v28, v28, v29
    v_cvt_pk_bf16_f32 v29, v30, v31
    v_pk_fma_f32 v[200:201], v[36:37], s[40:41], v[250:251]
    v_pk_fma_f32 v[202:203], v[38:39], s[40:41], v[250:251]
    v_exp_f32_e64 v200, v200 clamp
    v_exp_f32_e64 v201, v201 clamp
    v_exp_f32_e64 v202, v202 clamp
    v_exp_f32_e64 v203, v203 clamp
    v_pk_add_f32 v[200:201], v[200:201], v[252:253]
    v_pk_add_f32 v[202:203], v[202:203], v[252:253]
    v_max_f32 v200, v200, v36
    v_max_f32 v201, v201, v37
    v_max_f32 v202, v202, v38
    v_max_f32 v203, v203, v39
    v_cvt_pk_bf16_f32 v18, v200, v201
    v_cvt_pk_bf16_f32 v19, v202, v203
    v_pk_fma_f32 v[204:205], v[40:41], s[40:41], v[250:251]
    v_pk_fma_f32 v[206:207], v[42:43], s[40:41], v[250:251]
    v_exp_f32_e64 v204, v204 clamp
    v_exp_f32_e64 v205, v205 clamp
    v_exp_f32_e64 v206, v206 clamp
    v_exp_f32_e64 v207, v207 clamp
    v_pk_add_f32 v[204:205], v[204:205], v[252:253]
    v_pk_add_f32 v[206:207], v[206:207], v[252:253]
    v_max_f32 v204, v204, v40
    v_max_f32 v205, v205, v41
    v_max_f32 v206, v206, v42
    v_max_f32 v207, v207, v43
    v_cvt_pk_bf16_f32 v22, v204, v205
    v_cvt_pk_bf16_f32 v23, v206, v207
    v_pk_fma_f32 v[200:201], v[52:53], s[40:41], v[250:251]
    v_pk_fma_f32 v[202:203], v[54:55], s[40:41], v[250:251]
    v_exp_f32_e64 v200, v200 clamp
    v_exp_f32_e64 v201, v201 clamp
    v_exp_f32_e64 v202, v202 clamp
    v_exp_f32_e64 v203, v203 clamp
    v_pk_add_f32 v[200:201], v[200:201], v[252:253]
    v_pk_add_f32 v[202:203], v[202:203], v[252:253]
    v_max_f32 v200, v200, v52
    v_max_f32 v201, v201, v53
    v_max_f32 v202, v202, v54
    v_max_f32 v203, v203, v55
    v_cndmask_b32 v200, v200, v52, s[98:99]
    v_cndmask_b32 v201, v201, v53, s[98:99]
    v_cndmask_b32 v202, v202, v54, s[98:99]
    v_cndmask_b32 v203, v203, v55, s[98:99]
    v_cvt_pk_bf16_f32 v34, v200, v201
    v_cvt_pk_bf16_f32 v35, v202, v203
    v_cndmask_b32 v34, v34, v13, s[100:101]
    v_cndmask_b32 v35, v35, v13, s[100:101]
    v_cvt_pk_bf16_f32 v26, v44, v45
    v_cvt_pk_bf16_f32 v27, v46, v47
    v_cvt_pk_bf16_f32 v30, v48, v49
    v_cvt_pk_bf16_f32 v31, v50, v51
    v_fma_f32 v200, v56, s40, v250
    v_fma_f32 v201, v57, s40, v250
    v_mfma_f32_16x16x32_bf16 v[208:211], v[24:27], v[16:19], 0
    v_fma_f32 v202, v58, s40, v250
    v_fma_f32 v203, v59, s40, v250
    v_mfma_f32_16x16x32_bf16 v[212:215], v[28:31], v[20:23], 0
    v_exp_f32_e64 v200, v200 clamp
    v_mfma_f32_16x16x32_bf16 v[216:219], v[24:27], v[32:35], 0
    v_exp_f32_e64 v201, v201 clamp
    v_mfma_f32_16x16x32_bf16 v[220:223], v[28:31], v[32:35], 0
    v_exp_f32_e64 v202, v202 clamp
    v_mfma_f32_16x16x32_bf16 v[224:227], v[32:35], v[16:19], 0
    v_exp_f32_e64 v203, v203 clamp
    v_mfma_f32_16x16x32_bf16 v[228:231], v[32:35], v[20:23], 0
    v_add_f32 v200, v252, v200
    v_add_f32 v201, v252, v201
    v_mfma_f32_16x16x32_bf16 v[232:235], v[32:35], v[32:35], 0
    v_pk_add_f32 v[202:203], v[202:203], v[252:253]
    v_max_f32 v200, v200, v56
    v_max_f32 v201, v201, v57
    v_max_f32 v202, v202, v58
    v_max_f32 v203, v203, v59
    v_cvt_pk_bf16_f32 v56, v200, v201
    v_cvt_pk_bf16_f32 v57, v202, v203
    v_pk_fma_f32 v[204:205], v[60:61], s[40:41], v[250:251]
    v_pk_fma_f32 v[206:207], v[62:63], s[40:41], v[250:251]
    v_exp_f32_e64 v204, v204 clamp
    v_exp_f32_e64 v205, v205 clamp
    v_exp_f32_e64 v206, v206 clamp
    v_exp_f32_e64 v207, v207 clamp
    v_pk_add_f32 v[204:205], v[204:205], v[252:253]
    v_pk_add_f32 v[206:207], v[206:207], v[252:253]
    v_max_f32 v204, v204, v60
    v_max_f32 v205, v205, v61
    v_max_f32 v206, v206, v62
    v_max_f32 v207, v207, v63
    v_cvt_pk_bf16_f32 v60, v204, v205
    v_cvt_pk_bf16_f32 v61, v206, v207
    v_pk_fma_f32 v[200:201], v[72:73], s[40:41], v[250:251]
    v_pk_fma_f32 v[202:203], v[74:75], s[40:41], v[250:251]
    v_exp_f32_e64 v200, v200 clamp
    v_exp_f32_e64 v201, v201 clamp
    v_exp_f32_e64 v202, v202 clamp
    v_exp_f32_e64 v203, v203 clamp
    v_pk_add_f32 v[200:201], v[200:201], v[252:253]
    v_pk_add_f32 v[202:203], v[202:203], v[252:253]
    v_max_f32 v200, v200, v72
    v_max_f32 v201, v201, v73
    v_max_f32 v202, v202, v74
    v_max_f32 v203, v203, v75
    v_cndmask_b32 v200, v200, v72, s[98:99]
    v_cndmask_b32 v201, v201, v73, s[98:99]
    v_cndmask_b32 v202, v202, v74, s[98:99]
    v_cndmask_b32 v203, v203, v75, s[98:99]
    v_cvt_pk_bf16_f32 v72, v200, v201
    v_cvt_pk_bf16_f32 v73, v202, v203
    v_cndmask_b32 v72, v72, v13, s[100:101]
    v_cndmask_b32 v73, v73, v13, s[100:101]
    v_cvt_pk_bf16_f32 v64, v64, v65
    v_cvt_pk_bf16_f32 v65, v66, v67
    v_cvt_pk_bf16_f32 v68, v68, v69
    v_cvt_pk_bf16_f32 v69, v70, v71
    v_pk_fma_f32 v[200:201], v[76:77], s[40:41], v[250:251]
    v_pk_fma_f32 v[202:203], v[78:79], s[40:41], v[250:251]
    v_exp_f32_e64 v200, v200 clamp
    v_exp_f32_e64 v201, v201 clamp
    v_exp_f32_e64 v202, v202 clamp
    v_exp_f32_e64 v203, v203 clamp
    v_pk_add_f32 v[200:201], v[200:201], v[252:253]
    v_pk_add_f32 v[202:203], v[202:203], v[252:253]
    v_max_f32 v200, v200, v76
    v_max_f32 v201, v201, v77
    v_max_f32 v202, v202, v78
    v_max_f32 v203, v203, v79
    v_cvt_pk_bf16_f32 v58, v200, v201
    v_cvt_pk_bf16_f32 v59, v202, v203
    v_pk_fma_f32 v[204:205], v[80:81], s[40:41], v[250:251]
    v_pk_fma_f32 v[206:207], v[82:83], s[40:41], v[250:251]
    v_exp_f32_e64 v204, v204 clamp
    v_exp_f32_e64 v205, v205 clamp
    v_exp_f32_e64 v206, v206 clamp
    v_exp_f32_e64 v207, v207 clamp
    v_pk_add_f32 v[204:205], v[204:205], v[252:253]
    v_pk_add_f32 v[206:207], v[206:207], v[252:253]
    v_max_f32 v204, v204, v80
    v_max_f32 v205, v205, v81
    v_max_f32 v206, v206, v82
    v_max_f32 v207, v207, v83
    v_cvt_pk_bf16_f32 v62, v204, v205
    v_cvt_pk_bf16_f32 v63, v206, v207
    v_pk_fma_f32 v[200:201], v[92:93], s[40:41], v[250:251]
    v_pk_fma_f32 v[202:203], v[94:95], s[40:41], v[250:251]
    v_exp_f32_e64 v200, v200 clamp
    v_exp_f32_e64 v201, v201 clamp
    v_exp_f32_e64 v202, v202 clamp
    v_exp_f32_e64 v203, v203 clamp
    v_pk_add_f32 v[200:201], v[200:201], v[252:253]
    v_pk_add_f32 v[202:203], v[202:203], v[252:253]
    v_max_f32 v200, v200, v92
    v_max_f32 v201, v201, v93
    v_max_f32 v202, v202, v94
    v_max_f32 v203, v203, v95
    v_cndmask_b32 v200, v200, v92, s[98:99]
    v_cndmask_b32 v201, v201, v93, s[98:99]
    v_cndmask_b32 v202, v202, v94, s[98:99]
    v_cndmask_b32 v203, v203, v95, s[98:99]
    v_cvt_pk_bf16_f32 v74, v200, v201
    v_cvt_pk_bf16_f32 v75, v202, v203
    v_cndmask_b32 v74, v74, v13, s[100:101]
    v_cndmask_b32 v75, v75, v13, s[100:101]
    v_cvt_pk_bf16_f32 v66, v84, v85
    v_cvt_pk_bf16_f32 v67, v86, v87
    v_cvt_pk_bf16_f32 v70, v88, v89
    v_cvt_pk_bf16_f32 v71, v90, v91
    v_mfma_f32_16x16x32_bf16 v[208:211], v[64:67], v[56:59], v[208:211]
    s_nop 0
    v_mfma_f32_16x16x32_bf16 v[212:215], v[68:71], v[60:63], v[212:215]
    v_mfma_f32_16x16x32_bf16 v[216:219], v[64:67], v[72:75], v[216:219]
    v_mfma_f32_16x16x32_bf16 v[220:223], v[68:71], v[72:75], v[220:223]
    v_mfma_f32_16x16x32_bf16 v[224:227], v[72:75], v[56:59], v[224:227]
    v_mfma_f32_16x16x32_bf16 v[228:231], v[72:75], v[60:63], v[228:231]
    v_mfma_f32_16x16x32_bf16 v[232:235], v[72:75], v[72:75], v[232:235]
    s_nop 4
    v_cndmask_b32 v216, v220, v216, s[46:47]
    v_cndmask_b32 v217, v221, v217, s[46:47]
    v_cndmask_b32 v218, v222, v218, s[46:47]
    v_cndmask_b32 v219, v223, v219, s[46:47]
    v_mov_b64 v[226:227], v[230:231]
    v_cndmask_b32 v232, v234, v232, s[46:47]
    v_cndmask_b32 v233, v235, v233, s[46:47]
    s_cmp_eq_u32 s35, 1
    s_cbranch_scc1 L_kv_rx1
    ds_write_b128 v248, v[212:215]
    ds_write_b128 v248, v[224:227] offset:1024
    ds_write2_b32 v14, v233, v14 offset0:0 offset1:1
    s_mov_b32 s3, 0
L_kv_rp0:
    ds_read_b64 v[200:201], v15
    ds_read_b128 v[16:19], v249
    ds_read_b128 v[20:23], v249 offset:1024
    s_add_u32 s3, s3, 1
    s_waitcnt lgkmcnt(0)
    v_cmp_eq_u32 vcc, 0, v201
    s_cmp_ge_u32 s3, 0x100000
    s_cbranch_scc1 L_kv_rq0
    s_cbranch_vccnz L_kv_rp0
L_kv_rq0:
    v_pk_add_f32 v[208:209], v[208:209], v[16:17]
    v_pk_add_f32 v[210:211], v[210:211], v[18:19]
    v_pk_add_f32 v[216:217], v[216:217], v[20:21]
    v_pk_add_f32 v[218:219], v[218:219], v[22:23]
    v_add_f32 v232, v232, v200
    buffer_atomic_add_f32 v208, v236, s[56:59], s51 offen offset:0
    buffer_atomic_add_f32 v209, v236, s[56:59], s51 offen offset:64
    buffer_atomic_add_f32 v210, v236, s[56:59], s51 offen offset:128
    buffer_atomic_add_f32 v211, v236, s[56:59], s51 offen offset:192
    buffer_atomic_add_f32 v216, v237, s[56:59], s51 offen offset:2048
    buffer_atomic_add_f32 v217, v237, s[56:59], s51 offen offset:2112
    buffer_atomic_add_f32 v218, v237, s[56:59], s51 offen offset:2176
    buffer_atomic_add_f32 v219, v237, s[56:59], s51 offen offset:2240
    buffer_atomic_add_f32 v232, v241, s[56:59], s51 offen offset:2688
    s_branch L_kv_rxd
L_kv_rx1:
    ds_write_b128 v248, v[208:211]
    ds_write_b128 v248, v[216:219] offset:1024
    ds_write2_b32 v14, v232, v14 offset0:0 offset1:1
    s_mov_b32 s3, 0
L_kv_rp1:
    ds_read_b64 v[200:201], v15
    ds_read_b128 v[16:19], v249
    ds_read_b128 v[20:23], v249 offset:1024
    s_add_u32 s3, s3, 1
    s_waitcnt lgkmcnt(0)
    v_cmp_eq_u32 vcc, 0, v201
    s_cmp_ge_u32 s3, 0x100000
    s_cbranch_scc1 L_kv_rq1
    s_cbranch_vccnz L_kv_rp1
L_kv_rq1:
    v_pk_add_f32 v[212:213], v[212:213], v[16:17]
    v_pk_add_f32 v[214:215], v[214:215], v[18:19]
    v_pk_add_f32 v[224:225], v[224:225], v[20:21]
    v_pk_add_f32 v[226:227], v[226:227], v[22:23]
    v_add_f32 v233, v233, v200
    buffer_atomic_add_f32 v212, v236, s[56:59], s51 offen offset:1024
    buffer_atomic_add_f32 v213, v236, s[56:59], s51 offen offset:1088
    buffer_atomic_add_f32 v214, v236, s[56:59], s51 offen offset:1152
    buffer_atomic_add_f32 v215, v236, s[56:59], s51 offen offset:1216
    buffer_atomic_add_f32 v224, v238, s[56:59], s51 offen offset:2304
    buffer_atomic_add_f32 v225, v240, s[56:59], s51 offen offset:2496
    buffer_atomic_add_f32 v226, v239, s[56:59], s51 offen offset:2304
    buffer_atomic_add_f32 v227, v240, s[56:59], s51 offen offset:2624
    buffer_atomic_add_f32 v233, v242, s[56:59], s51 offen offset:2704
L_kv_rxd:
    s_barrier
    v_mov_b64 v[106:107], v[244:245]
    v_mov_b64 v[108:109], v[246:247]
    s_mov_b32 s33, s97
    s_lshl_b32 s34, s42, 2
    s_add_u32 s32, s96, s34
    s_and_b32 s36, s31, 1
    s_lshr_b32 s35, s31, 1
    s_xor_b32 s35, s35, 2
    v_mov_b32 v8, 0x7ffffff0
    v_lshlrev_b32 v9, 4, v1
    s_add_u32 s40, s31, s43
    s_and_b32 s40, s40, 7
    s_and_b32 s41, s33, 3
    s_mul_i32 s37, s40, 5632
    v_and_b32 v6, 3, v2
    v_bfe_u32 v7, v2, 2, 1
    v_lshl_add_u32 v7, v7, 1, v6
    v_cmp_gt_u32 vcc, 2, v6
    s_nop 1
    v_cndmask_b32 v7, v7, v6, vcc
    v_lshlrev_b32 v12, 4, v3
    v_lshl_add_u32 v12, v7, 6, v12
    v_cmp_gt_u32 s[44:45], 8, v2
    s_nop 0
    s_or_b64 s[96:97], s[44:45], vcc
    s_orn2_b64 vcc, vcc, s[44:45]
    v_cndmask_b32 v13, v8, v12, vcc
    v_cndmask_b32 v12, v8, v12, s[96:97]
    v_lshlrev_b32 v10, 4, v2
    v_lshlrev_b32 v11, 4, v7
    v_add_u32 v11, 640, v11
    v_cmp_lt_u32 s[100:101], 1, v3
    s_nop 1
    v_cndmask_b32 v10, v10, v11, s[100:101]
    v_and_b32 v6, 1, v3
    v_mul_u32_u24 v11, 2816, v6
    v_add_u32 v10, v10, v11
    v_cmp_eq_u32 s[98:99], 1, v6
    v_cmp_eq_u32 s[44:45], 1, v7
    v_cmp_lt_u32 s[46:47], 3, v7
    s_nop 0
    s_or_b64 s[44:45], s[44:45], s[46:47]
    s_andn2_b64 s[46:47], s[100:101], s[98:99]
    s_and_b64 s[46:47], s[46:47], s[96:97]
    s_and_b64 s[96:97], s[100:101], s[98:99]
    s_and_b64 s[96:97], s[96:97], vcc
    v_lshlrev_b32 v7, 3, v2
    v_lshl_add_u32 v7, v6, 7, v7
    s_lshl_b32 s38, s32, 6
    s_lshl_b32 s39, s40, 1
    s_add_u32 s38, s38, s39
    s_lshl_b32 s39, s38, 7
    s_add_u32 s39, s39, 3145728
    s_lshl_b32 s38, s38, 10
    s_add_u32 s38, s38, 1048576
    v_mov_b32 v4, 163776
    v_mov_b32 v5, 1
    s_waitcnt vmcnt(0)
    s_mov_b64 exec, 1
    ds_add_rtn_u32 v6, v4, v5
    s_mov_b64 exec, -1
    s_waitcnt lgkmcnt(0)
    v_readfirstlane_b32 s3, v6
    s_nop 0
    s_cmp_lg_u32 s3, 3
    s_cbranch_scc1 L_kv_sig
    s_mov_b64 exec, 255
    buffer_atomic_add v5, v243, s[56:59], s50 offen
    s_mov_b64 exec, -1
L_kv_sig:
    s_branch L_bjoin
L_notkv:
    s_mov_b32 s39, s2
    s_sub_u32 s35, s2, 179
    s_cmp_lt_u32 s35, 2
    s_cselect_b32 s36, 74, 0
    s_add_u32 s39, s39, s36
    s_sub_u32 s35, s2, 253
    s_cmp_lt_u32 s35, 2
    s_cselect_b32 s36, 74, 0
    s_sub_u32 s39, s39, s36
    s_and_b32 s42, s39, 7
    s_lshr_b32 s43, s39, 3
    s_add_u32 s35, s42, 15
    s_cmp_gt_u32 s39, 248
    s_cselect_b32 s36, s35, s43
    s_cselect_b32 s37, 0, s42
    s_sub_u32 s35, s43, 16
    s_cmp_lt_u32 s35, 7
    s_cselect_b32 s38, s42, 1
    s_add_u32 s35, s35, 1
    s_cmp_eq_u32 s38, 0
    s_cselect_b32 s43, 31, s36
    s_cselect_b32 s42, s35, s37
    s_and_b32 s34, s42, 3
    s_cmp_ge_u32 s43, 23
    s_cbranch_scc1 L_rolea
    s_mul_i32 s35, s34, 107
    s_add_u32 s36, s35, 107
    s_lshr_b32 s35, s35, 4
    s_lshr_b32 s36, s36, 4
    s_add_u32 s35, s35, s43
    s_sub_u32 s35, s35, 16
    s_cmp_ge_u32 s35, s36
    s_cbranch_scc1 L_spare
    s_lshr_b32 s33, s35, 1
    s_and_b32 s36, s35, 1
    s_lshr_b32 s32, s42, 1
    s_and_b32 s32, s32, 2
    s_add_u32 s32, s32, s36
    s_and_b32 s94, s43, 6
    s_cmp_lt_u32 s31, 4
    s_cbranch_scc1 L_q_comp
    s_sub_u32 s35, s31, 4
    s_and_b32 s37, s35, 1
    s_mul_i32 s34, s33, 160
    s_mul_i32 s36, s35, 40
    s_add_u32 s36, s36, s34
    v_lshrrev_b32 v4, 3, v1
    v_add_u32 v4, s36, v4
    v_mul_u32_u24 v4, 1152, v4
    v_and_b32 v5, 7, v1
    v_xor_b32 v5, v5, v3
    s_lshl_b32 s36, s37, 2
    v_xor_b32 v5, s36, v5
    v_lshl_add_u32 v10, v5, 4, v4
    v_xor_b32 v5, 4, v5
    v_lshl_add_u32 v11, v5, 4, v4
    s_mul_i32 s38, s35, 5120
    s_lshr_b32 s36, s35, 1
    s_lshl_b32 s36, s36, 3
    s_add_u32 s36, s36, s37
    s_mul_i32 s36, s36, 13824
    s_mul_i32 s39, s32, 288
    s_add_u32 s36, s36, s39
    s_mul_i32 s39, s35, 4608
    s_mov_b32 s50, 1990656
    s_mov_b32 s51, 0x20000
    s_mov_b32 s46, 2359296
    s_mov_b32 s47, 0x20000
    s_movk_i32 s34, 1152
    v_mul_u32_u24 v5, 3641, v1
    v_lshrrev_b32 v5, 16, v5
    v_lshl_add_u32 v6, v1, 4, s36
    v_mul_u32_u24 v7, 3168, v5
    v_lshrrev_b32 v5, 2, v5
    v_mul_u32_u24 v5, 13824, v5
    v_add3_u32 v13, v5, v6, v7
    v_add_u32 v4, 64, v1
    v_mul_u32_u24 v5, 3641, v4
    v_lshrrev_b32 v5, 16, v5
    v_lshl_add_u32 v6, v4, 4, s36
    v_mul_u32_u24 v7, 3168, v5
    v_lshrrev_b32 v5, 2, v5
    v_mul_u32_u24 v5, 13824, v5
    v_add3_u32 v14, v5, v6, v7
    s_waitcnt lgkmcnt(0)
    s_mov_b64 s[48:49], s[20:21]
    s_mov_b64 s[44:45], s[18:19]
    s_lshl_b32 s30, s94, 7
    s_add_u32 m0, s38, 0
    s_add_u32 s3, s30, 0
    buffer_load_dwordx4 v10, s[44:47], s3 offen lds
    s_add_u32 m0, s38, 1024
    s_add_u32 s3, s30, 9216
    buffer_load_dwordx4 v11, s[44:47], s3 offen lds
    s_add_u32 m0, s38, 2048
    s_add_u32 s3, s30, 18432
    buffer_load_dwordx4 v10, s[44:47], s3 offen lds
    s_add_u32 m0, s38, 3072
    s_add_u32 s3, s30, 27648
    buffer_load_dwordx4 v11, s[44:47], s3 offen lds
    s_add_u32 m0, s38, 4096
    s_add_u32 s3, s30, 36864
    buffer_load_dwordx4 v10, s[44:47], s3 offen lds
    s_mul_i32 s30, s94, 221184
    s_add_u32 s94, s94, 1
    s_and_b32 s94, s94, 7
    s_add_u32 m0, s39, 20480
    s_nop 0
    buffer_load_dwordx4 v13, s[48:51], s30 offen lds
    s_add_u32 m0, s39, 21504
    s_nop 0
    buffer_load_dwordx4 v14, s[48:51], s30 offen lds
    v_add_u32 v4, 128, v1
    v_mul_u32_u24 v5, 3641, v4
    v_lshrrev_b32 v5, 16, v5
    v_lshl_add_u32 v6, v4, 4, s36
    v_mul_u32_u24 v7, 3168, v5
    v_lshrrev_b32 v5, 2, v5
    v_mul_u32_u24 v5, 13824, v5
    v_add3_u32 v15, v5, v6, v7
    s_add_u32 m0, s39, 22528
    s_nop 0
    buffer_load_dwordx4 v15, s[48:51], s30 offen lds
    v_add_u32 v4, 192, v1
    v_mul_u32_u24 v5, 3641, v4
    v_lshrrev_b32 v5, 16, v5
    v_lshl_add_u32 v6, v4, 4, s36
    v_mul_u32_u24 v7, 3168, v5
    v_lshrrev_b32 v5, 2, v5
    v_mul_u32_u24 v5, 13824, v5
    v_add3_u32 v16, v5, v6, v7
    s_add_u32 m0, s39, 23552
    s_nop 0
    buffer_load_dwordx4 v16, s[48:51], s30 offen lds
    v_add_u32 v4, 256, v1
    v_mul_u32_u24 v5, 3641, v4
    v_lshrrev_b32 v5, 16, v5
    v_lshl_add_u32 v6, v4, 4, s36
    v_mul_u32_u24 v7, 3168, v5
    v_lshrrev_b32 v5, 2, v5
    v_mul_u32_u24 v5, 13824, v5
    v_add3_u32 v17, v5, v6, v7
    s_mov_b32 exec_hi, 0
    s_add_u32 m0, s39, 24576
    s_nop 0
    buffer_load_dwordx4 v17, s[48:51], s30 offen lds
    s_mov_b32 exec_hi, -1
    s_lshl_b32 s30, s94, 7
    s_add_u32 m0, s38, 38912
    s_add_u32 s3, s30, 0
    buffer_load_dwordx4 v10, s[44:47], s3 offen lds
    s_add_u32 m0, s38, 39936
    s_add_u32 s3, s30, 9216
    buffer_load_dwordx4 v11, s[44:47], s3 offen lds
    s_add_u32 m0, s38, 40960
    s_add_u32 s3, s30, 18432
    buffer_load_dwordx4 v10, s[44:47], s3 offen lds
    s_add_u32 m0, s38, 41984
    s_add_u32 s3, s30, 27648
    buffer_load_dwordx4 v11, s[44:47], s3 offen lds
    s_add_u32 m0, s38, 43008
    s_add_u32 s3, s30, 36864
    buffer_load_dwordx4 v10, s[44:47], s3 offen lds
    s_mul_i32 s30, s94, 221184
    s_add_u32 s94, s94, 1
    s_and_b32 s94, s94, 7
    s_add_u32 m0, s39, 59392
    s_nop 0
    buffer_load_dwordx4 v13, s[48:51], s30 offen lds
    s_add_u32 m0, s39, 60416
    s_nop 0
    buffer_load_dwordx4 v14, s[48:51], s30 offen lds
    s_add_u32 m0, s39, 61440
    s_nop 0
    buffer_load_dwordx4 v15, s[48:51], s30 offen lds
    s_add_u32 m0, s39, 62464
    s_nop 0
    buffer_load_dwordx4 v16, s[48:51], s30 offen lds
    s_mov_b32 exec_hi, 0
    s_add_u32 m0, s39, 63488
    s_nop 0
    buffer_load_dwordx4 v17, s[48:51], s30 offen lds
    s_mov_b32 exec_hi, -1
    s_mov_b32 s56, s28
    s_mov_b32 s57, s29
    s_mov_b32 s58, 4194304
    s_mov_b32 s59, 0x20000
    s_mov_b32 s60, s26
    s_mov_b32 s61, s27
    s_mov_b32 s62, 256
    s_mov_b32 s63, 0x20000
    s_mov_b32 s52, s22
    s_mov_b32 s53, s23
    s_mov_b32 s54, 663552
    s_mov_b32 s55, 0x20000
    s_lshr_b32 s96, s43, 2
    s_and_b32 s97, s43, 3
    s_cmp_ge_u32 s43, 16
    s_cselect_b32 s96, s97, s96
    s_cselect_b32 s97, 4, s97
    s_and_b32 s30, s31, 1
    s_lshl_b32 s3, s30, 3
    v_lshl_add_u32 v23, v3, 1, s3
    v_xor_b32 v23, v23, v2
    s_lshl_b32 s3, s97, 8
    v_lshl_add_u32 v23, v23, 4, s3
    v_mov_b32 v21, 0x40000000
    v_cmp_gt_u32 vcc, 1152, v23
    s_nop 1
    v_cndmask_b32 v23, v21, v23, vcc
    s_and_b32 s3, s31, 3
    s_lshl_b32 s95, s3, 10
    v_lshl_add_u32 v21, v3, 2, s3
    v_mul_u32_u24 v21, 1152, v21
    v_add_u32 v21, v21, v23
    s_mul_i32 s3, s3, 18
    s_lshl_b32 s30, s30, 4
    s_sub_u32 s3, s3, s30
    s_add_u32 s3, s3, 16
    v_lshrrev_b32 v22, 1, v3
    v_mul_u32_u24 v22, 70, v22
    v_add3_u32 v22, v22, v3, s3
    v_mul_u32_u24 v22, 1152, v22
    v_add_u32 v22, v22, v23
    v_lshrrev_b32 v106, 2, v2
    v_lshl_add_u32 v106, v3, 2, v106
    v_and_b32 v107, 7, v106
    v_lshlrev_b32 v107, 1, v107
    v_bfe_u32 v108, v2, 1, 1
    s_lshr_b32 s3, s31, 1
    s_xor_b32 s3, s3, 2
    s_lshl_b32 s3, s3, 2
    v_add_u32 v108, s3, v108
    v_xor_b32 v107, v107, v108
    v_lshlrev_b32 v106, 8, v106
    v_lshl_add_u32 v106, v107, 4, v106
    v_and_b32 v107, 1, v2
    v_lshl_add_u32 v106, v107, 3, v106
    v_xor_b32 v107, 32, v106
    v_add_u32 v108, 0x10000, v106
    v_add_u32 v109, 0x10000, v107
    v_mov_b32 v4, 0
    s_waitcnt vmcnt(10)
    s_barrier
    s_lshl_b32 s30, s94, 7
    s_add_u32 m0, s38, 77824
    s_add_u32 s3, s30, 0
    buffer_load_dwordx4 v10, s[44:47], s3 offen lds
    s_add_u32 m0, s38, 78848
    s_add_u32 s3, s30, 9216
    buffer_load_dwordx4 v11, s[44:47], s3 offen lds
    s_add_u32 m0, s38, 79872
    s_add_u32 s3, s30, 18432
    buffer_load_dwordx4 v10, s[44:47], s3 offen lds
    s_add_u32 m0, s38, 80896
    s_add_u32 s3, s30, 27648
    buffer_load_dwordx4 v11, s[44:47], s3 offen lds
    s_add_u32 m0, s38, 81920
    s_add_u32 s3, s30, 36864
    buffer_load_dwordx4 v10, s[44:47], s3 offen lds
    s_mul_i32 s30, s94, 221184
    s_add_u32 s94, s94, 1
    s_and_b32 s94, s94, 7
    s_add_u32 m0, s39, 98304
    s_nop 0
    buffer_load_dwordx4 v13, s[48:51], s30 offen lds
    s_add_u32 m0, s39, 99328
    s_nop 0
    buffer_load_dwordx4 v14, s[48:51], s30 offen lds
    s_add_u32 m0, s39, 100352
    s_nop 0
    buffer_load_dwordx4 v15, s[48:51], s30 offen lds
    s_add_u32 m0, s39, 101376
    s_nop 0
    buffer_load_dwordx4 v16, s[48:51], s30 offen lds
    s_mov_b32 exec_hi, 0
    s_add_u32 m0, s39, 102400
    s_nop 0
    buffer_load_dwordx4 v17, s[48:51], s30 offen lds
    s_mov_b32 exec_hi, -1
    s_waitcnt vmcnt(10)
    s_barrier
    s_lshl_b32 s30, s94, 7
    s_add_u32 m0, s38, 116736
    s_add_u32 s3, s30, 0
    buffer_load_dwordx4 v10, s[44:47], s3 offen lds
    s_add_u32 m0, s38, 117760
    s_add_u32 s3, s30, 9216
    buffer_load_dwordx4 v11, s[44:47], s3 offen lds
    s_add_u32 m0, s38, 118784
    s_add_u32 s3, s30, 18432
    buffer_load_dwordx4 v10, s[44:47], s3 offen lds
    s_add_u32 m0, s38, 119808
    s_add_u32 s3, s30, 27648
    buffer_load_dwordx4 v11, s[44:47], s3 offen lds
    s_add_u32 m0, s38, 120832
    s_add_u32 s3, s30, 36864
    buffer_load_dwordx4 v10, s[44:47], s3 offen lds
    s_mul_i32 s30, s94, 221184
    s_add_u32 s94, s94, 1
    s_and_b32 s94, s94, 7
    s_add_u32 m0, s39, 137216
    s_nop 0
    buffer_load_dwordx4 v13, s[48:51], s30 offen lds
    s_add_u32 m0, s39, 138240
    s_nop 0
    buffer_load_dwordx4 v14, s[48:51], s30 offen lds
    s_add_u32 m0, s39, 139264
    s_nop 0
    buffer_load_dwordx4 v15, s[48:51], s30 offen lds
    s_add_u32 m0, s39, 140288
    s_nop 0
    buffer_load_dwordx4 v16, s[48:51], s30 offen lds
    s_mov_b32 exec_hi, 0
    s_add_u32 m0, s39, 141312
    s_nop 0
    buffer_load_dwordx4 v17, s[48:51], s30 offen lds
    s_mov_b32 exec_hi, -1
    s_waitcnt vmcnt(10)
    s_barrier
    s_lshl_b32 s30, s94, 7
    s_add_u32 m0, s38, 0
    s_add_u32 s3, s30, 0
    buffer_load_dwordx4 v10, s[44:47], s3 offen lds
    s_add_u32 m0, s38, 1024
    s_add_u32 s3, s30, 9216
    buffer_load_dwordx4 v11, s[44:47], s3 offen lds
    s_add_u32 m0, s38, 2048
    s_add_u32 s3, s30, 18432
    buffer_load_dwordx4 v10, s[44:47], s3 offen lds
    s_add_u32 m0, s38, 3072
    s_add_u32 s3, s30, 27648
    buffer_load_dwordx4 v11, s[44:47], s3 offen lds
    s_add_u32 m0, s38, 4096
    s_add_u32 s3, s30, 36864
    buffer_load_dwordx4 v10, s[44:47], s3 offen lds
    s_mul_i32 s30, s94, 221184
    s_add_u32 s94, s94, 1
    s_and_b32 s94, s94, 7
    s_add_u32 m0, s39, 20480
    s_nop 0
    buffer_load_dwordx4 v13, s[48:51], s30 offen lds
    s_add_u32 m0, s39, 21504
    s_nop 0
    buffer_load_dwordx4 v14, s[48:51], s30 offen lds
    s_add_u32 m0, s39, 22528
    s_nop 0
    buffer_load_dwordx4 v15, s[48:51], s30 offen lds
    s_add_u32 m0, s39, 23552
    s_nop 0
    buffer_load_dwordx4 v16, s[48:51], s30 offen lds
    s_mov_b32 exec_hi, 0
    s_add_u32 m0, s39, 24576
    s_nop 0
    buffer_load_dwordx4 v17, s[48:51], s30 offen lds
    s_mov_b32 exec_hi, -1
    s_waitcnt vmcnt(10)
    s_barrier
    s_lshl_b32 s30, s94, 7
    s_add_u32 m0, s38, 38912
    s_add_u32 s3, s30, 0
    buffer_load_dwordx4 v10, s[44:47], s3 offen lds
    s_add_u32 m0, s38, 39936
    s_add_u32 s3, s30, 9216
    buffer_load_dwordx4 v11, s[44:47], s3 offen lds
    s_add_u32 m0, s38, 40960
    s_add_u32 s3, s30, 18432
    buffer_load_dwordx4 v10, s[44:47], s3 offen lds
    s_add_u32 m0, s38, 41984
    s_add_u32 s3, s30, 27648
    buffer_load_dwordx4 v11, s[44:47], s3 offen lds
    s_add_u32 m0, s38, 43008
    s_add_u32 s3, s30, 36864
    buffer_load_dwordx4 v10, s[44:47], s3 offen lds
    s_mul_i32 s30, s94, 221184
    s_add_u32 s94, s94, 1
    s_and_b32 s94, s94, 7
    s_add_u32 m0, s39, 59392
    s_nop 0
    buffer_load_dwordx4 v13, s[48:51], s30 offen lds
    s_add_u32 m0, s39, 60416
    s_nop 0
    buffer_load_dwordx4 v14, s[48:51], s30 offen lds
    s_add_u32 m0, s39, 61440
    s_nop 0
    buffer_load_dwordx4 v15, s[48:51], s30 offen lds
    s_add_u32 m0, s39, 62464
    s_nop 0
    buffer_load_dwordx4 v16, s[48:51], s30 offen lds
    s_mov_b32 exec_hi, 0
    s_add_u32 m0, s39, 63488
    s_nop 0
    buffer_load_dwordx4 v17, s[48:51], s30 offen lds
    s_mov_b32 exec_hi, -1
    s_waitcnt vmcnt(10)
    s_barrier
    s_lshl_b32 s30, s94, 7
    s_add_u32 m0, s38, 77824
    s_add_u32 s3, s30, 0
    buffer_load_dwordx4 v10, s[44:47], s3 offen lds
    s_add_u32 m0, s38, 78848
    s_add_u32 s3, s30, 9216
    buffer_load_dwordx4 v11, s[44:47], s3 offen lds
    s_add_u32 m0, s38, 79872
    s_add_u32 s3, s30, 18432
    buffer_load_dwordx4 v10, s[44:47], s3 offen lds
    s_add_u32 m0, s38, 80896
    s_add_u32 s3, s30, 27648
    buffer_load_dwordx4 v11, s[44:47], s3 offen lds
    s_add_u32 m0, s38, 81920
    s_add_u32 s3, s30, 36864
    buffer_load_dwordx4 v10, s[44:47], s3 offen lds
    s_mul_i32 s30, s94, 221184
    s_add_u32 s94, s94, 1
    s_and_b32 s94, s94, 7
    s_add_u32 m0, s39, 98304
    s_nop 0
    buffer_load_dwordx4 v13, s[48:51], s30 offen lds
    s_add_u32 m0, s39, 99328
    s_nop 0
    buffer_load_dwordx4 v14, s[48:51], s30 offen lds
    s_add_u32 m0, s39, 100352
    s_nop 0
    buffer_load_dwordx4 v15, s[48:51], s30 offen lds
    s_add_u32 m0, s39, 101376
    s_nop 0
    buffer_load_dwordx4 v16, s[48:51], s30 offen lds
    s_mov_b32 exec_hi, 0
    s_add_u32 m0, s39, 102400
    s_nop 0
    buffer_load_dwordx4 v17, s[48:51], s30 offen lds
    s_mov_b32 exec_hi, -1
    s_waitcnt vmcnt(10)
    s_barrier
    buffer_load_dword v24, v4, s[60:63], 0 offen sc1
    s_lshl_b32 s30, s94, 7
    s_add_u32 m0, s38, 116736
    s_add_u32 s3, s30, 0
    buffer_load_dwordx4 v10, s[44:47], s3 offen lds
    s_add_u32 m0, s38, 117760
    s_add_u32 s3, s30, 9216
    buffer_load_dwordx4 v11, s[44:47], s3 offen lds
    s_add_u32 m0, s38, 118784
    s_add_u32 s3, s30, 18432
    buffer_load_dwordx4 v10, s[44:47], s3 offen lds
    s_add_u32 m0, s38, 119808
    s_add_u32 s3, s30, 27648
    buffer_load_dwordx4 v11, s[44:47], s3 offen lds
    s_add_u32 m0, s38, 120832
    s_add_u32 s3, s30, 36864
    buffer_load_dwordx4 v10, s[44:47], s3 offen lds
    s_mul_i32 s30, s94, 221184
    s_mov_b32 s94, 8
    s_add_u32 m0, s39, 137216
    s_nop 0
    buffer_load_dwordx4 v13, s[48:51], s30 offen lds
    s_add_u32 m0, s39, 138240
    s_nop 0
    buffer_load_dwordx4 v14, s[48:51], s30 offen lds
    s_add_u32 m0, s39, 139264
    s_nop 0
    buffer_load_dwordx4 v15, s[48:51], s30 offen lds
    s_add_u32 m0, s39, 140288
    s_nop 0
    buffer_load_dwordx4 v16, s[48:51], s30 offen lds
    s_mov_b32 exec_hi, 0
    s_add_u32 m0, s39, 141312
    s_nop 0
    buffer_load_dwordx4 v17, s[48:51], s30 offen lds
    s_mov_b32 exec_hi, -1
    s_waitcnt vmcnt(11)
    s_barrier
    s_lshl_b32 s30, s94, 7
    s_add_u32 m0, s38, 0
    s_add_u32 s3, s30, 0
    buffer_load_dwordx4 v10, s[44:47], s3 offen lds
    s_add_u32 m0, s38, 1024
    s_add_u32 s3, s30, 9216
    buffer_load_dwordx4 v11, s[44:47], s3 offen lds
    s_add_u32 m0, s38, 2048
    s_add_u32 s3, s30, 18432
    buffer_load_dwordx4 v10, s[44:47], s3 offen lds
    s_add_u32 m0, s38, 3072
    s_add_u32 s3, s30, 27648
    buffer_load_dwordx4 v11, s[44:47], s3 offen lds
    s_add_u32 m0, s38, 4096
    s_add_u32 s3, s30, 36864
    buffer_load_dwordx4 v10, s[44:47], s3 offen lds
    s_mul_i32 s30, s94, 221184
    s_add_u32 s94, s94, 1
    s_and_b32 s94, s94, 7
    s_add_u32 m0, s39, 20480
    s_nop 0
    buffer_load_dwordx4 v13, s[48:51], s30 offen lds
    s_add_u32 m0, s39, 21504
    s_nop 0
    buffer_load_dwordx4 v14, s[48:51], s30 offen lds
    s_add_u32 m0, s39, 22528
    s_nop 0
    buffer_load_dwordx4 v15, s[48:51], s30 offen lds
    s_add_u32 m0, s39, 23552
    s_nop 0
    buffer_load_dwordx4 v16, s[48:51], s30 offen lds
    s_mov_b32 exec_hi, 0
    s_add_u32 m0, s39, 24576
    s_nop 0
    buffer_load_dwordx4 v17, s[48:51], s30 offen lds
    s_mov_b32 exec_hi, -1
    s_waitcnt vmcnt(10)
    s_barrier
    s_add_u32 m0, s95, 40960
    s_mov_b32 s3, 207360
    buffer_load_dwordx4 v21, s[52:55], s3 offen lds
    s_add_u32 m0, s95, 45056
    s_mov_b32 s3, 230400
    buffer_load_dwordx4 v21, s[52:55], s3 offen lds
    s_add_u32 m0, s95, 49152
    s_mov_b32 s3, 248832
    buffer_load_dwordx4 v21, s[52:55], s3 offen lds
    s_add_u32 m0, s95, 53248
    s_mov_b32 s3, 271872
    buffer_load_dwordx4 v21, s[52:55], s3 offen lds
    s_add_u32 m0, s95, 57344
    s_mov_b32 s3, 290304
    buffer_load_dwordx4 v21, s[52:55], s3 offen lds
    s_add_u32 m0, s95, 61440
    s_mov_b32 s3, 313344
    buffer_load_dwordx4 v21, s[52:55], s3 offen lds
    s_add_u32 m0, s95, 65536
    s_mov_b32 s3, 331776
    buffer_load_dwordx4 v21, s[52:55], s3 offen lds
    s_add_u32 m0, s95, 69632
    s_mov_b32 s3, 354816
    buffer_load_dwordx4 v21, s[52:55], s3 offen lds
    s_waitcnt vmcnt(8)
    s_barrier
    s_add_u32 m0, s95, 73728
    s_mov_b32 s3, 373248
    buffer_load_dwordx4 v21, s[52:55], s3 offen lds
    s_add_u32 m0, s95, 77824
    s_mov_b32 s3, 396288
    buffer_load_dwordx4 v21, s[52:55], s3 offen lds
    s_add_u32 m0, s95, 81920
    s_mov_b32 s3, 414720
    buffer_load_dwordx4 v21, s[52:55], s3 offen lds
    s_add_u32 m0, s95, 86016
    s_mov_b32 s3, 437760
    buffer_load_dwordx4 v21, s[52:55], s3 offen lds
    v_readfirstlane_b32 s37, v24
    s_mov_b32 s36, 0
    s_cmp_lg_u32 s37, 0
    s_cbranch_scc1 L_q_rdy2
L_q_rdy:
    buffer_load_dword v5, v4, s[60:63], 0 offen sc1
    s_add_u32 s36, s36, 1
    s_waitcnt vmcnt(0)
    v_readfirstlane_b32 s37, v5
    s_cmp_ge_u32 s36, 0x10000
    s_cbranch_scc1 L_q_rdy2
    s_cmp_eq_u32 s37, 0
    s_cbranch_scc1 L_q_rdy
L_q_rdy2:
    s_barrier
    s_add_u32 m0, s95, 90112
    s_mov_b32 s3, 456192
    buffer_load_dwordx4 v21, s[52:55], s3 offen lds
    s_add_u32 m0, s95, 94208
    s_mov_b32 s3, 479232
    buffer_load_dwordx4 v21, s[52:55], s3 offen lds
    s_add_u32 m0, s95, 98304
    s_mov_b32 s3, 497664
    buffer_load_dwordx4 v21, s[52:55], s3 offen lds
    s_add_u32 m0, s95, 102400
    s_mov_b32 s3, 520704
    buffer_load_dwordx4 v21, s[52:55], s3 offen lds
    s_add_u32 m0, s95, 106496
    s_mov_b32 s3, 539136
    buffer_load_dwordx4 v21, s[52:55], s3 offen lds
    s_add_u32 m0, s95, 110592
    s_mov_b32 s3, 562176
    buffer_load_dwordx4 v21, s[52:55], s3 offen lds
    s_add_u32 m0, s95, 0
    s_mov_b32 s3, 0
    buffer_load_dwordx4 v21, s[52:55], s3 offen lds
    s_add_u32 m0, s95, 4096
    s_mov_b32 s3, 23040
    buffer_load_dwordx4 v21, s[52:55], s3 offen lds
    s_add_u32 m0, s95, 8192
    s_mov_b32 s3, 41472
    buffer_load_dwordx4 v21, s[52:55], s3 offen lds
    s_add_u32 m0, s95, 12288
    s_mov_b32 s3, 64512
    buffer_load_dwordx4 v21, s[52:55], s3 offen lds
    s_add_u32 m0, s95, 16384
    s_mov_b32 s3, 82944
    buffer_load_dwordx4 v21, s[52:55], s3 offen lds
    s_add_u32 m0, s95, 20480
    s_mov_b32 s3, 105984
    buffer_load_dwordx4 v21, s[52:55], s3 offen lds
    s_add_u32 m0, s95, 24576
    s_mov_b32 s3, 124416
    buffer_load_dwordx4 v21, s[52:55], s3 offen lds
    s_add_u32 m0, s95, 28672
    s_mov_b32 s3, 147456
    buffer_load_dwordx4 v21, s[52:55], s3 offen lds
    s_add_u32 m0, s95, 32768
    s_mov_b32 s3, 165888
    buffer_load_dwordx4 v21, s[52:55], s3 offen lds
    s_add_u32 m0, s95, 36864
    s_mov_b32 s3, 188928
    buffer_load_dwordx4 v21, s[52:55], s3 offen lds
    s_mov_b32 s33, s97
    s_lshl_b32 s34, s42, 2
    s_add_u32 s32, s96, s34
    s_and_b32 s36, s31, 1
    s_lshr_b32 s35, s31, 1
    s_xor_b32 s35, s35, 2
    v_mov_b32 v8, 0x7ffffff0
    v_lshlrev_b32 v9, 4, v1
    s_add_u32 s40, s31, s43
    s_and_b32 s40, s40, 7
    s_and_b32 s41, s33, 3
    s_mul_i32 s37, s40, 5632
    v_and_b32 v6, 3, v2
    v_bfe_u32 v7, v2, 2, 1
    v_lshl_add_u32 v7, v7, 1, v6
    v_cmp_gt_u32 vcc, 2, v6
    s_nop 1
    v_cndmask_b32 v7, v7, v6, vcc
    v_lshlrev_b32 v12, 4, v3
    v_lshl_add_u32 v12, v7, 6, v12
    v_cmp_gt_u32 s[44:45], 8, v2
    s_nop 0
    s_or_b64 s[96:97], s[44:45], vcc
    s_orn2_b64 vcc, vcc, s[44:45]
    v_cndmask_b32 v13, v8, v12, vcc
    v_cndmask_b32 v12, v8, v12, s[96:97]
    v_lshlrev_b32 v10, 4, v2
    v_lshlrev_b32 v11, 4, v7
    v_add_u32 v11, 640, v11
    v_cmp_lt_u32 s[100:101], 1, v3
    s_nop 1
    v_cndmask_b32 v10, v10, v11, s[100:101]
    v_and_b32 v6, 1, v3
    v_mul_u32_u24 v11, 2816, v6
    v_add_u32 v10, v10, v11
    v_cmp_eq_u32 s[98:99], 1, v6
    v_cmp_eq_u32 s[44:45], 1, v7
    v_cmp_lt_u32 s[46:47], 3, v7
    s_nop 0
    s_or_b64 s[44:45], s[44:45], s[46:47]
    s_andn2_b64 s[46:47], s[100:101], s[98:99]
    s_and_b64 s[46:47], s[46:47], s[96:97]
    s_and_b64 s[96:97], s[100:101], s[98:99]
    s_and_b64 s[96:97], s[96:97], vcc
    v_lshlrev_b32 v7, 3, v2
    v_lshl_add_u32 v7, v6, 7, v7
    s_lshl_b32 s38, s32, 6
    s_lshl_b32 s39, s40, 1
    s_add_u32 s38, s38, s39
    s_lshl_b32 s39, s38, 7
    s_add_u32 s39, s39, 3145728
    s_lshl_b32 s38, s38, 10
    s_add_u32 s38, s38, 1048576
    s_barrier
    s_add_u32 m0, s95, 114688
    s_mov_b32 s3, 580608
    buffer_load_dwordx4 v21, s[52:55], s3 offen lds
    s_add_u32 m0, s95, 118784
    s_mov_b32 s3, 603648
    buffer_load_dwordx4 v21, s[52:55], s3 offen lds
    s_add_u32 m0, s95, 122880
    s_mov_b32 s3, 622080
    buffer_load_dwordx4 v21, s[52:55], s3 offen lds
    s_add_u32 m0, s95, 126976
    s_mov_b32 s3, 645120
    buffer_load_dwordx4 v21, s[52:55], s3 offen lds
    s_add_u32 m0, s95, 131072
    s_mov_b32 s3, 0
    buffer_load_dwordx4 v22, s[52:55], s3 offen lds
    s_add_u32 m0, s95, 135168
    s_mov_b32 s3, 165888
    buffer_load_dwordx4 v22, s[52:55], s3 offen lds
    s_add_u32 m0, s95, 139264
    s_mov_b32 s3, 331776
    buffer_load_dwordx4 v22, s[52:55], s3 offen lds
    s_add_u32 m0, s95, 143360
    s_mov_b32 s3, 497664
    buffer_load_dwordx4 v22, s[52:55], s3 offen lds
    v_mov_b32 v4, 163780
    v_mov_b32 v5, 1
    s_waitcnt vmcnt(0)
    s_mov_b64 exec, 1
    ds_add_u32 v4, v5
    s_mov_b64 exec, -1
    s_branch L_bjoin
L_q_comp:
    s_lshr_b32 s96, s43, 2
    s_and_b32 s97, s43, 3
    s_cmp_ge_u32 s43, 16
    s_cselect_b32 s96, s97, s96
    s_cselect_b32 s97, 4, s97
    s_and_b32 s35, s31, 1
    s_lshr_b32 s36, s31, 1
    v_lshrrev_b32 v9, 1, v2
    v_xor_b32 v9, v9, v3
    v_lshlrev_b32 v10, 7, v2
    v_lshl_add_u32 v10, v9, 4, v10
    s_mul_i32 s37, s35, 10240
    v_add_u32 v4, s37, v10
    v_xor_b32 v5, 64, v4
    v_lshrrev_b32 v9, 2, v2
    v_and_b32 v10, 3, v2
    v_lshl_add_u32 v11, v3, 2, v9
    v_mul_u32_u24 v11, 288, v11
    s_mul_i32 s37, s36, 144
    s_add_u32 s37, s37, 20480
    v_add_u32 v11, s37, v11
    v_lshl_add_u32 v6, v10, 3, v11
    v_and_b32 v12, 1, v10
    v_mul_u32_u24 v12, 72, v12
    v_add3_u32 v7, v11, v12, 32
    v_mov_b32 v12, 163776
    v_mov_b32 v14, 0
    v_mov_b32 v15, 0
    ds_write_b64 v12, v[14:15]
    v_mov_b32 v8, 0x3f800008
    v_mov_b32 v9, v8
    v_mov_b64 v[16:17], v[8:9]
    v_mov_b64 v[18:19], v[8:9]
    v_mov_b64 v[20:21], v[8:9]
    v_mov_b64 v[22:23], v[8:9]
    v_mov_b64 v[24:25], v[8:9]
    v_mov_b64 v[26:27], v[8:9]
    v_mov_b64 v[28:29], v[8:9]
    v_mov_b64 v[30:31], v[8:9]
    v_mov_b64 v[32:33], v[8:9]
    v_mov_b64 v[34:35], v[8:9]
    v_mov_b64 v[36:37], v[8:9]
    v_mov_b64 v[38:39], v[8:9]
    v_mov_b64 v[40:41], v[8:9]
    v_mov_b64 v[42:43], v[8:9]
    v_mov_b64 v[44:45], v[8:9]
    v_mov_b64 v[46:47], v[8:9]
    v_mov_b64 v[48:49], v[8:9]
    v_mov_b64 v[50:51], v[8:9]
    v_mov_b64 v[52:53], v[8:9]
    v_mov_b64 v[54:55], v[8:9]
    v_mov_b64 v[56:57], v[8:9]
    v_mov_b64 v[58:59], v[8:9]
    v_mov_b64 v[60:61], v[8:9]
    v_mov_b64 v[62:63], v[8:9]
    v_mov_b64 v[64:65], v[8:9]
    v_mov_b64 v[66:67], v[8:9]
    v_mov_b64 v[68:69], v[8:9]
    v_mov_b64 v[70:71], v[8:9]
    v_mov_b64 v[72:73], v[8:9]
    v_mov_b64 v[74:75], v[8:9]
    v_mov_b64 v[76:77], v[8:9]
    v_mov_b64 v[78:79], v[8:9]
    v_mov_b64 v[80:81], v[8:9]
    v_mov_b64 v[82:83], v[8:9]
    v_mov_b64 v[84:85], v[8:9]
    v_mov_b64 v[86:87], v[8:9]
    v_mov_b64 v[88:89], v[8:9]
    v_mov_b64 v[90:91], v[8:9]
    v_mov_b64 v[92:93], v[8:9]
    v_mov_b64 v[94:95], v[8:9]
    v_mov_b64 v[96:97], v[8:9]
    v_mov_b64 v[98:99], v[8:9]
    v_mov_b64 v[100:101], v[8:9]
    v_mov_b64 v[102:103], v[8:9]
    v_mov_b64 v[104:105], v[8:9]
    v_mov_b64 v[106:107], v[8:9]
    v_mov_b64 v[108:109], v[8:9]
    v_mov_b64 v[110:111], v[8:9]
    v_mov_b64 v[112:113], v[8:9]
    v_mov_b64 v[114:115], v[8:9]
    s_mov_b32 s40, 0x3fb8aa3b
    s_mov_b32 s41, s40
    v_mov_b32 v250, 0xbfb8aa47
    v_mov_b32 v251, v250
    v_mov_b32 v252, 0x358637bd
    v_mov_b32 v253, v252
    s_waitcnt lgkmcnt(0)
    s_mov_b32 s56, s28
    s_mov_b32 s57, s29
    s_mov_b32 s58, 4194304
    s_mov_b32 s59, 0x20000
    s_mov_b32 s52, s22
    s_mov_b32 s53, s23
    s_mov_b32 s54, 663552
    s_mov_b32 s55, 0x20000
    v_lshlrev_b32 v8, 4, v1
    v_lshlrev_b32 v9, 3, v1
    s_mul_i32 s38, s33, 10
    s_mul_i32 s39, s35, 5
    s_add_u32 s38, s38, s39
    s_lshl_b32 s38, s38, 4
    s_lshl_b32 s39, s32, 2
    s_add_u32 s38, s38, s39
    s_lshl_b32 s39, s36, 1
    s_add_u32 s38, s38, s39
    s_lshl_b32 s37, s38, 10
    s_add_u32 s37, s37, 1048576
    s_lshl_b32 s39, s38, 7
    s_add_u32 s39, s39, 3145728
    s_mov_b32 s44, s28
    s_mov_b32 s45, s29
    s_mov_b32 s46, 3145728
    s_mov_b32 s47, 0x20000
    s_mov_b32 s48, s28
    s_mov_b32 s49, s29
    s_mov_b32 s50, 3407872
    s_mov_b32 s51, 0x20000
    v_lshrrev_b32 v244, 2, v2
    v_lshl_add_u32 v244, v3, 2, v244
    v_and_b32 v245, 7, v244
    v_lshlrev_b32 v245, 1, v245
    v_bfe_u32 v246, v2, 1, 1
    s_lshr_b32 s3, s31, 1
    s_xor_b32 s3, s3, 2
    s_lshl_b32 s3, s3, 2
    v_add_u32 v246, s3, v246
    v_xor_b32 v245, v245, v246
    v_lshlrev_b32 v244, 8, v244
    v_lshl_add_u32 v244, v245, 4, v244
    v_and_b32 v245, 1, v2
    v_lshl_add_u32 v244, v245, 3, v244
    v_xor_b32 v245, 32, v244
    v_add_u32 v246, 0x10000, v244
    v_add_u32 v247, 0x10000, v245
    s_barrier
    ds_read_b64_tr_b16 v[140:141], v6 offset:0
    ds_read_b64_tr_b16 v[142:143], v6 offset:4608
    ds_read_b128 v[120:123], v4 offset:0
    ds_read_b128 v[124:127], v4 offset:2048
    ds_read_b128 v[128:131], v4 offset:4096
    ds_read_b128 v[132:135], v4 offset:6144
    ds_read_b128 v[136:139], v4 offset:8192
    ds_read_b64_tr_b16 v[144:145], v6 offset:40
    ds_read_b64_tr_b16 v[146:147], v6 offset:4648
    ds_read_b64_tr_b16 v[156:157], v7 offset:0
    ds_read_b64_tr_b16 v[158:159], v7 offset:4608
    ds_read_b64_tr_b16 v[148:149], v6 offset:72
    ds_read_b64_tr_b16 v[150:151], v6 offset:4680
    ds_read_b64_tr_b16 v[152:153], v6 offset:112
    ds_read_b64_tr_b16 v[154:155], v6 offset:4720
    s_waitcnt lgkmcnt(0)
    ds_read_b64_tr_b16 v[180:181], v6 offset:9216
    v_mfma_f32_16x16x32_bf16 v[16:19], v[140:143], v[120:123], v[16:19]
    ds_read_b64_tr_b16 v[182:183], v6 offset:13824
    v_mfma_f32_16x16x32_bf16 v[36:39], v[140:143], v[124:127], v[36:39]
    ds_read_b128 v[160:163], v5 offset:0
    v_mfma_f32_16x16x32_bf16 v[56:59], v[140:143], v[128:131], v[56:59]
    ds_read_b128 v[164:167], v5 offset:2048
    v_mfma_f32_16x16x32_bf16 v[76:79], v[140:143], v[132:135], v[76:79]
    ds_read_b128 v[168:171], v5 offset:4096
    v_mfma_f32_16x16x32_bf16 v[96:99], v[140:143], v[136:139], v[96:99]
    ds_read_b128 v[172:175], v5 offset:6144
    v_mfma_f32_16x16x32_bf16 v[20:23], v[144:147], v[120:123], v[20:23]
    ds_read_b128 v[176:179], v5 offset:8192
    v_mfma_f32_16x16x32_bf16 v[40:43], v[144:147], v[124:127], v[40:43]
    ds_read_b64_tr_b16 v[184:185], v6 offset:9256
    v_mfma_f32_16x16x32_bf16 v[60:63], v[144:147], v[128:131], v[60:63]
    ds_read_b64_tr_b16 v[186:187], v6 offset:13864
    v_mfma_f32_16x16x32_bf16 v[80:83], v[144:147], v[132:135], v[80:83]
    ds_read_b64_tr_b16 v[196:197], v7 offset:9216
    v_mfma_f32_16x16x32_bf16 v[100:103], v[144:147], v[136:139], v[100:103]
    ds_read_b64_tr_b16 v[198:199], v7 offset:13824
    v_mfma_f32_16x16x32_bf16 v[32:35], v[156:159], v[120:123], v[32:35]
    ds_read_b64_tr_b16 v[188:189], v6 offset:9288
    v_mfma_f32_16x16x32_bf16 v[52:55], v[156:159], v[124:127], v[52:55]
    ds_read_b64_tr_b16 v[190:191], v6 offset:13896
    v_mfma_f32_16x16x32_bf16 v[72:75], v[156:159], v[128:131], v[72:75]
    ds_read_b64_tr_b16 v[192:193], v6 offset:9328
    v_mfma_f32_16x16x32_bf16 v[92:95], v[156:159], v[132:135], v[92:95]
    ds_read_b64_tr_b16 v[194:195], v6 offset:13936
    v_mfma_f32_16x16x32_bf16 v[112:115], v[156:159], v[136:139], v[112:115]
    v_add_u32 v4, 0x9800, v4
    v_mfma_f32_16x16x32_bf16 v[24:27], v[148:151], v[120:123], v[24:27]
    v_add_u32 v5, 0x9800, v5
    v_mfma_f32_16x16x32_bf16 v[44:47], v[148:151], v[124:127], v[44:47]
    v_add_u32 v6, 0x9800, v6
    v_mfma_f32_16x16x32_bf16 v[64:67], v[148:151], v[128:131], v[64:67]
    v_add_u32 v7, 0x9800, v7
    v_mfma_f32_16x16x32_bf16 v[84:87], v[148:151], v[132:135], v[84:87]
    v_mfma_f32_16x16x32_bf16 v[104:107], v[148:151], v[136:139], v[104:107]
    v_mfma_f32_16x16x32_bf16 v[28:31], v[152:155], v[120:123], v[28:31]
    v_mfma_f32_16x16x32_bf16 v[48:51], v[152:155], v[124:127], v[48:51]
    v_mfma_f32_16x16x32_bf16 v[68:71], v[152:155], v[128:131], v[68:71]
    v_mfma_f32_16x16x32_bf16 v[88:91], v[152:155], v[132:135], v[88:91]
    v_mfma_f32_16x16x32_bf16 v[108:111], v[152:155], v[136:139], v[108:111]
    s_waitcnt lgkmcnt(0)
    s_barrier
    ds_read_b64_tr_b16 v[140:141], v6 offset:0
    v_mfma_f32_16x16x32_bf16 v[16:19], v[180:183], v[160:163], v[16:19]
    ds_read_b64_tr_b16 v[142:143], v6 offset:4608
    v_mfma_f32_16x16x32_bf16 v[36:39], v[180:183], v[164:167], v[36:39]
    ds_read_b128 v[120:123], v4 offset:0
    v_mfma_f32_16x16x32_bf16 v[56:59], v[180:183], v[168:171], v[56:59]
    ds_read_b128 v[124:127], v4 offset:2048
    v_mfma_f32_16x16x32_bf16 v[76:79], v[180:183], v[172:175], v[76:79]
    ds_read_b128 v[128:131], v4 offset:4096
    v_mfma_f32_16x16x32_bf16 v[96:99], v[180:183], v[176:179], v[96:99]
    ds_read_b128 v[132:135], v4 offset:6144
    v_mfma_f32_16x16x32_bf16 v[20:23], v[184:187], v[160:163], v[20:23]
    ds_read_b128 v[136:139], v4 offset:8192
    v_mfma_f32_16x16x32_bf16 v[40:43], v[184:187], v[164:167], v[40:43]
    ds_read_b64_tr_b16 v[144:145], v6 offset:40
    v_mfma_f32_16x16x32_bf16 v[60:63], v[184:187], v[168:171], v[60:63]
    ds_read_b64_tr_b16 v[146:147], v6 offset:4648
    v_mfma_f32_16x16x32_bf16 v[80:83], v[184:187], v[172:175], v[80:83]
    ds_read_b64_tr_b16 v[156:157], v7 offset:0
    v_mfma_f32_16x16x32_bf16 v[100:103], v[184:187], v[176:179], v[100:103]
    ds_read_b64_tr_b16 v[158:159], v7 offset:4608
    v_mfma_f32_16x16x32_bf16 v[32:35], v[196:199], v[160:163], v[32:35]
    ds_read_b64_tr_b16 v[148:149], v6 offset:72
    v_mfma_f32_16x16x32_bf16 v[52:55], v[196:199], v[164:167], v[52:55]
    ds_read_b64_tr_b16 v[150:151], v6 offset:4680
    v_mfma_f32_16x16x32_bf16 v[72:75], v[196:199], v[168:171], v[72:75]
    ds_read_b64_tr_b16 v[152:153], v6 offset:112
    v_mfma_f32_16x16x32_bf16 v[92:95], v[196:199], v[172:175], v[92:95]
    ds_read_b64_tr_b16 v[154:155], v6 offset:4720
    v_mfma_f32_16x16x32_bf16 v[112:115], v[196:199], v[176:179], v[112:115]
    v_mfma_f32_16x16x32_bf16 v[24:27], v[188:191], v[160:163], v[24:27]
    v_mfma_f32_16x16x32_bf16 v[44:47], v[188:191], v[164:167], v[44:47]
    v_mfma_f32_16x16x32_bf16 v[64:67], v[188:191], v[168:171], v[64:67]
    v_mfma_f32_16x16x32_bf16 v[84:87], v[188:191], v[172:175], v[84:87]
    v_mfma_f32_16x16x32_bf16 v[104:107], v[188:191], v[176:179], v[104:107]
    v_mfma_f32_16x16x32_bf16 v[28:31], v[192:195], v[160:163], v[28:31]
    v_mfma_f32_16x16x32_bf16 v[48:51], v[192:195], v[164:167], v[48:51]
    v_mfma_f32_16x16x32_bf16 v[68:71], v[192:195], v[168:171], v[68:71]
    v_mfma_f32_16x16x32_bf16 v[88:91], v[192:195], v[172:175], v[88:91]
    v_mfma_f32_16x16x32_bf16 v[108:111], v[192:195], v[176:179], v[108:111]
    s_waitcnt lgkmcnt(0)
    ds_read_b64_tr_b16 v[180:181], v6 offset:9216
    v_mfma_f32_16x16x32_bf16 v[16:19], v[140:143], v[120:123], v[16:19]
    ds_read_b64_tr_b16 v[182:183], v6 offset:13824
    v_mfma_f32_16x16x32_bf16 v[36:39], v[140:143], v[124:127], v[36:39]
    ds_read_b128 v[160:163], v5 offset:0
    v_mfma_f32_16x16x32_bf16 v[56:59], v[140:143], v[128:131], v[56:59]
    ds_read_b128 v[164:167], v5 offset:2048
    v_mfma_f32_16x16x32_bf16 v[76:79], v[140:143], v[132:135], v[76:79]
    ds_read_b128 v[168:171], v5 offset:4096
    v_mfma_f32_16x16x32_bf16 v[96:99], v[140:143], v[136:139], v[96:99]
    ds_read_b128 v[172:175], v5 offset:6144
    v_mfma_f32_16x16x32_bf16 v[20:23], v[144:147], v[120:123], v[20:23]
    ds_read_b128 v[176:179], v5 offset:8192
    v_mfma_f32_16x16x32_bf16 v[40:43], v[144:147], v[124:127], v[40:43]
    ds_read_b64_tr_b16 v[184:185], v6 offset:9256
    v_mfma_f32_16x16x32_bf16 v[60:63], v[144:147], v[128:131], v[60:63]
    ds_read_b64_tr_b16 v[186:187], v6 offset:13864
    v_mfma_f32_16x16x32_bf16 v[80:83], v[144:147], v[132:135], v[80:83]
    ds_read_b64_tr_b16 v[196:197], v7 offset:9216
    v_mfma_f32_16x16x32_bf16 v[100:103], v[144:147], v[136:139], v[100:103]
    ds_read_b64_tr_b16 v[198:199], v7 offset:13824
    v_mfma_f32_16x16x32_bf16 v[32:35], v[156:159], v[120:123], v[32:35]
    ds_read_b64_tr_b16 v[188:189], v6 offset:9288
    v_mfma_f32_16x16x32_bf16 v[52:55], v[156:159], v[124:127], v[52:55]
    ds_read_b64_tr_b16 v[190:191], v6 offset:13896
    v_mfma_f32_16x16x32_bf16 v[72:75], v[156:159], v[128:131], v[72:75]
    ds_read_b64_tr_b16 v[192:193], v6 offset:9328
    v_mfma_f32_16x16x32_bf16 v[92:95], v[156:159], v[132:135], v[92:95]
    ds_read_b64_tr_b16 v[194:195], v6 offset:13936
    v_mfma_f32_16x16x32_bf16 v[112:115], v[156:159], v[136:139], v[112:115]
    v_add_u32 v4, 0x9800, v4
    v_mfma_f32_16x16x32_bf16 v[24:27], v[148:151], v[120:123], v[24:27]
    v_add_u32 v5, 0x9800, v5
    v_mfma_f32_16x16x32_bf16 v[44:47], v[148:151], v[124:127], v[44:47]
    v_add_u32 v6, 0x9800, v6
    v_mfma_f32_16x16x32_bf16 v[64:67], v[148:151], v[128:131], v[64:67]
    v_add_u32 v7, 0x9800, v7
    v_mfma_f32_16x16x32_bf16 v[84:87], v[148:151], v[132:135], v[84:87]
    v_mfma_f32_16x16x32_bf16 v[104:107], v[148:151], v[136:139], v[104:107]
    v_mfma_f32_16x16x32_bf16 v[28:31], v[152:155], v[120:123], v[28:31]
    v_mfma_f32_16x16x32_bf16 v[48:51], v[152:155], v[124:127], v[48:51]
    v_mfma_f32_16x16x32_bf16 v[68:71], v[152:155], v[128:131], v[68:71]
    v_mfma_f32_16x16x32_bf16 v[88:91], v[152:155], v[132:135], v[88:91]
    v_mfma_f32_16x16x32_bf16 v[108:111], v[152:155], v[136:139], v[108:111]
    s_waitcnt lgkmcnt(0)
    s_barrier
    ds_read_b64_tr_b16 v[140:141], v6 offset:0
    v_mfma_f32_16x16x32_bf16 v[16:19], v[180:183], v[160:163], v[16:19]
    ds_read_b64_tr_b16 v[142:143], v6 offset:4608
    v_mfma_f32_16x16x32_bf16 v[36:39], v[180:183], v[164:167], v[36:39]
    ds_read_b128 v[120:123], v4 offset:0
    v_mfma_f32_16x16x32_bf16 v[56:59], v[180:183], v[168:171], v[56:59]
    ds_read_b128 v[124:127], v4 offset:2048
    v_mfma_f32_16x16x32_bf16 v[76:79], v[180:183], v[172:175], v[76:79]
    ds_read_b128 v[128:131], v4 offset:4096
    v_mfma_f32_16x16x32_bf16 v[96:99], v[180:183], v[176:179], v[96:99]
    ds_read_b128 v[132:135], v4 offset:6144
    v_mfma_f32_16x16x32_bf16 v[20:23], v[184:187], v[160:163], v[20:23]
    ds_read_b128 v[136:139], v4 offset:8192
    v_mfma_f32_16x16x32_bf16 v[40:43], v[184:187], v[164:167], v[40:43]
    ds_read_b64_tr_b16 v[144:145], v6 offset:40
    v_mfma_f32_16x16x32_bf16 v[60:63], v[184:187], v[168:171], v[60:63]
    ds_read_b64_tr_b16 v[146:147], v6 offset:4648
    v_mfma_f32_16x16x32_bf16 v[80:83], v[184:187], v[172:175], v[80:83]
    ds_read_b64_tr_b16 v[156:157], v7 offset:0
    v_mfma_f32_16x16x32_bf16 v[100:103], v[184:187], v[176:179], v[100:103]
    ds_read_b64_tr_b16 v[158:159], v7 offset:4608
    v_mfma_f32_16x16x32_bf16 v[32:35], v[196:199], v[160:163], v[32:35]
    ds_read_b64_tr_b16 v[148:149], v6 offset:72
    v_mfma_f32_16x16x32_bf16 v[52:55], v[196:199], v[164:167], v[52:55]
    ds_read_b64_tr_b16 v[150:151], v6 offset:4680
    v_mfma_f32_16x16x32_bf16 v[72:75], v[196:199], v[168:171], v[72:75]
    ds_read_b64_tr_b16 v[152:153], v6 offset:112
    v_mfma_f32_16x16x32_bf16 v[92:95], v[196:199], v[172:175], v[92:95]
    ds_read_b64_tr_b16 v[154:155], v6 offset:4720
    v_mfma_f32_16x16x32_bf16 v[112:115], v[196:199], v[176:179], v[112:115]
    v_mfma_f32_16x16x32_bf16 v[24:27], v[188:191], v[160:163], v[24:27]
    v_mfma_f32_16x16x32_bf16 v[44:47], v[188:191], v[164:167], v[44:47]
    v_mfma_f32_16x16x32_bf16 v[64:67], v[188:191], v[168:171], v[64:67]
    v_mfma_f32_16x16x32_bf16 v[84:87], v[188:191], v[172:175], v[84:87]
    v_mfma_f32_16x16x32_bf16 v[104:107], v[188:191], v[176:179], v[104:107]
    v_mfma_f32_16x16x32_bf16 v[28:31], v[192:195], v[160:163], v[28:31]
    v_mfma_f32_16x16x32_bf16 v[48:51], v[192:195], v[164:167], v[48:51]
    v_mfma_f32_16x16x32_bf16 v[68:71], v[192:195], v[168:171], v[68:71]
    v_mfma_f32_16x16x32_bf16 v[88:91], v[192:195], v[172:175], v[88:91]
    v_mfma_f32_16x16x32_bf16 v[108:111], v[192:195], v[176:179], v[108:111]
    s_waitcnt lgkmcnt(0)
    ds_read_b64_tr_b16 v[180:181], v6 offset:9216
    v_mfma_f32_16x16x32_bf16 v[16:19], v[140:143], v[120:123], v[16:19]
    ds_read_b64_tr_b16 v[182:183], v6 offset:13824
    v_mfma_f32_16x16x32_bf16 v[36:39], v[140:143], v[124:127], v[36:39]
    ds_read_b128 v[160:163], v5 offset:0
    v_mfma_f32_16x16x32_bf16 v[56:59], v[140:143], v[128:131], v[56:59]
    ds_read_b128 v[164:167], v5 offset:2048
    v_mfma_f32_16x16x32_bf16 v[76:79], v[140:143], v[132:135], v[76:79]
    ds_read_b128 v[168:171], v5 offset:4096
    v_mfma_f32_16x16x32_bf16 v[96:99], v[140:143], v[136:139], v[96:99]
    ds_read_b128 v[172:175], v5 offset:6144
    v_mfma_f32_16x16x32_bf16 v[20:23], v[144:147], v[120:123], v[20:23]
    ds_read_b128 v[176:179], v5 offset:8192
    v_mfma_f32_16x16x32_bf16 v[40:43], v[144:147], v[124:127], v[40:43]
    ds_read_b64_tr_b16 v[184:185], v6 offset:9256
    v_mfma_f32_16x16x32_bf16 v[60:63], v[144:147], v[128:131], v[60:63]
    ds_read_b64_tr_b16 v[186:187], v6 offset:13864
    v_mfma_f32_16x16x32_bf16 v[80:83], v[144:147], v[132:135], v[80:83]
    ds_read_b64_tr_b16 v[196:197], v7 offset:9216
    v_mfma_f32_16x16x32_bf16 v[100:103], v[144:147], v[136:139], v[100:103]
    ds_read_b64_tr_b16 v[198:199], v7 offset:13824
    v_mfma_f32_16x16x32_bf16 v[32:35], v[156:159], v[120:123], v[32:35]
    ds_read_b64_tr_b16 v[188:189], v6 offset:9288
    v_mfma_f32_16x16x32_bf16 v[52:55], v[156:159], v[124:127], v[52:55]
    ds_read_b64_tr_b16 v[190:191], v6 offset:13896
    v_mfma_f32_16x16x32_bf16 v[72:75], v[156:159], v[128:131], v[72:75]
    ds_read_b64_tr_b16 v[192:193], v6 offset:9328
    v_mfma_f32_16x16x32_bf16 v[92:95], v[156:159], v[132:135], v[92:95]
    ds_read_b64_tr_b16 v[194:195], v6 offset:13936
    v_mfma_f32_16x16x32_bf16 v[112:115], v[156:159], v[136:139], v[112:115]
    v_add_u32 v4, 0x9800, v4
    v_mfma_f32_16x16x32_bf16 v[24:27], v[148:151], v[120:123], v[24:27]
    v_add_u32 v5, 0x9800, v5
    v_mfma_f32_16x16x32_bf16 v[44:47], v[148:151], v[124:127], v[44:47]
    v_add_u32 v6, 0x9800, v6
    v_mfma_f32_16x16x32_bf16 v[64:67], v[148:151], v[128:131], v[64:67]
    v_add_u32 v7, 0x9800, v7
    v_mfma_f32_16x16x32_bf16 v[84:87], v[148:151], v[132:135], v[84:87]
    v_mfma_f32_16x16x32_bf16 v[104:107], v[148:151], v[136:139], v[104:107]
    v_mfma_f32_16x16x32_bf16 v[28:31], v[152:155], v[120:123], v[28:31]
    v_mfma_f32_16x16x32_bf16 v[48:51], v[152:155], v[124:127], v[48:51]
    v_mfma_f32_16x16x32_bf16 v[68:71], v[152:155], v[128:131], v[68:71]
    v_mfma_f32_16x16x32_bf16 v[88:91], v[152:155], v[132:135], v[88:91]
    v_mfma_f32_16x16x32_bf16 v[108:111], v[152:155], v[136:139], v[108:111]
    s_waitcnt lgkmcnt(0)
    s_barrier
    ds_read_b64_tr_b16 v[140:141], v6 offset:0
    v_mfma_f32_16x16x32_bf16 v[16:19], v[180:183], v[160:163], v[16:19]
    ds_read_b64_tr_b16 v[142:143], v6 offset:4608
    v_mfma_f32_16x16x32_bf16 v[36:39], v[180:183], v[164:167], v[36:39]
    ds_read_b128 v[120:123], v4 offset:0
    v_mfma_f32_16x16x32_bf16 v[56:59], v[180:183], v[168:171], v[56:59]
    ds_read_b128 v[124:127], v4 offset:2048
    v_mfma_f32_16x16x32_bf16 v[76:79], v[180:183], v[172:175], v[76:79]
    ds_read_b128 v[128:131], v4 offset:4096
    v_mfma_f32_16x16x32_bf16 v[96:99], v[180:183], v[176:179], v[96:99]
    ds_read_b128 v[132:135], v4 offset:6144
    v_mfma_f32_16x16x32_bf16 v[20:23], v[184:187], v[160:163], v[20:23]
    ds_read_b128 v[136:139], v4 offset:8192
    v_mfma_f32_16x16x32_bf16 v[40:43], v[184:187], v[164:167], v[40:43]
    ds_read_b64_tr_b16 v[144:145], v6 offset:40
    v_mfma_f32_16x16x32_bf16 v[60:63], v[184:187], v[168:171], v[60:63]
    ds_read_b64_tr_b16 v[146:147], v6 offset:4648
    v_mfma_f32_16x16x32_bf16 v[80:83], v[184:187], v[172:175], v[80:83]
    ds_read_b64_tr_b16 v[156:157], v7 offset:0
    v_mfma_f32_16x16x32_bf16 v[100:103], v[184:187], v[176:179], v[100:103]
    ds_read_b64_tr_b16 v[158:159], v7 offset:4608
    v_mfma_f32_16x16x32_bf16 v[32:35], v[196:199], v[160:163], v[32:35]
    ds_read_b64_tr_b16 v[148:149], v6 offset:72
    v_mfma_f32_16x16x32_bf16 v[52:55], v[196:199], v[164:167], v[52:55]
    ds_read_b64_tr_b16 v[150:151], v6 offset:4680
    v_mfma_f32_16x16x32_bf16 v[72:75], v[196:199], v[168:171], v[72:75]
    ds_read_b64_tr_b16 v[152:153], v6 offset:112
    v_mfma_f32_16x16x32_bf16 v[92:95], v[196:199], v[172:175], v[92:95]
    ds_read_b64_tr_b16 v[154:155], v6 offset:4720
    v_mfma_f32_16x16x32_bf16 v[112:115], v[196:199], v[176:179], v[112:115]
    v_mfma_f32_16x16x32_bf16 v[24:27], v[188:191], v[160:163], v[24:27]
    v_mfma_f32_16x16x32_bf16 v[44:47], v[188:191], v[164:167], v[44:47]
    v_mfma_f32_16x16x32_bf16 v[64:67], v[188:191], v[168:171], v[64:67]
    v_mfma_f32_16x16x32_bf16 v[84:87], v[188:191], v[172:175], v[84:87]
    v_mfma_f32_16x16x32_bf16 v[104:107], v[188:191], v[176:179], v[104:107]
    v_mfma_f32_16x16x32_bf16 v[28:31], v[192:195], v[160:163], v[28:31]
    v_mfma_f32_16x16x32_bf16 v[48:51], v[192:195], v[164:167], v[48:51]
    v_mfma_f32_16x16x32_bf16 v[68:71], v[192:195], v[168:171], v[68:71]
    v_mfma_f32_16x16x32_bf16 v[88:91], v[192:195], v[172:175], v[88:91]
    v_mfma_f32_16x16x32_bf16 v[108:111], v[192:195], v[176:179], v[108:111]
    s_waitcnt lgkmcnt(0)
    ds_read_b64_tr_b16 v[180:181], v6 offset:9216
    v_mfma_f32_16x16x32_bf16 v[16:19], v[140:143], v[120:123], v[16:19]
    ds_read_b64_tr_b16 v[182:183], v6 offset:13824
    v_mfma_f32_16x16x32_bf16 v[36:39], v[140:143], v[124:127], v[36:39]
    ds_read_b128 v[160:163], v5 offset:0
    v_mfma_f32_16x16x32_bf16 v[56:59], v[140:143], v[128:131], v[56:59]
    ds_read_b128 v[164:167], v5 offset:2048
    v_mfma_f32_16x16x32_bf16 v[76:79], v[140:143], v[132:135], v[76:79]
    ds_read_b128 v[168:171], v5 offset:4096
    v_mfma_f32_16x16x32_bf16 v[96:99], v[140:143], v[136:139], v[96:99]
    ds_read_b128 v[172:175], v5 offset:6144
    v_mfma_f32_16x16x32_bf16 v[20:23], v[144:147], v[120:123], v[20:23]
    ds_read_b128 v[176:179], v5 offset:8192
    v_mfma_f32_16x16x32_bf16 v[40:43], v[144:147], v[124:127], v[40:43]
    ds_read_b64_tr_b16 v[184:185], v6 offset:9256
    v_mfma_f32_16x16x32_bf16 v[60:63], v[144:147], v[128:131], v[60:63]
    ds_read_b64_tr_b16 v[186:187], v6 offset:13864
    v_mfma_f32_16x16x32_bf16 v[80:83], v[144:147], v[132:135], v[80:83]
    ds_read_b64_tr_b16 v[196:197], v7 offset:9216
    v_mfma_f32_16x16x32_bf16 v[100:103], v[144:147], v[136:139], v[100:103]
    ds_read_b64_tr_b16 v[198:199], v7 offset:13824
    v_mfma_f32_16x16x32_bf16 v[32:35], v[156:159], v[120:123], v[32:35]
    ds_read_b64_tr_b16 v[188:189], v6 offset:9288
    v_mfma_f32_16x16x32_bf16 v[52:55], v[156:159], v[124:127], v[52:55]
    ds_read_b64_tr_b16 v[190:191], v6 offset:13896
    v_mfma_f32_16x16x32_bf16 v[72:75], v[156:159], v[128:131], v[72:75]
    ds_read_b64_tr_b16 v[192:193], v6 offset:9328
    v_mfma_f32_16x16x32_bf16 v[92:95], v[156:159], v[132:135], v[92:95]
    ds_read_b64_tr_b16 v[194:195], v6 offset:13936
    v_mfma_f32_16x16x32_bf16 v[112:115], v[156:159], v[136:139], v[112:115]
    v_add_u32 v4, 0xfffe3800, v4
    v_mfma_f32_16x16x32_bf16 v[24:27], v[148:151], v[120:123], v[24:27]
    v_add_u32 v5, 0xfffe3800, v5
    v_mfma_f32_16x16x32_bf16 v[44:47], v[148:151], v[124:127], v[44:47]
    v_add_u32 v6, 0xfffe3800, v6
    v_mfma_f32_16x16x32_bf16 v[64:67], v[148:151], v[128:131], v[64:67]
    v_add_u32 v7, 0xfffe3800, v7
    v_mfma_f32_16x16x32_bf16 v[84:87], v[148:151], v[132:135], v[84:87]
    v_mfma_f32_16x16x32_bf16 v[104:107], v[148:151], v[136:139], v[104:107]
    v_mfma_f32_16x16x32_bf16 v[28:31], v[152:155], v[120:123], v[28:31]
    v_mfma_f32_16x16x32_bf16 v[48:51], v[152:155], v[124:127], v[48:51]
    v_mfma_f32_16x16x32_bf16 v[68:71], v[152:155], v[128:131], v[68:71]
    v_mfma_f32_16x16x32_bf16 v[88:91], v[152:155], v[132:135], v[88:91]
    v_mfma_f32_16x16x32_bf16 v[108:111], v[152:155], v[136:139], v[108:111]
    s_waitcnt lgkmcnt(0)
    s_barrier
    ds_read_b64_tr_b16 v[140:141], v6 offset:0
    v_mfma_f32_16x16x32_bf16 v[16:19], v[180:183], v[160:163], v[16:19]
    ds_read_b64_tr_b16 v[142:143], v6 offset:4608
    v_mfma_f32_16x16x32_bf16 v[36:39], v[180:183], v[164:167], v[36:39]
    ds_read_b128 v[120:123], v4 offset:0
    v_mfma_f32_16x16x32_bf16 v[56:59], v[180:183], v[168:171], v[56:59]
    ds_read_b128 v[124:127], v4 offset:2048
    v_mfma_f32_16x16x32_bf16 v[76:79], v[180:183], v[172:175], v[76:79]
    ds_read_b128 v[128:131], v4 offset:4096
    v_mfma_f32_16x16x32_bf16 v[96:99], v[180:183], v[176:179], v[96:99]
    ds_read_b128 v[132:135], v4 offset:6144
    v_mfma_f32_16x16x32_bf16 v[20:23], v[184:187], v[160:163], v[20:23]
    ds_read_b128 v[136:139], v4 offset:8192
    v_mfma_f32_16x16x32_bf16 v[40:43], v[184:187], v[164:167], v[40:43]
    ds_read_b64_tr_b16 v[144:145], v6 offset:40
    v_mfma_f32_16x16x32_bf16 v[60:63], v[184:187], v[168:171], v[60:63]
    ds_read_b64_tr_b16 v[146:147], v6 offset:4648
    v_mfma_f32_16x16x32_bf16 v[80:83], v[184:187], v[172:175], v[80:83]
    ds_read_b64_tr_b16 v[156:157], v7 offset:0
    v_mfma_f32_16x16x32_bf16 v[100:103], v[184:187], v[176:179], v[100:103]
    ds_read_b64_tr_b16 v[158:159], v7 offset:4608
    v_mfma_f32_16x16x32_bf16 v[32:35], v[196:199], v[160:163], v[32:35]
    ds_read_b64_tr_b16 v[148:149], v6 offset:72
    v_mfma_f32_16x16x32_bf16 v[52:55], v[196:199], v[164:167], v[52:55]
    ds_read_b64_tr_b16 v[150:151], v6 offset:4680
    v_mfma_f32_16x16x32_bf16 v[72:75], v[196:199], v[168:171], v[72:75]
    ds_read_b64_tr_b16 v[152:153], v6 offset:112
    v_mfma_f32_16x16x32_bf16 v[92:95], v[196:199], v[172:175], v[92:95]
    ds_read_b64_tr_b16 v[154:155], v6 offset:4720
    v_mfma_f32_16x16x32_bf16 v[112:115], v[196:199], v[176:179], v[112:115]
    v_mfma_f32_16x16x32_bf16 v[24:27], v[188:191], v[160:163], v[24:27]
    v_mfma_f32_16x16x32_bf16 v[44:47], v[188:191], v[164:167], v[44:47]
    v_mfma_f32_16x16x32_bf16 v[64:67], v[188:191], v[168:171], v[64:67]
    v_mfma_f32_16x16x32_bf16 v[84:87], v[188:191], v[172:175], v[84:87]
    v_mfma_f32_16x16x32_bf16 v[104:107], v[188:191], v[176:179], v[104:107]
    v_mfma_f32_16x16x32_bf16 v[28:31], v[192:195], v[160:163], v[28:31]
    v_mfma_f32_16x16x32_bf16 v[48:51], v[192:195], v[164:167], v[48:51]
    v_mfma_f32_16x16x32_bf16 v[68:71], v[192:195], v[168:171], v[68:71]
    v_mfma_f32_16x16x32_bf16 v[88:91], v[192:195], v[172:175], v[88:91]
    v_mfma_f32_16x16x32_bf16 v[108:111], v[192:195], v[176:179], v[108:111]
    s_waitcnt lgkmcnt(0)
    ds_read_b64_tr_b16 v[180:181], v6 offset:9216
    v_mfma_f32_16x16x32_bf16 v[16:19], v[140:143], v[120:123], v[16:19]
    ds_read_b64_tr_b16 v[182:183], v6 offset:13824
    v_mfma_f32_16x16x32_bf16 v[36:39], v[140:143], v[124:127], v[36:39]
    ds_read_b128 v[160:163], v5 offset:0
    v_mfma_f32_16x16x32_bf16 v[56:59], v[140:143], v[128:131], v[56:59]
    ds_read_b128 v[164:167], v5 offset:2048
    v_mfma_f32_16x16x32_bf16 v[76:79], v[140:143], v[132:135], v[76:79]
    ds_read_b128 v[168:171], v5 offset:4096
    v_mfma_f32_16x16x32_bf16 v[96:99], v[140:143], v[136:139], v[96:99]
    ds_read_b128 v[172:175], v5 offset:6144
    v_mfma_f32_16x16x32_bf16 v[20:23], v[144:147], v[120:123], v[20:23]
    ds_read_b128 v[176:179], v5 offset:8192
    v_mfma_f32_16x16x32_bf16 v[40:43], v[144:147], v[124:127], v[40:43]
    ds_read_b64_tr_b16 v[184:185], v6 offset:9256
    v_mfma_f32_16x16x32_bf16 v[60:63], v[144:147], v[128:131], v[60:63]
    ds_read_b64_tr_b16 v[186:187], v6 offset:13864
    v_mfma_f32_16x16x32_bf16 v[80:83], v[144:147], v[132:135], v[80:83]
    ds_read_b64_tr_b16 v[196:197], v7 offset:9216
    v_mfma_f32_16x16x32_bf16 v[100:103], v[144:147], v[136:139], v[100:103]
    ds_read_b64_tr_b16 v[198:199], v7 offset:13824
    v_mfma_f32_16x16x32_bf16 v[32:35], v[156:159], v[120:123], v[32:35]
    ds_read_b64_tr_b16 v[188:189], v6 offset:9288
    v_mfma_f32_16x16x32_bf16 v[52:55], v[156:159], v[124:127], v[52:55]
    ds_read_b64_tr_b16 v[190:191], v6 offset:13896
    v_mfma_f32_16x16x32_bf16 v[72:75], v[156:159], v[128:131], v[72:75]
    ds_read_b64_tr_b16 v[192:193], v6 offset:9328
    v_mfma_f32_16x16x32_bf16 v[92:95], v[156:159], v[132:135], v[92:95]
    ds_read_b64_tr_b16 v[194:195], v6 offset:13936
    v_mfma_f32_16x16x32_bf16 v[112:115], v[156:159], v[136:139], v[112:115]
    v_add_u32 v4, 0x9800, v4
    v_mfma_f32_16x16x32_bf16 v[24:27], v[148:151], v[120:123], v[24:27]
    v_add_u32 v5, 0x9800, v5
    v_mfma_f32_16x16x32_bf16 v[44:47], v[148:151], v[124:127], v[44:47]
    v_add_u32 v6, 0x9800, v6
    v_mfma_f32_16x16x32_bf16 v[64:67], v[148:151], v[128:131], v[64:67]
    v_add_u32 v7, 0x9800, v7
    v_mfma_f32_16x16x32_bf16 v[84:87], v[148:151], v[132:135], v[84:87]
    v_mfma_f32_16x16x32_bf16 v[104:107], v[148:151], v[136:139], v[104:107]
    v_mfma_f32_16x16x32_bf16 v[28:31], v[152:155], v[120:123], v[28:31]
    v_mfma_f32_16x16x32_bf16 v[48:51], v[152:155], v[124:127], v[48:51]
    v_mfma_f32_16x16x32_bf16 v[68:71], v[152:155], v[128:131], v[68:71]
    v_mfma_f32_16x16x32_bf16 v[88:91], v[152:155], v[132:135], v[88:91]
    v_mfma_f32_16x16x32_bf16 v[108:111], v[152:155], v[136:139], v[108:111]
    s_waitcnt lgkmcnt(0)
    s_barrier
    ds_read_b64_tr_b16 v[140:141], v6 offset:0
    v_mfma_f32_16x16x32_bf16 v[16:19], v[180:183], v[160:163], v[16:19]
    ds_read_b64_tr_b16 v[142:143], v6 offset:4608
    v_mfma_f32_16x16x32_bf16 v[36:39], v[180:183], v[164:167], v[36:39]
    ds_read_b128 v[120:123], v4 offset:0
    v_mfma_f32_16x16x32_bf16 v[56:59], v[180:183], v[168:171], v[56:59]
    ds_read_b128 v[124:127], v4 offset:2048
    v_mfma_f32_16x16x32_bf16 v[76:79], v[180:183], v[172:175], v[76:79]
    ds_read_b128 v[128:131], v4 offset:4096
    v_mfma_f32_16x16x32_bf16 v[96:99], v[180:183], v[176:179], v[96:99]
    ds_read_b128 v[132:135], v4 offset:6144
    v_mfma_f32_16x16x32_bf16 v[20:23], v[184:187], v[160:163], v[20:23]
    ds_read_b128 v[136:139], v4 offset:8192
    v_mfma_f32_16x16x32_bf16 v[40:43], v[184:187], v[164:167], v[40:43]
    ds_read_b64_tr_b16 v[144:145], v6 offset:40
    v_mfma_f32_16x16x32_bf16 v[60:63], v[184:187], v[168:171], v[60:63]
    ds_read_b64_tr_b16 v[146:147], v6 offset:4648
    v_mfma_f32_16x16x32_bf16 v[80:83], v[184:187], v[172:175], v[80:83]
    ds_read_b64_tr_b16 v[156:157], v7 offset:0
    v_mfma_f32_16x16x32_bf16 v[100:103], v[184:187], v[176:179], v[100:103]
    ds_read_b64_tr_b16 v[158:159], v7 offset:4608
    v_mfma_f32_16x16x32_bf16 v[32:35], v[196:199], v[160:163], v[32:35]
    ds_read_b64_tr_b16 v[148:149], v6 offset:72
    v_mfma_f32_16x16x32_bf16 v[52:55], v[196:199], v[164:167], v[52:55]
    ds_read_b64_tr_b16 v[150:151], v6 offset:4680
    v_mfma_f32_16x16x32_bf16 v[72:75], v[196:199], v[168:171], v[72:75]
    ds_read_b64_tr_b16 v[152:153], v6 offset:112
    v_mfma_f32_16x16x32_bf16 v[92:95], v[196:199], v[172:175], v[92:95]
    ds_read_b64_tr_b16 v[154:155], v6 offset:4720
    v_mfma_f32_16x16x32_bf16 v[112:115], v[196:199], v[176:179], v[112:115]
    v_mfma_f32_16x16x32_bf16 v[24:27], v[188:191], v[160:163], v[24:27]
    v_mfma_f32_16x16x32_bf16 v[44:47], v[188:191], v[164:167], v[44:47]
    v_mfma_f32_16x16x32_bf16 v[64:67], v[188:191], v[168:171], v[64:67]
    v_mfma_f32_16x16x32_bf16 v[84:87], v[188:191], v[172:175], v[84:87]
    v_mfma_f32_16x16x32_bf16 v[104:107], v[188:191], v[176:179], v[104:107]
    v_mfma_f32_16x16x32_bf16 v[28:31], v[192:195], v[160:163], v[28:31]
    v_mfma_f32_16x16x32_bf16 v[48:51], v[192:195], v[164:167], v[48:51]
    v_mfma_f32_16x16x32_bf16 v[68:71], v[192:195], v[168:171], v[68:71]
    v_mfma_f32_16x16x32_bf16 v[88:91], v[192:195], v[172:175], v[88:91]
    v_mfma_f32_16x16x32_bf16 v[108:111], v[192:195], v[176:179], v[108:111]
    s_waitcnt lgkmcnt(0)
    ds_read_b64_tr_b16 v[180:181], v6 offset:9216
    v_mfma_f32_16x16x32_bf16 v[16:19], v[140:143], v[120:123], v[16:19]
    ds_read_b64_tr_b16 v[182:183], v6 offset:13824
    v_mfma_f32_16x16x32_bf16 v[36:39], v[140:143], v[124:127], v[36:39]
    ds_read_b128 v[160:163], v5 offset:0
    v_mfma_f32_16x16x32_bf16 v[56:59], v[140:143], v[128:131], v[56:59]
    ds_read_b128 v[164:167], v5 offset:2048
    v_mfma_f32_16x16x32_bf16 v[76:79], v[140:143], v[132:135], v[76:79]
    ds_read_b128 v[168:171], v5 offset:4096
    v_mfma_f32_16x16x32_bf16 v[96:99], v[140:143], v[136:139], v[96:99]
    ds_read_b128 v[172:175], v5 offset:6144
    v_mfma_f32_16x16x32_bf16 v[20:23], v[144:147], v[120:123], v[20:23]
    ds_read_b128 v[176:179], v5 offset:8192
    v_mfma_f32_16x16x32_bf16 v[40:43], v[144:147], v[124:127], v[40:43]
    ds_read_b64_tr_b16 v[184:185], v6 offset:9256
    v_mfma_f32_16x16x32_bf16 v[60:63], v[144:147], v[128:131], v[60:63]
    ds_read_b64_tr_b16 v[186:187], v6 offset:13864
    v_mfma_f32_16x16x32_bf16 v[80:83], v[144:147], v[132:135], v[80:83]
    ds_read_b64_tr_b16 v[196:197], v7 offset:9216
    v_mfma_f32_16x16x32_bf16 v[100:103], v[144:147], v[136:139], v[100:103]
    ds_read_b64_tr_b16 v[198:199], v7 offset:13824
    v_mfma_f32_16x16x32_bf16 v[32:35], v[156:159], v[120:123], v[32:35]
    ds_read_b64_tr_b16 v[188:189], v6 offset:9288
    v_mfma_f32_16x16x32_bf16 v[52:55], v[156:159], v[124:127], v[52:55]
    ds_read_b64_tr_b16 v[190:191], v6 offset:13896
    v_mfma_f32_16x16x32_bf16 v[72:75], v[156:159], v[128:131], v[72:75]
    ds_read_b64_tr_b16 v[192:193], v6 offset:9328
    v_mfma_f32_16x16x32_bf16 v[92:95], v[156:159], v[132:135], v[92:95]
    ds_read_b64_tr_b16 v[194:195], v6 offset:13936
    v_mfma_f32_16x16x32_bf16 v[112:115], v[156:159], v[136:139], v[112:115]
    v_add_u32 v4, 0x9800, v4
    v_mfma_f32_16x16x32_bf16 v[24:27], v[148:151], v[120:123], v[24:27]
    v_add_u32 v5, 0x9800, v5
    v_mfma_f32_16x16x32_bf16 v[44:47], v[148:151], v[124:127], v[44:47]
    v_add_u32 v6, 0x9800, v6
    v_mfma_f32_16x16x32_bf16 v[64:67], v[148:151], v[128:131], v[64:67]
    v_add_u32 v7, 0x9800, v7
    v_mfma_f32_16x16x32_bf16 v[84:87], v[148:151], v[132:135], v[84:87]
    v_mfma_f32_16x16x32_bf16 v[104:107], v[148:151], v[136:139], v[104:107]
    v_mfma_f32_16x16x32_bf16 v[28:31], v[152:155], v[120:123], v[28:31]
    v_mfma_f32_16x16x32_bf16 v[48:51], v[152:155], v[124:127], v[48:51]
    v_mfma_f32_16x16x32_bf16 v[68:71], v[152:155], v[128:131], v[68:71]
    v_mfma_f32_16x16x32_bf16 v[88:91], v[152:155], v[132:135], v[88:91]
    v_mfma_f32_16x16x32_bf16 v[108:111], v[152:155], v[136:139], v[108:111]
    s_waitcnt lgkmcnt(0)
    s_barrier
    ds_read_b64_tr_b16 v[140:141], v6 offset:0
    v_mfma_f32_16x16x32_bf16 v[16:19], v[180:183], v[160:163], v[16:19]
    ds_read_b64_tr_b16 v[142:143], v6 offset:4608
    v_mfma_f32_16x16x32_bf16 v[36:39], v[180:183], v[164:167], v[36:39]
    ds_read_b128 v[120:123], v4 offset:0
    v_mfma_f32_16x16x32_bf16 v[56:59], v[180:183], v[168:171], v[56:59]
    ds_read_b128 v[124:127], v4 offset:2048
    v_mfma_f32_16x16x32_bf16 v[76:79], v[180:183], v[172:175], v[76:79]
    ds_read_b128 v[128:131], v4 offset:4096
    v_mfma_f32_16x16x32_bf16 v[96:99], v[180:183], v[176:179], v[96:99]
    ds_read_b128 v[132:135], v4 offset:6144
    v_mfma_f32_16x16x32_bf16 v[20:23], v[184:187], v[160:163], v[20:23]
    ds_read_b128 v[136:139], v4 offset:8192
    v_mfma_f32_16x16x32_bf16 v[40:43], v[184:187], v[164:167], v[40:43]
    ds_read_b64_tr_b16 v[144:145], v6 offset:40
    v_mfma_f32_16x16x32_bf16 v[60:63], v[184:187], v[168:171], v[60:63]
    ds_read_b64_tr_b16 v[146:147], v6 offset:4648
    v_mfma_f32_16x16x32_bf16 v[80:83], v[184:187], v[172:175], v[80:83]
    ds_read_b64_tr_b16 v[156:157], v7 offset:0
    v_mfma_f32_16x16x32_bf16 v[100:103], v[184:187], v[176:179], v[100:103]
    ds_read_b64_tr_b16 v[158:159], v7 offset:4608
    v_mfma_f32_16x16x32_bf16 v[32:35], v[196:199], v[160:163], v[32:35]
    ds_read_b64_tr_b16 v[148:149], v6 offset:72
    v_mfma_f32_16x16x32_bf16 v[52:55], v[196:199], v[164:167], v[52:55]
    ds_read_b64_tr_b16 v[150:151], v6 offset:4680
    v_mfma_f32_16x16x32_bf16 v[72:75], v[196:199], v[168:171], v[72:75]
    ds_read_b64_tr_b16 v[152:153], v6 offset:112
    v_mfma_f32_16x16x32_bf16 v[92:95], v[196:199], v[172:175], v[92:95]
    ds_read_b64_tr_b16 v[154:155], v6 offset:4720
    v_mfma_f32_16x16x32_bf16 v[112:115], v[196:199], v[176:179], v[112:115]
    v_mfma_f32_16x16x32_bf16 v[24:27], v[188:191], v[160:163], v[24:27]
    v_mfma_f32_16x16x32_bf16 v[44:47], v[188:191], v[164:167], v[44:47]
    v_mfma_f32_16x16x32_bf16 v[64:67], v[188:191], v[168:171], v[64:67]
    v_mfma_f32_16x16x32_bf16 v[84:87], v[188:191], v[172:175], v[84:87]
    v_mfma_f32_16x16x32_bf16 v[104:107], v[188:191], v[176:179], v[104:107]
    v_mfma_f32_16x16x32_bf16 v[28:31], v[192:195], v[160:163], v[28:31]
    v_mfma_f32_16x16x32_bf16 v[48:51], v[192:195], v[164:167], v[48:51]
    v_mfma_f32_16x16x32_bf16 v[68:71], v[192:195], v[168:171], v[68:71]
    v_mfma_f32_16x16x32_bf16 v[88:91], v[192:195], v[172:175], v[88:91]
    v_mfma_f32_16x16x32_bf16 v[108:111], v[192:195], v[176:179], v[108:111]
    s_waitcnt lgkmcnt(0)
    ds_read_b64_tr_b16 v[180:181], v6 offset:9216
    v_mfma_f32_16x16x32_bf16 v[16:19], v[140:143], v[120:123], v[16:19]
    ds_read_b64_tr_b16 v[182:183], v6 offset:13824
    v_mfma_f32_16x16x32_bf16 v[36:39], v[140:143], v[124:127], v[36:39]
    ds_read_b128 v[160:163], v5 offset:0
    v_mfma_f32_16x16x32_bf16 v[56:59], v[140:143], v[128:131], v[56:59]
    ds_read_b128 v[164:167], v5 offset:2048
    v_mfma_f32_16x16x32_bf16 v[76:79], v[140:143], v[132:135], v[76:79]
    ds_read_b128 v[168:171], v5 offset:4096
    v_mfma_f32_16x16x32_bf16 v[96:99], v[140:143], v[136:139], v[96:99]
    ds_read_b128 v[172:175], v5 offset:6144
    v_mfma_f32_16x16x32_bf16 v[20:23], v[144:147], v[120:123], v[20:23]
    ds_read_b128 v[176:179], v5 offset:8192
    v_mfma_f32_16x16x32_bf16 v[40:43], v[144:147], v[124:127], v[40:43]
    ds_read_b64_tr_b16 v[184:185], v6 offset:9256
    v_mfma_f32_16x16x32_bf16 v[60:63], v[144:147], v[128:131], v[60:63]
    ds_read_b64_tr_b16 v[186:187], v6 offset:13864
    v_mfma_f32_16x16x32_bf16 v[80:83], v[144:147], v[132:135], v[80:83]
    ds_read_b64_tr_b16 v[196:197], v7 offset:9216
    v_mfma_f32_16x16x32_bf16 v[100:103], v[144:147], v[136:139], v[100:103]
    ds_read_b64_tr_b16 v[198:199], v7 offset:13824
    v_mfma_f32_16x16x32_bf16 v[32:35], v[156:159], v[120:123], v[32:35]
    ds_read_b64_tr_b16 v[188:189], v6 offset:9288
    v_mfma_f32_16x16x32_bf16 v[52:55], v[156:159], v[124:127], v[52:55]
    ds_read_b64_tr_b16 v[190:191], v6 offset:13896
    v_mfma_f32_16x16x32_bf16 v[72:75], v[156:159], v[128:131], v[72:75]
    ds_read_b64_tr_b16 v[192:193], v6 offset:9328
    v_mfma_f32_16x16x32_bf16 v[92:95], v[156:159], v[132:135], v[92:95]
    ds_read_b64_tr_b16 v[194:195], v6 offset:13936
    v_mfma_f32_16x16x32_bf16 v[112:115], v[156:159], v[136:139], v[112:115]
    v_add_u32 v4, 0x9800, v4
    v_mfma_f32_16x16x32_bf16 v[24:27], v[148:151], v[120:123], v[24:27]
    v_add_u32 v5, 0x9800, v5
    v_mfma_f32_16x16x32_bf16 v[44:47], v[148:151], v[124:127], v[44:47]
    v_add_u32 v6, 0x9800, v6
    v_mfma_f32_16x16x32_bf16 v[64:67], v[148:151], v[128:131], v[64:67]
    v_add_u32 v7, 0x9800, v7
    v_mfma_f32_16x16x32_bf16 v[84:87], v[148:151], v[132:135], v[84:87]
    v_mfma_f32_16x16x32_bf16 v[104:107], v[148:151], v[136:139], v[104:107]
    v_mfma_f32_16x16x32_bf16 v[28:31], v[152:155], v[120:123], v[28:31]
    v_mfma_f32_16x16x32_bf16 v[48:51], v[152:155], v[124:127], v[48:51]
    v_mfma_f32_16x16x32_bf16 v[68:71], v[152:155], v[128:131], v[68:71]
    v_mfma_f32_16x16x32_bf16 v[88:91], v[152:155], v[132:135], v[88:91]
    v_mfma_f32_16x16x32_bf16 v[108:111], v[152:155], v[136:139], v[108:111]
    s_waitcnt lgkmcnt(0)
    s_barrier
    ds_read_b64_tr_b16 v[140:141], v6 offset:0
    v_mfma_f32_16x16x32_bf16 v[16:19], v[180:183], v[160:163], v[16:19]
    ds_read_b64_tr_b16 v[142:143], v6 offset:4608
    v_mfma_f32_16x16x32_bf16 v[36:39], v[180:183], v[164:167], v[36:39]
    ds_read_b128 v[120:123], v4 offset:0
    v_mfma_f32_16x16x32_bf16 v[56:59], v[180:183], v[168:171], v[56:59]
    ds_read_b128 v[124:127], v4 offset:2048
    v_mfma_f32_16x16x32_bf16 v[76:79], v[180:183], v[172:175], v[76:79]
    ds_read_b128 v[128:131], v4 offset:4096
    v_mfma_f32_16x16x32_bf16 v[96:99], v[180:183], v[176:179], v[96:99]
    ds_read_b128 v[132:135], v4 offset:6144
    v_mfma_f32_16x16x32_bf16 v[20:23], v[184:187], v[160:163], v[20:23]
    ds_read_b128 v[136:139], v4 offset:8192
    v_mfma_f32_16x16x32_bf16 v[40:43], v[184:187], v[164:167], v[40:43]
    ds_read_b64_tr_b16 v[144:145], v6 offset:40
    v_mfma_f32_16x16x32_bf16 v[60:63], v[184:187], v[168:171], v[60:63]
    ds_read_b64_tr_b16 v[146:147], v6 offset:4648
    v_mfma_f32_16x16x32_bf16 v[80:83], v[184:187], v[172:175], v[80:83]
    ds_read_b64_tr_b16 v[156:157], v7 offset:0
    v_mfma_f32_16x16x32_bf16 v[100:103], v[184:187], v[176:179], v[100:103]
    ds_read_b64_tr_b16 v[158:159], v7 offset:4608
    v_mfma_f32_16x16x32_bf16 v[32:35], v[196:199], v[160:163], v[32:35]
    ds_read_b64_tr_b16 v[148:149], v6 offset:72
    v_mfma_f32_16x16x32_bf16 v[52:55], v[196:199], v[164:167], v[52:55]
    ds_read_b64_tr_b16 v[150:151], v6 offset:4680
    v_mfma_f32_16x16x32_bf16 v[72:75], v[196:199], v[168:171], v[72:75]
    ds_read_b64_tr_b16 v[152:153], v6 offset:112
    v_mfma_f32_16x16x32_bf16 v[92:95], v[196:199], v[172:175], v[92:95]
    ds_read_b64_tr_b16 v[154:155], v6 offset:4720
    v_mfma_f32_16x16x32_bf16 v[112:115], v[196:199], v[176:179], v[112:115]
    v_mfma_f32_16x16x32_bf16 v[24:27], v[188:191], v[160:163], v[24:27]
    v_mfma_f32_16x16x32_bf16 v[44:47], v[188:191], v[164:167], v[44:47]
    v_mfma_f32_16x16x32_bf16 v[64:67], v[188:191], v[168:171], v[64:67]
    v_mfma_f32_16x16x32_bf16 v[84:87], v[188:191], v[172:175], v[84:87]
    v_mfma_f32_16x16x32_bf16 v[104:107], v[188:191], v[176:179], v[104:107]
    v_mfma_f32_16x16x32_bf16 v[28:31], v[192:195], v[160:163], v[28:31]
    v_mfma_f32_16x16x32_bf16 v[48:51], v[192:195], v[164:167], v[48:51]
    v_mfma_f32_16x16x32_bf16 v[68:71], v[192:195], v[168:171], v[68:71]
    v_mfma_f32_16x16x32_bf16 v[88:91], v[192:195], v[172:175], v[88:91]
    v_mfma_f32_16x16x32_bf16 v[108:111], v[192:195], v[176:179], v[108:111]
    s_waitcnt lgkmcnt(0)
    ds_read_b64_tr_b16 v[180:181], v6 offset:9216
    v_mfma_f32_16x16x32_bf16 v[16:19], v[140:143], v[120:123], v[16:19]
    ds_read_b64_tr_b16 v[182:183], v6 offset:13824
    v_mfma_f32_16x16x32_bf16 v[36:39], v[140:143], v[124:127], v[36:39]
    ds_read_b128 v[160:163], v5 offset:0
    v_mfma_f32_16x16x32_bf16 v[56:59], v[140:143], v[128:131], v[56:59]
    ds_read_b128 v[164:167], v5 offset:2048
    v_mfma_f32_16x16x32_bf16 v[76:79], v[140:143], v[132:135], v[76:79]
    ds_read_b128 v[168:171], v5 offset:4096
    v_mfma_f32_16x16x32_bf16 v[96:99], v[140:143], v[136:139], v[96:99]
    ds_read_b128 v[172:175], v5 offset:6144
    v_mfma_f32_16x16x32_bf16 v[20:23], v[144:147], v[120:123], v[20:23]
    ds_read_b128 v[176:179], v5 offset:8192
    v_mfma_f32_16x16x32_bf16 v[40:43], v[144:147], v[124:127], v[40:43]
    ds_read_b64_tr_b16 v[184:185], v6 offset:9256
    v_mfma_f32_16x16x32_bf16 v[60:63], v[144:147], v[128:131], v[60:63]
    ds_read_b64_tr_b16 v[186:187], v6 offset:13864
    v_mfma_f32_16x16x32_bf16 v[80:83], v[144:147], v[132:135], v[80:83]
    ds_read_b64_tr_b16 v[196:197], v7 offset:9216
    v_mfma_f32_16x16x32_bf16 v[100:103], v[144:147], v[136:139], v[100:103]
    ds_read_b64_tr_b16 v[198:199], v7 offset:13824
    v_mfma_f32_16x16x32_bf16 v[32:35], v[156:159], v[120:123], v[32:35]
    ds_read_b64_tr_b16 v[188:189], v6 offset:9288
    v_mfma_f32_16x16x32_bf16 v[52:55], v[156:159], v[124:127], v[52:55]
    ds_read_b64_tr_b16 v[190:191], v6 offset:13896
    v_mfma_f32_16x16x32_bf16 v[72:75], v[156:159], v[128:131], v[72:75]
    ds_read_b64_tr_b16 v[192:193], v6 offset:9328
    v_mfma_f32_16x16x32_bf16 v[92:95], v[156:159], v[132:135], v[92:95]
    ds_read_b64_tr_b16 v[194:195], v6 offset:13936
    v_mfma_f32_16x16x32_bf16 v[112:115], v[156:159], v[136:139], v[112:115]
    v_add_u32 v4, 0xfffe3800, v4
    v_mfma_f32_16x16x32_bf16 v[24:27], v[148:151], v[120:123], v[24:27]
    v_add_u32 v5, 0xfffe3800, v5
    v_mfma_f32_16x16x32_bf16 v[44:47], v[148:151], v[124:127], v[44:47]
    v_add_u32 v6, 0xfffe3800, v6
    v_mfma_f32_16x16x32_bf16 v[64:67], v[148:151], v[128:131], v[64:67]
    v_add_u32 v7, 0xfffe3800, v7
    v_mfma_f32_16x16x32_bf16 v[84:87], v[148:151], v[132:135], v[84:87]
    v_mfma_f32_16x16x32_bf16 v[104:107], v[148:151], v[136:139], v[104:107]
    v_mfma_f32_16x16x32_bf16 v[28:31], v[152:155], v[120:123], v[28:31]
    v_mfma_f32_16x16x32_bf16 v[48:51], v[152:155], v[124:127], v[48:51]
    v_mfma_f32_16x16x32_bf16 v[68:71], v[152:155], v[128:131], v[68:71]
    v_mfma_f32_16x16x32_bf16 v[88:91], v[152:155], v[132:135], v[88:91]
    v_mfma_f32_16x16x32_bf16 v[108:111], v[152:155], v[136:139], v[108:111]
    s_waitcnt lgkmcnt(0)
    s_barrier
    ds_read_b64_tr_b16 v[140:141], v6 offset:0
    v_mfma_f32_16x16x32_bf16 v[16:19], v[180:183], v[160:163], v[16:19]
    ds_read_b64_tr_b16 v[142:143], v6 offset:4608
    v_mfma_f32_16x16x32_bf16 v[36:39], v[180:183], v[164:167], v[36:39]
    ds_read_b128 v[120:123], v4 offset:0
    v_mfma_f32_16x16x32_bf16 v[56:59], v[180:183], v[168:171], v[56:59]
    ds_read_b128 v[124:127], v4 offset:2048
    v_mfma_f32_16x16x32_bf16 v[76:79], v[180:183], v[172:175], v[76:79]
    ds_read_b128 v[128:131], v4 offset:4096
    v_mfma_f32_16x16x32_bf16 v[96:99], v[180:183], v[176:179], v[96:99]
    ds_read_b128 v[132:135], v4 offset:6144
    v_mfma_f32_16x16x32_bf16 v[20:23], v[184:187], v[160:163], v[20:23]
    ds_read_b128 v[136:139], v4 offset:8192
    v_mfma_f32_16x16x32_bf16 v[40:43], v[184:187], v[164:167], v[40:43]
    ds_read_b64_tr_b16 v[144:145], v6 offset:40
    v_mfma_f32_16x16x32_bf16 v[60:63], v[184:187], v[168:171], v[60:63]
    ds_read_b64_tr_b16 v[146:147], v6 offset:4648
    v_mfma_f32_16x16x32_bf16 v[80:83], v[184:187], v[172:175], v[80:83]
    ds_read_b64_tr_b16 v[156:157], v7 offset:0
    v_mfma_f32_16x16x32_bf16 v[100:103], v[184:187], v[176:179], v[100:103]
    ds_read_b64_tr_b16 v[158:159], v7 offset:4608
    v_mfma_f32_16x16x32_bf16 v[32:35], v[196:199], v[160:163], v[32:35]
    ds_read_b64_tr_b16 v[148:149], v6 offset:72
    v_mfma_f32_16x16x32_bf16 v[52:55], v[196:199], v[164:167], v[52:55]
    ds_read_b64_tr_b16 v[150:151], v6 offset:4680
    v_mfma_f32_16x16x32_bf16 v[72:75], v[196:199], v[168:171], v[72:75]
    ds_read_b64_tr_b16 v[152:153], v6 offset:112
    v_mfma_f32_16x16x32_bf16 v[92:95], v[196:199], v[172:175], v[92:95]
    ds_read_b64_tr_b16 v[154:155], v6 offset:4720
    v_mfma_f32_16x16x32_bf16 v[112:115], v[196:199], v[176:179], v[112:115]
    v_mfma_f32_16x16x32_bf16 v[24:27], v[188:191], v[160:163], v[24:27]
    v_mfma_f32_16x16x32_bf16 v[44:47], v[188:191], v[164:167], v[44:47]
    v_mfma_f32_16x16x32_bf16 v[64:67], v[188:191], v[168:171], v[64:67]
    v_mfma_f32_16x16x32_bf16 v[84:87], v[188:191], v[172:175], v[84:87]
    v_mfma_f32_16x16x32_bf16 v[104:107], v[188:191], v[176:179], v[104:107]
    v_mfma_f32_16x16x32_bf16 v[28:31], v[192:195], v[160:163], v[28:31]
    v_mfma_f32_16x16x32_bf16 v[48:51], v[192:195], v[164:167], v[48:51]
    v_mfma_f32_16x16x32_bf16 v[68:71], v[192:195], v[168:171], v[68:71]
    v_mfma_f32_16x16x32_bf16 v[88:91], v[192:195], v[172:175], v[88:91]
    v_mfma_f32_16x16x32_bf16 v[108:111], v[192:195], v[176:179], v[108:111]
    s_waitcnt lgkmcnt(0)
    ds_read_b64_tr_b16 v[180:181], v6 offset:9216
    ds_read_b64_tr_b16 v[182:183], v6 offset:13824
    v_mfma_f32_16x16x32_bf16 v[16:19], v[140:143], v[120:123], v[16:19]
    ds_read_b128 v[160:163], v5 offset:0
    ds_read_b128 v[164:167], v5 offset:2048
    v_mfma_f32_16x16x32_bf16 v[20:23], v[144:147], v[120:123], v[20:23]
    ds_read_b128 v[168:171], v5 offset:4096
    ds_read_b128 v[172:175], v5 offset:6144
    v_mfma_f32_16x16x32_bf16 v[32:35], v[156:159], v[120:123], v[32:35]
    ds_read_b128 v[176:179], v5 offset:8192
    ds_read_b64_tr_b16 v[184:185], v6 offset:9256
    v_mfma_f32_16x16x32_bf16 v[24:27], v[148:151], v[120:123], v[24:27]
    ds_read_b64_tr_b16 v[186:187], v6 offset:13864
    ds_read_b64_tr_b16 v[196:197], v7 offset:9216
    v_mfma_f32_16x16x32_bf16 v[28:31], v[152:155], v[120:123], v[28:31]
    ds_read_b64_tr_b16 v[198:199], v7 offset:13824
    ds_read_b64_tr_b16 v[188:189], v6 offset:9288
    v_mfma_f32_16x16x32_bf16 v[36:39], v[140:143], v[124:127], v[36:39]
    ds_read_b64_tr_b16 v[190:191], v6 offset:13896
    ds_read_b64_tr_b16 v[192:193], v6 offset:9328
    v_mfma_f32_16x16x32_bf16 v[40:43], v[144:147], v[124:127], v[40:43]
    ds_read_b64_tr_b16 v[194:195], v6 offset:13936
    v_mfma_f32_16x16x32_bf16 v[52:55], v[156:159], v[124:127], v[52:55]
    v_mfma_f32_16x16x32_bf16 v[44:47], v[148:151], v[124:127], v[44:47]
    v_mfma_f32_16x16x32_bf16 v[48:51], v[152:155], v[124:127], v[48:51]
    s_waitcnt lgkmcnt(0)
    s_barrier
    v_mfma_f32_16x16x32_bf16 v[16:19], v[180:183], v[160:163], v[16:19]
    v_mfma_f32_16x16x32_bf16 v[20:23], v[184:187], v[160:163], v[20:23]
    v_mfma_f32_16x16x32_bf16 v[32:35], v[196:199], v[160:163], v[32:35]
    v_mfma_f32_16x16x32_bf16 v[24:27], v[188:191], v[160:163], v[24:27]
    v_mfma_f32_16x16x32_bf16 v[28:31], v[192:195], v[160:163], v[28:31]
    v_mfma_f32_16x16x32_bf16 v[36:39], v[180:183], v[164:167], v[36:39]
    v_mfma_f32_16x16x32_bf16 v[40:43], v[184:187], v[164:167], v[40:43]
    v_mfma_f32_16x16x32_bf16 v[52:55], v[196:199], v[164:167], v[52:55]
    s_nop 0
    v_fma_f32 v200, v16, s40, v250
    v_fma_f32 v201, v17, s40, v250
    v_mfma_f32_16x16x32_bf16 v[44:47], v[188:191], v[164:167], v[44:47]
    v_fma_f32 v202, v18, s40, v250
    v_fma_f32 v203, v19, s40, v250
    v_mfma_f32_16x16x32_bf16 v[48:51], v[192:195], v[164:167], v[48:51]
    v_exp_f32_e64 v200, v200 clamp
    v_mfma_f32_16x16x32_bf16 v[56:59], v[140:143], v[128:131], v[56:59]
    v_exp_f32_e64 v201, v201 clamp
    v_mfma_f32_16x16x32_bf16 v[60:63], v[144:147], v[128:131], v[60:63]
    v_exp_f32_e64 v202, v202 clamp
    v_mfma_f32_16x16x32_bf16 v[72:75], v[156:159], v[128:131], v[72:75]
    v_exp_f32_e64 v203, v203 clamp
    v_mfma_f32_16x16x32_bf16 v[64:67], v[148:151], v[128:131], v[64:67]
    v_add_f32 v200, v252, v200
    v_add_f32 v201, v252, v201
    v_mfma_f32_16x16x32_bf16 v[68:71], v[152:155], v[128:131], v[68:71]
    v_add_f32 v202, v252, v202
    v_add_f32 v203, v252, v203
    v_mfma_f32_16x16x32_bf16 v[56:59], v[180:183], v[168:171], v[56:59]
    v_max_f32 v200, v200, v16
    v_max_f32 v201, v201, v17
    v_mfma_f32_16x16x32_bf16 v[60:63], v[184:187], v[168:171], v[60:63]
    v_max_f32 v202, v202, v18
    v_max_f32 v203, v203, v19
    v_mfma_f32_16x16x32_bf16 v[72:75], v[196:199], v[168:171], v[72:75]
    v_cvt_pk_bf16_f32 v208, v200, v201
    v_cvt_pk_bf16_f32 v209, v202, v203
    v_mfma_f32_16x16x32_bf16 v[64:67], v[188:191], v[168:171], v[64:67]
    v_fma_f32 v204, v20, s40, v250
    v_fma_f32 v205, v21, s40, v250
    v_mfma_f32_16x16x32_bf16 v[68:71], v[192:195], v[168:171], v[68:71]
    v_fma_f32 v206, v22, s40, v250
    v_fma_f32 v207, v23, s40, v250
    v_mfma_f32_16x16x32_bf16 v[76:79], v[140:143], v[132:135], v[76:79]
    v_exp_f32_e64 v204, v204 clamp
    v_mfma_f32_16x16x32_bf16 v[80:83], v[144:147], v[132:135], v[80:83]
    v_exp_f32_e64 v205, v205 clamp
    v_mfma_f32_16x16x32_bf16 v[92:95], v[156:159], v[132:135], v[92:95]
    v_exp_f32_e64 v206, v206 clamp
    v_mfma_f32_16x16x32_bf16 v[84:87], v[148:151], v[132:135], v[84:87]
    v_exp_f32_e64 v207, v207 clamp
    v_mfma_f32_16x16x32_bf16 v[88:91], v[152:155], v[132:135], v[88:91]
    v_add_f32 v204, v252, v204
    v_add_f32 v205, v252, v205
    v_mfma_f32_16x16x32_bf16 v[76:79], v[180:183], v[172:175], v[76:79]
    v_add_f32 v206, v252, v206
    v_add_f32 v207, v252, v207
    v_mfma_f32_16x16x32_bf16 v[80:83], v[184:187], v[172:175], v[80:83]
    v_max_f32 v204, v204, v20
    v_max_f32 v205, v205, v21
    v_mfma_f32_16x16x32_bf16 v[92:95], v[196:199], v[172:175], v[92:95]
    v_max_f32 v206, v206, v22
    v_max_f32 v207, v207, v23
    v_mfma_f32_16x16x32_bf16 v[84:87], v[188:191], v[172:175], v[84:87]
    v_cvt_pk_bf16_f32 v210, v204, v205
    v_cvt_pk_bf16_f32 v211, v206, v207
    v_mfma_f32_16x16x32_bf16 v[88:91], v[192:195], v[172:175], v[88:91]
    buffer_store_dwordx4 v[208:211], v8, s[44:47], s37 offen sc1
    v_fma_f32 v200, v32, s40, v250
    v_mfma_f32_16x16x32_bf16 v[96:99], v[140:143], v[136:139], v[96:99]
    v_fma_f32 v201, v33, s40, v250
    v_fma_f32 v202, v34, s40, v250
    v_mfma_f32_16x16x32_bf16 v[100:103], v[144:147], v[136:139], v[100:103]
    v_fma_f32 v203, v35, s40, v250
    v_exp_f32_e64 v200, v200 clamp
    v_mfma_f32_16x16x32_bf16 v[112:115], v[156:159], v[136:139], v[112:115]
    v_exp_f32_e64 v201, v201 clamp
    v_mfma_f32_16x16x32_bf16 v[104:107], v[148:151], v[136:139], v[104:107]
    v_exp_f32_e64 v202, v202 clamp
    v_mfma_f32_16x16x32_bf16 v[108:111], v[152:155], v[136:139], v[108:111]
    v_exp_f32_e64 v203, v203 clamp
    v_mfma_f32_16x16x32_bf16 v[96:99], v[180:183], v[176:179], v[96:99]
    v_add_f32 v200, v252, v200
    v_add_f32 v201, v252, v201
    v_mfma_f32_16x16x32_bf16 v[100:103], v[184:187], v[176:179], v[100:103]
    v_add_f32 v202, v252, v202
    v_add_f32 v203, v252, v203
    v_mfma_f32_16x16x32_bf16 v[112:115], v[196:199], v[176:179], v[112:115]
    v_max_f32 v200, v200, v32
    v_max_f32 v201, v201, v33
    v_mfma_f32_16x16x32_bf16 v[104:107], v[188:191], v[176:179], v[104:107]
    v_max_f32 v202, v202, v34
    v_max_f32 v203, v203, v35
    v_mfma_f32_16x16x32_bf16 v[108:111], v[192:195], v[176:179], v[108:111]
    v_cvt_pk_bf16_f32 v216, v200, v201
    v_cvt_pk_bf16_f32 v217, v202, v203
    s_mov_b32 exec_hi, 0
    buffer_store_dwordx2 v[216:217], v9, s[48:51], s39 offen sc1
    s_mov_b32 exec_hi, -1
    v_pk_fma_f32 v[204:205], v[24:25], s[40:41], v[250:251]
    v_pk_fma_f32 v[206:207], v[26:27], s[40:41], v[250:251]
    v_exp_f32_e64 v204, v204 clamp
    v_exp_f32_e64 v205, v205 clamp
    v_exp_f32_e64 v206, v206 clamp
    v_exp_f32_e64 v207, v207 clamp
    v_pk_add_f32 v[204:205], v[204:205], v[252:253]
    v_pk_add_f32 v[206:207], v[206:207], v[252:253]
    v_max_f32 v204, v204, v24
    v_max_f32 v205, v205, v25
    v_max_f32 v206, v206, v26
    v_max_f32 v207, v207, v27
    v_cvt_pk_bf16_f32 v212, v204, v205
    v_cvt_pk_bf16_f32 v213, v206, v207
    v_pk_fma_f32 v[200:201], v[28:29], s[40:41], v[250:251]
    v_pk_fma_f32 v[202:203], v[30:31], s[40:41], v[250:251]
    v_exp_f32_e64 v200, v200 clamp
    v_exp_f32_e64 v201, v201 clamp
    v_exp_f32_e64 v202, v202 clamp
    v_exp_f32_e64 v203, v203 clamp
    v_pk_add_f32 v[200:201], v[200:201], v[252:253]
    v_pk_add_f32 v[202:203], v[202:203], v[252:253]
    v_max_f32 v200, v200, v28
    v_max_f32 v201, v201, v29
    v_max_f32 v202, v202, v30
    v_max_f32 v203, v203, v31
    v_cvt_pk_bf16_f32 v214, v200, v201
    v_cvt_pk_bf16_f32 v215, v202, v203
    buffer_store_dwordx4 v[212:215], v8, s[44:47], s37 offen offset:1024 sc1
    s_add_u32 s37, s37, 16384
    s_add_u32 s39, s39, 2048
    v_pk_fma_f32 v[200:201], v[36:37], s[40:41], v[250:251]
    v_pk_fma_f32 v[202:203], v[38:39], s[40:41], v[250:251]
    v_exp_f32_e64 v200, v200 clamp
    v_exp_f32_e64 v201, v201 clamp
    v_exp_f32_e64 v202, v202 clamp
    v_exp_f32_e64 v203, v203 clamp
    v_pk_add_f32 v[200:201], v[200:201], v[252:253]
    v_pk_add_f32 v[202:203], v[202:203], v[252:253]
    v_max_f32 v200, v200, v36
    v_max_f32 v201, v201, v37
    v_max_f32 v202, v202, v38
    v_max_f32 v203, v203, v39
    v_cvt_pk_bf16_f32 v220, v200, v201
    v_cvt_pk_bf16_f32 v221, v202, v203
    v_pk_fma_f32 v[204:205], v[40:41], s[40:41], v[250:251]
    v_pk_fma_f32 v[206:207], v[42:43], s[40:41], v[250:251]
    v_exp_f32_e64 v204, v204 clamp
    v_exp_f32_e64 v205, v205 clamp
    v_exp_f32_e64 v206, v206 clamp
    v_exp_f32_e64 v207, v207 clamp
    v_pk_add_f32 v[204:205], v[204:205], v[252:253]
    v_pk_add_f32 v[206:207], v[206:207], v[252:253]
    v_max_f32 v204, v204, v40
    v_max_f32 v205, v205, v41
    v_max_f32 v206, v206, v42
    v_max_f32 v207, v207, v43
    v_cvt_pk_bf16_f32 v222, v204, v205
    v_cvt_pk_bf16_f32 v223, v206, v207
    buffer_store_dwordx4 v[220:223], v8, s[44:47], s37 offen sc1
    v_pk_fma_f32 v[200:201], v[52:53], s[40:41], v[250:251]
    v_pk_fma_f32 v[202:203], v[54:55], s[40:41], v[250:251]
    v_exp_f32_e64 v200, v200 clamp
    v_exp_f32_e64 v201, v201 clamp
    v_exp_f32_e64 v202, v202 clamp
    v_exp_f32_e64 v203, v203 clamp
    v_pk_add_f32 v[200:201], v[200:201], v[252:253]
    v_pk_add_f32 v[202:203], v[202:203], v[252:253]
    v_max_f32 v200, v200, v52
    v_max_f32 v201, v201, v53
    v_max_f32 v202, v202, v54
    v_max_f32 v203, v203, v55
    v_cvt_pk_bf16_f32 v228, v200, v201
    v_cvt_pk_bf16_f32 v229, v202, v203
    s_mov_b32 exec_hi, 0
    buffer_store_dwordx2 v[228:229], v9, s[48:51], s39 offen sc1
    s_mov_b32 exec_hi, -1
    v_pk_fma_f32 v[204:205], v[44:45], s[40:41], v[250:251]
    v_pk_fma_f32 v[206:207], v[46:47], s[40:41], v[250:251]
    v_exp_f32_e64 v204, v204 clamp
    v_exp_f32_e64 v205, v205 clamp
    v_exp_f32_e64 v206, v206 clamp
    v_exp_f32_e64 v207, v207 clamp
    v_pk_add_f32 v[204:205], v[204:205], v[252:253]
    v_pk_add_f32 v[206:207], v[206:207], v[252:253]
    v_max_f32 v204, v204, v44
    v_max_f32 v205, v205, v45
    v_max_f32 v206, v206, v46
    v_max_f32 v207, v207, v47
    v_cvt_pk_bf16_f32 v224, v204, v205
    v_cvt_pk_bf16_f32 v225, v206, v207
    v_pk_fma_f32 v[200:201], v[48:49], s[40:41], v[250:251]
    v_pk_fma_f32 v[202:203], v[50:51], s[40:41], v[250:251]
    v_exp_f32_e64 v200, v200 clamp
    v_exp_f32_e64 v201, v201 clamp
    v_exp_f32_e64 v202, v202 clamp
    v_exp_f32_e64 v203, v203 clamp
    v_pk_add_f32 v[200:201], v[200:201], v[252:253]
    v_pk_add_f32 v[202:203], v[202:203], v[252:253]
    v_max_f32 v200, v200, v48
    v_max_f32 v201, v201, v49
    v_max_f32 v202, v202, v50
    v_max_f32 v203, v203, v51
    v_cvt_pk_bf16_f32 v226, v200, v201
    v_cvt_pk_bf16_f32 v227, v202, v203
    buffer_store_dwordx4 v[224:227], v8, s[44:47], s37 offen offset:1024 sc1
    s_add_u32 s37, s37, 16384
    s_add_u32 s39, s39, 2048
    v_pk_fma_f32 v[200:201], v[56:57], s[40:41], v[250:251]
    v_pk_fma_f32 v[202:203], v[58:59], s[40:41], v[250:251]
    v_exp_f32_e64 v200, v200 clamp
    v_exp_f32_e64 v201, v201 clamp
    v_exp_f32_e64 v202, v202 clamp
    v_exp_f32_e64 v203, v203 clamp
    v_pk_add_f32 v[200:201], v[200:201], v[252:253]
    v_pk_add_f32 v[202:203], v[202:203], v[252:253]
    v_max_f32 v200, v200, v56
    v_max_f32 v201, v201, v57
    v_max_f32 v202, v202, v58
    v_max_f32 v203, v203, v59
    v_cvt_pk_bf16_f32 v208, v200, v201
    v_cvt_pk_bf16_f32 v209, v202, v203
    v_pk_fma_f32 v[204:205], v[60:61], s[40:41], v[250:251]
    v_pk_fma_f32 v[206:207], v[62:63], s[40:41], v[250:251]
    v_exp_f32_e64 v204, v204 clamp
    v_exp_f32_e64 v205, v205 clamp
    v_exp_f32_e64 v206, v206 clamp
    v_exp_f32_e64 v207, v207 clamp
    v_pk_add_f32 v[204:205], v[204:205], v[252:253]
    v_pk_add_f32 v[206:207], v[206:207], v[252:253]
    v_max_f32 v204, v204, v60
    v_max_f32 v205, v205, v61
    v_max_f32 v206, v206, v62
    v_max_f32 v207, v207, v63
    v_cvt_pk_bf16_f32 v210, v204, v205
    v_cvt_pk_bf16_f32 v211, v206, v207
    buffer_store_dwordx4 v[208:211], v8, s[44:47], s37 offen sc1
    v_pk_fma_f32 v[200:201], v[72:73], s[40:41], v[250:251]
    v_pk_fma_f32 v[202:203], v[74:75], s[40:41], v[250:251]
    v_exp_f32_e64 v200, v200 clamp
    v_exp_f32_e64 v201, v201 clamp
    v_exp_f32_e64 v202, v202 clamp
    v_exp_f32_e64 v203, v203 clamp
    v_pk_add_f32 v[200:201], v[200:201], v[252:253]
    v_pk_add_f32 v[202:203], v[202:203], v[252:253]
    v_max_f32 v200, v200, v72
    v_max_f32 v201, v201, v73
    v_max_f32 v202, v202, v74
    v_max_f32 v203, v203, v75
    v_cvt_pk_bf16_f32 v216, v200, v201
    v_cvt_pk_bf16_f32 v217, v202, v203
    s_mov_b32 exec_hi, 0
    buffer_store_dwordx2 v[216:217], v9, s[48:51], s39 offen sc1
    s_mov_b32 exec_hi, -1
    v_pk_fma_f32 v[204:205], v[64:65], s[40:41], v[250:251]
    v_pk_fma_f32 v[206:207], v[66:67], s[40:41], v[250:251]
    v_exp_f32_e64 v204, v204 clamp
    v_exp_f32_e64 v205, v205 clamp
    v_exp_f32_e64 v206, v206 clamp
    v_exp_f32_e64 v207, v207 clamp
    v_pk_add_f32 v[204:205], v[204:205], v[252:253]
    v_pk_add_f32 v[206:207], v[206:207], v[252:253]
    v_max_f32 v204, v204, v64
    v_max_f32 v205, v205, v65
    v_max_f32 v206, v206, v66
    v_max_f32 v207, v207, v67
    v_cvt_pk_bf16_f32 v212, v204, v205
    v_cvt_pk_bf16_f32 v213, v206, v207
    v_pk_fma_f32 v[200:201], v[68:69], s[40:41], v[250:251]
    v_pk_fma_f32 v[202:203], v[70:71], s[40:41], v[250:251]
    v_exp_f32_e64 v200, v200 clamp
    v_exp_f32_e64 v201, v201 clamp
    v_exp_f32_e64 v202, v202 clamp
    v_exp_f32_e64 v203, v203 clamp
    v_pk_add_f32 v[200:201], v[200:201], v[252:253]
    v_pk_add_f32 v[202:203], v[202:203], v[252:253]
    v_max_f32 v200, v200, v68
    v_max_f32 v201, v201, v69
    v_max_f32 v202, v202, v70
    v_max_f32 v203, v203, v71
    v_cvt_pk_bf16_f32 v214, v200, v201
    v_cvt_pk_bf16_f32 v215, v202, v203
    buffer_store_dwordx4 v[212:215], v8, s[44:47], s37 offen offset:1024 sc1
    s_add_u32 s37, s37, 16384
    s_add_u32 s39, s39, 2048
    v_pk_fma_f32 v[200:201], v[76:77], s[40:41], v[250:251]
    v_pk_fma_f32 v[202:203], v[78:79], s[40:41], v[250:251]
    v_exp_f32_e64 v200, v200 clamp
    v_exp_f32_e64 v201, v201 clamp
    v_exp_f32_e64 v202, v202 clamp
    v_exp_f32_e64 v203, v203 clamp
    v_pk_add_f32 v[200:201], v[200:201], v[252:253]
    v_pk_add_f32 v[202:203], v[202:203], v[252:253]
    v_max_f32 v200, v200, v76
    v_max_f32 v201, v201, v77
    v_max_f32 v202, v202, v78
    v_max_f32 v203, v203, v79
    v_cvt_pk_bf16_f32 v220, v200, v201
    v_cvt_pk_bf16_f32 v221, v202, v203
    v_pk_fma_f32 v[204:205], v[80:81], s[40:41], v[250:251]
    v_pk_fma_f32 v[206:207], v[82:83], s[40:41], v[250:251]
    v_exp_f32_e64 v204, v204 clamp
    v_exp_f32_e64 v205, v205 clamp
    v_exp_f32_e64 v206, v206 clamp
    v_exp_f32_e64 v207, v207 clamp
    v_pk_add_f32 v[204:205], v[204:205], v[252:253]
    v_pk_add_f32 v[206:207], v[206:207], v[252:253]
    v_max_f32 v204, v204, v80
    v_max_f32 v205, v205, v81
    v_max_f32 v206, v206, v82
    v_max_f32 v207, v207, v83
    v_cvt_pk_bf16_f32 v222, v204, v205
    v_cvt_pk_bf16_f32 v223, v206, v207
    buffer_store_dwordx4 v[220:223], v8, s[44:47], s37 offen sc1
    v_pk_fma_f32 v[200:201], v[92:93], s[40:41], v[250:251]
    v_pk_fma_f32 v[202:203], v[94:95], s[40:41], v[250:251]
    v_exp_f32_e64 v200, v200 clamp
    v_exp_f32_e64 v201, v201 clamp
    v_exp_f32_e64 v202, v202 clamp
    v_exp_f32_e64 v203, v203 clamp
    v_pk_add_f32 v[200:201], v[200:201], v[252:253]
    v_pk_add_f32 v[202:203], v[202:203], v[252:253]
    v_max_f32 v200, v200, v92
    v_max_f32 v201, v201, v93
    v_max_f32 v202, v202, v94
    v_max_f32 v203, v203, v95
    v_cvt_pk_bf16_f32 v228, v200, v201
    v_cvt_pk_bf16_f32 v229, v202, v203
    s_mov_b32 exec_hi, 0
    buffer_store_dwordx2 v[228:229], v9, s[48:51], s39 offen sc1
    s_mov_b32 exec_hi, -1
    v_pk_fma_f32 v[204:205], v[84:85], s[40:41], v[250:251]
    v_pk_fma_f32 v[206:207], v[86:87], s[40:41], v[250:251]
    v_exp_f32_e64 v204, v204 clamp
    v_exp_f32_e64 v205, v205 clamp
    v_exp_f32_e64 v206, v206 clamp
    v_exp_f32_e64 v207, v207 clamp
    v_pk_add_f32 v[204:205], v[204:205], v[252:253]
    v_pk_add_f32 v[206:207], v[206:207], v[252:253]
    v_max_f32 v204, v204, v84
    v_max_f32 v205, v205, v85
    v_max_f32 v206, v206, v86
    v_max_f32 v207, v207, v87
    v_cvt_pk_bf16_f32 v224, v204, v205
    v_cvt_pk_bf16_f32 v225, v206, v207
    v_pk_fma_f32 v[200:201], v[88:89], s[40:41], v[250:251]
    v_pk_fma_f32 v[202:203], v[90:91], s[40:41], v[250:251]
    v_exp_f32_e64 v200, v200 clamp
    v_exp_f32_e64 v201, v201 clamp
    v_exp_f32_e64 v202, v202 clamp
    v_exp_f32_e64 v203, v203 clamp
    v_pk_add_f32 v[200:201], v[200:201], v[252:253]
    v_pk_add_f32 v[202:203], v[202:203], v[252:253]
    v_max_f32 v200, v200, v88
    v_max_f32 v201, v201, v89
    v_max_f32 v202, v202, v90
    v_max_f32 v203, v203, v91
    v_cvt_pk_bf16_f32 v226, v200, v201
    v_cvt_pk_bf16_f32 v227, v202, v203
    buffer_store_dwordx4 v[224:227], v8, s[44:47], s37 offen offset:1024 sc1
    s_add_u32 s37, s37, 16384
    s_add_u32 s39, s39, 2048
    v_pk_fma_f32 v[200:201], v[96:97], s[40:41], v[250:251]
    v_pk_fma_f32 v[202:203], v[98:99], s[40:41], v[250:251]
    v_exp_f32_e64 v200, v200 clamp
    v_exp_f32_e64 v201, v201 clamp
    v_exp_f32_e64 v202, v202 clamp
    v_exp_f32_e64 v203, v203 clamp
    v_pk_add_f32 v[200:201], v[200:201], v[252:253]
    v_pk_add_f32 v[202:203], v[202:203], v[252:253]
    v_max_f32 v200, v200, v96
    v_max_f32 v201, v201, v97
    v_max_f32 v202, v202, v98
    v_max_f32 v203, v203, v99
    v_cvt_pk_bf16_f32 v208, v200, v201
    v_cvt_pk_bf16_f32 v209, v202, v203
    v_pk_fma_f32 v[204:205], v[100:101], s[40:41], v[250:251]
    v_pk_fma_f32 v[206:207], v[102:103], s[40:41], v[250:251]
    v_exp_f32_e64 v204, v204 clamp
    v_exp_f32_e64 v205, v205 clamp
    v_exp_f32_e64 v206, v206 clamp
    v_exp_f32_e64 v207, v207 clamp
    v_pk_add_f32 v[204:205], v[204:205], v[252:253]
    v_pk_add_f32 v[206:207], v[206:207], v[252:253]
    v_max_f32 v204, v204, v100
    v_max_f32 v205, v205, v101
    v_max_f32 v206, v206, v102
    v_max_f32 v207, v207, v103
    v_cvt_pk_bf16_f32 v210, v204, v205
    v_cvt_pk_bf16_f32 v211, v206, v207
    buffer_store_dwordx4 v[208:211], v8, s[44:47], s37 offen sc1
    v_pk_fma_f32 v[200:201], v[112:113], s[40:41], v[250:251]
    v_pk_fma_f32 v[202:203], v[114:115], s[40:41], v[250:251]
    v_exp_f32_e64 v200, v200 clamp
    v_exp_f32_e64 v201, v201 clamp
    v_exp_f32_e64 v202, v202 clamp
    v_exp_f32_e64 v203, v203 clamp
    v_pk_add_f32 v[200:201], v[200:201], v[252:253]
    v_pk_add_f32 v[202:203], v[202:203], v[252:253]
    v_max_f32 v200, v200, v112
    v_max_f32 v201, v201, v113
    v_max_f32 v202, v202, v114
    v_max_f32 v203, v203, v115
    v_cvt_pk_bf16_f32 v216, v200, v201
    v_cvt_pk_bf16_f32 v217, v202, v203
    s_mov_b32 exec_hi, 0
    buffer_store_dwordx2 v[216:217], v9, s[48:51], s39 offen sc1
    s_mov_b32 exec_hi, -1
    v_pk_fma_f32 v[204:205], v[104:105], s[40:41], v[250:251]
    v_pk_fma_f32 v[206:207], v[106:107], s[40:41], v[250:251]
    v_exp_f32_e64 v204, v204 clamp
    v_exp_f32_e64 v205, v205 clamp
    v_exp_f32_e64 v206, v206 clamp
    v_exp_f32_e64 v207, v207 clamp
    v_pk_add_f32 v[204:205], v[204:205], v[252:253]
    v_pk_add_f32 v[206:207], v[206:207], v[252:253]
    v_max_f32 v204, v204, v104
    v_max_f32 v205, v205, v105
    v_max_f32 v206, v206, v106
    v_max_f32 v207, v207, v107
    v_cvt_pk_bf16_f32 v212, v204, v205
    v_cvt_pk_bf16_f32 v213, v206, v207
    v_pk_fma_f32 v[200:201], v[108:109], s[40:41], v[250:251]
    v_pk_fma_f32 v[202:203], v[110:111], s[40:41], v[250:251]
    v_exp_f32_e64 v200, v200 clamp
    v_exp_f32_e64 v201, v201 clamp
    v_exp_f32_e64 v202, v202 clamp
    v_exp_f32_e64 v203, v203 clamp
    v_pk_add_f32 v[200:201], v[200:201], v[252:253]
    v_pk_add_f32 v[202:203], v[202:203], v[252:253]
    v_max_f32 v200, v200, v108
    v_max_f32 v201, v201, v109
    v_max_f32 v202, v202, v110
    v_max_f32 v203, v203, v111
    v_cvt_pk_bf16_f32 v214, v200, v201
    v_cvt_pk_bf16_f32 v215, v202, v203
    buffer_store_dwordx4 v[212:215], v8, s[44:47], s37 offen offset:1024 sc1
    s_add_u32 s37, s37, 16384
    s_add_u32 s39, s39, 2048
    s_barrier
    v_mov_b64 v[106:107], v[244:245]
    v_mov_b64 v[108:109], v[246:247]
    s_lshl_b32 s50, s33, 7
    s_add_u32 s50, s50, 65536
    v_mov_b32 v243, 0
    s_mov_b32 s33, s97
    s_lshl_b32 s34, s42, 2
    s_add_u32 s32, s96, s34
    s_and_b32 s36, s31, 1
    s_lshr_b32 s35, s31, 1
    s_xor_b32 s35, s35, 2
    v_mov_b32 v8, 0x7ffffff0
    v_lshlrev_b32 v9, 4, v1
    s_add_u32 s40, s31, s43
    s_and_b32 s40, s40, 7
    s_and_b32 s41, s33, 3
    s_mul_i32 s37, s40, 5632
    v_and_b32 v6, 3, v2
    v_bfe_u32 v7, v2, 2, 1
    v_lshl_add_u32 v7, v7, 1, v6
    v_cmp_gt_u32 vcc, 2, v6
    s_nop 1
    v_cndmask_b32 v7, v7, v6, vcc
    v_lshlrev_b32 v12, 4, v3
    v_lshl_add_u32 v12, v7, 6, v12
    v_cmp_gt_u32 s[44:45], 8, v2
    s_nop 0
    s_or_b64 s[96:97], s[44:45], vcc
    s_orn2_b64 vcc, vcc, s[44:45]
    v_cndmask_b32 v13, v8, v12, vcc
    v_cndmask_b32 v12, v8, v12, s[96:97]
    v_lshlrev_b32 v10, 4, v2
    v_lshlrev_b32 v11, 4, v7
    v_add_u32 v11, 640, v11
    v_cmp_lt_u32 s[100:101], 1, v3
    s_nop 1
    v_cndmask_b32 v10, v10, v11, s[100:101]
    v_and_b32 v6, 1, v3
    v_mul_u32_u24 v11, 2816, v6
    v_add_u32 v10, v10, v11
    v_cmp_eq_u32 s[98:99], 1, v6
    v_cmp_eq_u32 s[44:45], 1, v7
    v_cmp_lt_u32 s[46:47], 3, v7
    s_nop 0
    s_or_b64 s[44:45], s[44:45], s[46:47]
    s_andn2_b64 s[46:47], s[100:101], s[98:99]
    s_and_b64 s[46:47], s[46:47], s[96:97]
    s_and_b64 s[96:97], s[100:101], s[98:99]
    s_and_b64 s[96:97], s[96:97], vcc
    v_lshlrev_b32 v7, 3, v2
    v_lshl_add_u32 v7, v6, 7, v7
    s_lshl_b32 s38, s32, 6
    s_lshl_b32 s39, s40, 1
    s_add_u32 s38, s38, s39
    s_lshl_b32 s39, s38, 7
    s_add_u32 s39, s39, 3145728
    s_lshl_b32 s38, s38, 10
    s_add_u32 s38, s38, 1048576
    v_mov_b32 v4, 163776
    v_mov_b32 v5, 1
    s_waitcnt vmcnt(0)
    s_mov_b64 exec, 1
    ds_add_rtn_u32 v6, v4, v5
    s_mov_b64 exec, -1
    s_waitcnt lgkmcnt(0)
    v_readfirstlane_b32 s3, v6
    s_nop 0
    s_cmp_lg_u32 s3, 3
    s_cbranch_scc1 L_q_sig
    s_mov_b64 exec, 1
    buffer_atomic_add v5, v243, s[56:59], s50 offen
    s_mov_b64 exec, -1
L_q_sig:
    s_branch L_bjoin
L_bjoin:
    s_cmp_ge_u32 s43, 20
    s_cbranch_scc1 L_fin
    v_mov_b32 v4, 163780
    s_mov_b32 s3, 0
L_xv:
    ds_read_b32 v5, v4
    s_add_u32 s3, s3, 1
    s_waitcnt lgkmcnt(0)
    v_cmp_gt_u32 vcc, 4, v5
    s_cmp_ge_u32 s3, 0x100000
    s_cbranch_scc1 L_xv2
    s_cbranch_vccnz L_xv
L_xv2:
    v_add_u32 v0, 0x1c000, v106
    s_lshl_b32 s3, s33, 2
    s_add_u32 s3, s3, s35
    s_cmp_ge_u32 s3, 18
    s_cbranch_scc1 L_notr
    ds_read_b64_tr_b16 v[112:113], v106 offset:0
    ds_read_b64_tr_b16 v[114:115], v106 offset:4096
    ds_read_b64_tr_b16 v[116:117], v107 offset:0
    ds_read_b64_tr_b16 v[118:119], v107 offset:4096
    ds_read_b64_tr_b16 v[120:121], v106 offset:8192
    ds_read_b64_tr_b16 v[122:123], v106 offset:12288
    ds_read_b64_tr_b16 v[124:125], v107 offset:8192
    ds_read_b64_tr_b16 v[126:127], v107 offset:12288
    ds_read_b64_tr_b16 v[128:129], v106 offset:16384
    ds_read_b64_tr_b16 v[130:131], v106 offset:20480
    ds_read_b64_tr_b16 v[132:133], v107 offset:16384
    ds_read_b64_tr_b16 v[134:135], v107 offset:20480
    ds_read_b64_tr_b16 v[136:137], v106 offset:24576
    ds_read_b64_tr_b16 v[138:139], v106 offset:28672
    ds_read_b64_tr_b16 v[140:141], v107 offset:24576
    ds_read_b64_tr_b16 v[142:143], v107 offset:28672
    ds_read_b64_tr_b16 v[144:145], v106 offset:32768
    ds_read_b64_tr_b16 v[146:147], v106 offset:36864
    ds_read_b64_tr_b16 v[148:149], v107 offset:32768
    ds_read_b64_tr_b16 v[150:151], v107 offset:36864
    ds_read_b64_tr_b16 v[152:153], v106 offset:40960
    ds_read_b64_tr_b16 v[154:155], v106 offset:45056
    ds_read_b64_tr_b16 v[156:157], v107 offset:40960
    ds_read_b64_tr_b16 v[158:159], v107 offset:45056
    ds_read_b64_tr_b16 v[160:161], v106 offset:49152
    ds_read_b64_tr_b16 v[162:163], v106 offset:53248
    ds_read_b64_tr_b16 v[164:165], v107 offset:49152
    ds_read_b64_tr_b16 v[166:167], v107 offset:53248
    ds_read_b64_tr_b16 v[168:169], v106 offset:57344
    ds_read_b64_tr_b16 v[170:171], v106 offset:61440
    ds_read_b64_tr_b16 v[172:173], v107 offset:57344
    ds_read_b64_tr_b16 v[174:175], v107 offset:61440
    ds_read_b64_tr_b16 v[176:177], v108 offset:0
    ds_read_b64_tr_b16 v[178:179], v108 offset:4096
    ds_read_b64_tr_b16 v[180:181], v109 offset:0
    ds_read_b64_tr_b16 v[182:183], v109 offset:4096
    ds_read_b64_tr_b16 v[184:185], v108 offset:8192
    ds_read_b64_tr_b16 v[186:187], v108 offset:12288
    ds_read_b64_tr_b16 v[188:189], v109 offset:8192
    ds_read_b64_tr_b16 v[190:191], v109 offset:12288
    ds_read_b64_tr_b16 v[192:193], v108 offset:16384
    ds_read_b64_tr_b16 v[194:195], v108 offset:20480
    ds_read_b64_tr_b16 v[196:197], v109 offset:16384
    ds_read_b64_tr_b16 v[198:199], v109 offset:20480
    ds_read_b64_tr_b16 v[200:201], v108 offset:24576
    ds_read_b64_tr_b16 v[202:203], v108 offset:28672
    ds_read_b64_tr_b16 v[204:205], v109 offset:24576
    ds_read_b64_tr_b16 v[206:207], v109 offset:28672
    ds_read_b64_tr_b16 v[208:209], v108 offset:32768
    ds_read_b64_tr_b16 v[210:211], v108 offset:36864
    ds_read_b64_tr_b16 v[212:213], v109 offset:32768
    ds_read_b64_tr_b16 v[214:215], v109 offset:36864
    ds_read_b64_tr_b16 v[216:217], v108 offset:40960
    ds_read_b64_tr_b16 v[218:219], v108 offset:45056
    ds_read_b64_tr_b16 v[220:221], v109 offset:40960
    ds_read_b64_tr_b16 v[222:223], v109 offset:45056
L_notr:
    v_mov_b32 v98, v9
    v_mov_b32 v99, v7
    v_mov_b32 v100, v10
    v_mov_b64 v[102:103], v[12:13]
    v_mov_b32 v254, v9
    v_mov_b32 v255, v7
    v_mov_b32 v101, v1
    s_mov_b32 s51, s37
    v_xor_b32 v5, 32, v0
    v_mov_b32 v4, v0
    ds_read_b64_tr_b16 v[224:225], v4 offset:0
    ds_read_b64_tr_b16 v[226:227], v4 offset:4096
    ds_read_b64_tr_b16 v[228:229], v5 offset:0
    ds_read_b64_tr_b16 v[230:231], v5 offset:4096
    ds_read_b64_tr_b16 v[232:233], v4 offset:8192
    ds_read_b64_tr_b16 v[234:235], v4 offset:12288
    ds_read_b64_tr_b16 v[236:237], v5 offset:8192
    ds_read_b64_tr_b16 v[238:239], v5 offset:12288
    s_lshl_b32 s34, s40, 11
    v_add_u32 v10, s34, v9
    s_lshr_b32 s34, s40, 2
    s_lshl_b32 s34, s34, 10
    s_and_b32 s3, s40, 3
    s_lshl_b32 s3, s3, 2
    s_add_u32 s34, s34, s3
    s_add_u32 s34, s34, 16384
    v_add_u32 v11, s34, v9
    s_mul_i32 s34, s36, 18432
    v_add_u32 v8, s34, v9
    s_lshl_b32 s34, s31, 10
    s_add_u32 s34, s34, 147456
    v_add_u32 v9, s34, v9
    v_and_b32 v12, 1, v3
    v_lshrrev_b32 v14, 1, v3
    v_lshl_add_u32 v12, v12, 1, v14
    s_lshl_b32 s3, s35, 2
    v_add_u32 v12, s3, v12
    v_xor_b32 v12, v12, v2
    v_lshl_add_u32 v12, v2, 4, v12
    s_lshl_b32 s3, s36, 12
    s_add_u32 s3, s3, 147456
    v_lshl_add_u32 v12, v12, 4, s3
    s_and_b32 s3, s31, 3
    s_lshl_b32 s3, s3, 2
    v_add_u32 v14, s3, v3
    v_xor_b32 v15, v14, v2
    v_cmp_eq_u32 vcc, 0, v3
    v_mov_b32 v2, v12
    s_lshr_b32 s3, s31, 2
    s_add_u32 s3, s3, s41
    s_and_b32 s3, s3, 3
    s_cmp_lt_u32 s3, 2
    s_mov_b32 s37, 73728
    s_cselect_b32 s37, s37, 0xfffee000
    s_lshl_b32 s34, s32, 6
    s_lshl_b32 s3, s3, 4
    s_add_u32 s34, s34, s3
    v_add_u32 v14, s34, v14
    v_mul_u32_u24 v14, 2304, v14
    s_lshl_b32 s34, s33, 8
    v_lshl_add_u32 v15, v15, 4, s34
    s_movk_i32 s3, 1152
    v_cmp_gt_u32 s[60:61], s3, v15
    v_add3_u32 v3, v14, v15, s3
    s_lshl_b32 s3, s35, 6
    s_add_u32 s34, s34, s3
    v_xor_b32 v1, 32, v0
    v_mov_b32 v12, 0x358637bd
    v_mov_b32 v13, v12
    v_mov_b32 v14, 0
    v_mov_b32 v15, 0
    v_mov_b32 v38, 0
    v_mov_b32 v46, 0
    s_andn2_b64 s[48:49], s[98:99], s[100:101]
    s_mov_b64 s[94:95], vcc
    s_mov_b32 s50, s34
    s_waitcnt lgkmcnt(0)
    s_cmp_lg_u32 s31, 4
    s_cbranch_scc1 L_pwq
    s_lshl_b32 s34, s32, 1
    v_add_u32 v104, s34, v101
    v_mul_u32_u24 v104, 205, v104
    v_lshrrev_b32 v104, 10, v104
    v_lshlrev_b32 v104, 7, v104
    s_mov_b32 s34, 65536
    s_mov_b64 exec, 0x3
    s_mov_b32 s3, 0
L_pollq:
    buffer_load_dword v105, v104, s[56:59], s34 offen sc1
    s_add_u32 s3, s3, 1
    s_waitcnt vmcnt(0)
    v_cmp_gt_u32 vcc, 4, v105
    s_cmp_ge_u32 s3, 0x10000
    s_cbranch_scc1 L_pdq
    s_cbranch_vccnz L_pollq
L_pdq:
    s_mov_b64 exec, -1
L_pwq:
    s_cmp_lg_u32 s31, 5
    s_cbranch_scc1 L_pwk
    v_lshlrev_b32 v104, 7, v101
    s_lshl_b32 s34, s42, 11
    s_add_u32 s34, s34, 49152
    s_mov_b64 exec, 0xffff
    s_mov_b32 s3, 0
L_pollk:
    buffer_load_dword v105, v104, s[56:59], s34 offen sc1
    s_add_u32 s3, s3, 1
    s_waitcnt vmcnt(0)
    v_cmp_gt_u32 vcc, 8, v105
    s_cmp_ge_u32 s3, 0x10000
    s_cbranch_scc1 L_pdk
    s_cbranch_vccnz L_pollk
L_pdk:
    s_mov_b64 exec, -1
L_pwk:
    s_barrier
    buffer_load_dwordx4 v[32:35], v102, s[56:59], s51 offen offset:2304 sc1
    buffer_load_dwordx4 v[48:51], v100, s[56:59], s51 offen offset:2048 sc1
    s_add_u32 s3, s51, 2816
    buffer_load_dwordx4 v[40:43], v103, s[56:59], s3 offen offset:2304 sc1
    buffer_load_dwordx4 v[16:19], v98, s[56:59], s51 offen offset:0 sc1
    buffer_load_dwordx4 v[20:23], v98, s[56:59], s51 offen offset:1024 sc1
    buffer_load_dwordx4 v[24:27], v98, s[56:59], s51 offen offset:2816 sc1
    buffer_load_dwordx4 v[28:31], v98, s[56:59], s51 offen offset:3840 sc1
    s_add_u32 s3, s41, 0
    s_and_b32 s3, s3, 3
    s_lshl_b32 s30, s3, 14
    s_add_u32 s30, s30, s38
    s_lshl_b32 s3, s3, 11
    s_add_u32 s3, s3, s39
    buffer_load_dwordx4 v[58:61], v98, s[56:59], s30 offen sc1
    buffer_load_dwordx4 v[64:67], v98, s[56:59], s30 offen offset:1024 sc1
    buffer_load_dwordx2 v[62:63], v99, s[56:59], s3 offen sc1
    s_add_u32 s3, s41, 1
    s_and_b32 s3, s3, 3
    s_lshl_b32 s30, s3, 14
    s_add_u32 s30, s30, s38
    s_lshl_b32 s3, s3, 11
    s_add_u32 s3, s3, s39
    buffer_load_dwordx4 v[72:75], v98, s[56:59], s30 offen sc1
    buffer_load_dwordx4 v[78:81], v98, s[56:59], s30 offen offset:1024 sc1
    buffer_load_dwordx2 v[76:77], v99, s[56:59], s3 offen sc1
    s_waitcnt vmcnt(10)
    v_cvt_pk_bf16_f32 v252, v48, v49
    v_cvt_pk_bf16_f32 v253, v50, v51
    v_cvt_pk_bf16_f32 v50, v32, v33
    v_cvt_pk_bf16_f32 v51, v34, v35
    v_cndmask_b32 v52, 0, v252, s[46:47]
    v_mov_b32 v33, 0
    v_cndmask_b32 v36, 0, v50, s[44:45]
    v_cndmask_b32 v37, 0, v51, s[44:45]
    v_cndmask_b32 v39, 0, v52, s[44:45]
    v_cndmask_b32 v32, v52, 0, s[44:45]
    v_cndmask_b32 v34, v50, 0, s[44:45]
    v_cndmask_b32 v35, v51, 0, s[44:45]
    v_cvt_pk_bf16_f32 v50, v40, v41
    v_cvt_pk_bf16_f32 v51, v42, v43
    v_cndmask_b32 v52, 0, v252, s[96:97]
    v_mov_b32 v41, 0
    v_cndmask_b32 v44, 0, v50, s[44:45]
    v_cndmask_b32 v45, 0, v51, s[44:45]
    v_cndmask_b32 v47, 0, v52, s[44:45]
    v_cndmask_b32 v40, v52, 0, s[44:45]
    v_cndmask_b32 v42, v50, 0, s[44:45]
    v_cndmask_b32 v43, v51, 0, s[44:45]
    s_waitcnt vmcnt(8)
    v_cvt_pk_bf16_f32 v19, v18, v19
    v_cvt_pk_bf16_f32 v18, v16, v17
    v_cndmask_b32 v16, 0, v252, s[94:95]
    v_mov_b32 v17, 0
    v_cvt_pk_bf16_f32 v20, v20, v21
    v_cvt_pk_bf16_f32 v21, v22, v23
    v_mov_b32 v22, 0
    v_cndmask_b32 v23, 0, v253, s[94:95]
    s_waitcnt vmcnt(6)
    v_cvt_pk_bf16_f32 v27, v26, v27
    v_cvt_pk_bf16_f32 v26, v24, v25
    v_cndmask_b32 v24, 0, v252, s[48:49]
    v_mov_b32 v25, 0
    v_cvt_pk_bf16_f32 v28, v28, v29
    v_cvt_pk_bf16_f32 v29, v30, v31
    v_mov_b32 v30, 0
    v_cndmask_b32 v31, 0, v253, s[48:49]
    s_waitcnt vmcnt(3)
    v_mov_b64 v[56:57], v[62:63]
    v_mov_b64 v[68:69], v[62:63]
    v_mfma_f32_16x16x32_bf16 v[48:51], v[36:39], v[60:63], v[12:15]
    s_nop 0
    v_mfma_f32_16x16x32_bf16 v[52:55], v[44:47], v[66:69], v[12:15]
    v_mfma_f32_16x16x32_bf16 v[48:51], v[32:35], v[56:59], v[48:51]
    v_mfma_f32_16x16x32_bf16 v[52:55], v[40:43], v[62:65], v[52:55]
    v_mfma_f32_16x16x32_bf16 v[4:7], v[16:19], v[56:59], 0
    v_mfma_f32_16x16x32_bf16 v[56:59], v[20:23], v[60:63], 0
    v_mfma_f32_16x16x32_bf16 v[62:65], v[24:27], v[62:65], 0
    v_mfma_f32_16x16x32_bf16 v[66:69], v[28:31], v[66:69], 0
    s_waitcnt vmcnt(0)
    v_mov_b64 v[70:71], v[76:77]
    v_mov_b64 v[82:83], v[76:77]
    v_mfma_f32_16x16x32_bf16 v[240:243], v[36:39], v[74:77], v[12:15]
    s_nop 0
    v_mfma_f32_16x16x32_bf16 v[244:247], v[44:47], v[80:83], v[12:15]
    v_mfma_f32_16x16x32_bf16 v[240:243], v[32:35], v[70:73], v[240:243]
    v_mfma_f32_16x16x32_bf16 v[244:247], v[40:43], v[76:79], v[244:247]
    v_mfma_f32_16x16x32_bf16 v[248:251], v[16:19], v[70:73], 0
    v_mfma_f32_16x16x32_bf16 v[70:73], v[20:23], v[74:77], 0
    v_mfma_f32_16x16x32_bf16 v[76:79], v[24:27], v[76:79], 0
    v_mfma_f32_16x16x32_bf16 v[80:83], v[28:31], v[80:83], 0
    s_add_u32 s3, s41, 2
    s_and_b32 s3, s3, 3
    s_lshl_b32 s30, s3, 14
    s_add_u32 s30, s30, s38
    s_lshl_b32 s3, s3, 11
    s_add_u32 s3, s3, s39
    buffer_load_dwordx4 v[86:89], v254, s[56:59], s30 offen sc1
    buffer_load_dwordx4 v[92:95], v254, s[56:59], s30 offen offset:1024 sc1
    buffer_load_dwordx2 v[90:91], v255, s[56:59], s3 offen sc1
    s_add_u32 s3, s41, 3
    s_and_b32 s3, s3, 3
    s_lshl_b32 s30, s3, 14
    s_add_u32 s30, s30, s38
    s_lshl_b32 s3, s3, 11
    s_add_u32 s3, s3, s39
    buffer_load_dwordx4 v[100:103], v254, s[56:59], s30 offen sc1
    buffer_load_dwordx4 v[106:109], v254, s[56:59], s30 offen offset:1024 sc1
    buffer_load_dwordx2 v[104:105], v255, s[56:59], s3 offen sc1
    v_rcp_f32 v48, v48
    v_rcp_f32 v49, v49
    v_rcp_f32 v52, v52
    v_rcp_f32 v53, v53
    v_add_f32 v50, v50, v54
    v_add_f32 v51, v51, v55
    v_cndmask_b32 v54, v48, v49, s[98:99]
    v_cndmask_b32 v55, v52, v53, s[98:99]
    v_cndmask_b32 v54, v54, v55, s[100:101]
    v_mul_f32 v50, v50, v54
    v_mul_f32 v51, v51, v54
    v_cvt_pk_bf16_f32 v60, v50, v51
    ds_write_b32 v11, v60 offset:0
    v_mul_f32 v4, v4, v48
    v_mul_f32 v5, v5, v48
    v_mul_f32 v6, v6, v48
    v_mul_f32 v7, v7, v48
    v_mul_f32 v56, v56, v49
    v_mul_f32 v57, v57, v49
    v_mul_f32 v58, v58, v49
    v_mul_f32 v59, v59, v49
    v_mul_f32 v62, v62, v52
    v_mul_f32 v63, v63, v52
    v_mul_f32 v64, v64, v52
    v_mul_f32 v65, v65, v52
    v_mul_f32 v66, v66, v53
    v_mul_f32 v67, v67, v53
    v_mul_f32 v68, v68, v53
    v_mul_f32 v69, v69, v53
    v_cvt_pk_bf16_f32 v4, v4, v5
    v_cvt_pk_bf16_f32 v5, v6, v7
    v_cvt_pk_bf16_f32 v6, v56, v57
    v_cvt_pk_bf16_f32 v7, v58, v59
    ds_write_b128 v10, v[4:7] offset:0
    v_cvt_pk_bf16_f32 v62, v62, v63
    v_cvt_pk_bf16_f32 v63, v64, v65
    v_cvt_pk_bf16_f32 v64, v66, v67
    v_cvt_pk_bf16_f32 v65, v68, v69
    ds_write_b128 v10, v[62:65] offset:1024
    v_rcp_f32 v240, v240
    v_rcp_f32 v241, v241
    v_rcp_f32 v244, v244
    v_rcp_f32 v245, v245
    v_add_f32 v242, v242, v246
    v_add_f32 v243, v243, v247
    v_cndmask_b32 v246, v240, v241, s[98:99]
    v_cndmask_b32 v247, v244, v245, s[98:99]
    v_cndmask_b32 v246, v246, v247, s[100:101]
    v_mul_f32 v242, v242, v246
    v_mul_f32 v243, v243, v246
    v_cvt_pk_bf16_f32 v74, v242, v243
    ds_write_b32 v11, v74 offset:18432
    v_mul_f32 v248, v248, v240
    v_mul_f32 v249, v249, v240
    v_mul_f32 v250, v250, v240
    v_mul_f32 v251, v251, v240
    v_mul_f32 v70, v70, v241
    v_mul_f32 v71, v71, v241
    v_mul_f32 v72, v72, v241
    v_mul_f32 v73, v73, v241
    v_mul_f32 v76, v76, v244
    v_mul_f32 v77, v77, v244
    v_mul_f32 v78, v78, v244
    v_mul_f32 v79, v79, v244
    v_mul_f32 v80, v80, v245
    v_mul_f32 v81, v81, v245
    v_mul_f32 v82, v82, v245
    v_mul_f32 v83, v83, v245
    v_cvt_pk_bf16_f32 v248, v248, v249
    v_cvt_pk_bf16_f32 v249, v250, v251
    v_cvt_pk_bf16_f32 v250, v70, v71
    v_cvt_pk_bf16_f32 v251, v72, v73
    ds_write_b128 v10, v[248:251] offset:18432
    v_cvt_pk_bf16_f32 v76, v76, v77
    v_cvt_pk_bf16_f32 v77, v78, v79
    v_cvt_pk_bf16_f32 v78, v80, v81
    v_cvt_pk_bf16_f32 v79, v82, v83
    ds_write_b128 v10, v[76:79] offset:19456
    s_waitcnt lgkmcnt(0)
    s_barrier
    ds_read_b128 v[240:243], v8 offset:0
    ds_read_b128 v[244:247], v8 offset:1024
    ds_read_b128 v[248:251], v8 offset:2048
    s_waitcnt vmcnt(3)
    v_mov_b64 v[84:85], v[90:91]
    v_mov_b64 v[96:97], v[90:91]
    v_mfma_f32_16x16x32_bf16 v[48:51], v[36:39], v[88:91], v[12:15]
    s_nop 0
    v_mfma_f32_16x16x32_bf16 v[52:55], v[44:47], v[94:97], v[12:15]
    v_mfma_f32_16x16x32_bf16 v[48:51], v[32:35], v[84:87], v[48:51]
    v_mfma_f32_16x16x32_bf16 v[52:55], v[40:43], v[90:93], v[52:55]
    v_mfma_f32_16x16x32_bf16 v[4:7], v[16:19], v[84:87], 0
    v_mfma_f32_16x16x32_bf16 v[84:87], v[20:23], v[88:91], 0
    v_mfma_f32_16x16x32_bf16 v[90:93], v[24:27], v[90:93], 0
    v_mfma_f32_16x16x32_bf16 v[94:97], v[28:31], v[94:97], 0
    s_waitcnt lgkmcnt(2)
    v_mfma_f32_16x16x32_bf16 v[68:71], v[112:115], v[240:243], 0
    v_mfma_f32_16x16x32_bf16 v[72:75], v[116:119], v[240:243], 0
    s_waitcnt vmcnt(0)
    v_mov_b64 v[98:99], v[104:105]
    v_mov_b64 v[110:111], v[104:105]
    v_mfma_f32_16x16x32_bf16 v[56:59], v[36:39], v[102:105], v[12:15]
    s_nop 0
    v_mfma_f32_16x16x32_bf16 v[60:63], v[44:47], v[108:111], v[12:15]
    v_mfma_f32_16x16x32_bf16 v[56:59], v[32:35], v[98:101], v[56:59]
    v_mfma_f32_16x16x32_bf16 v[60:63], v[40:43], v[104:107], v[60:63]
    v_mfma_f32_16x16x32_bf16 v[64:67], v[16:19], v[98:101], 0
    v_mfma_f32_16x16x32_bf16 v[98:101], v[20:23], v[102:105], 0
    v_mfma_f32_16x16x32_bf16 v[104:107], v[24:27], v[104:107], 0
    v_mfma_f32_16x16x32_bf16 v[108:111], v[28:31], v[108:111], 0
    ds_read_b128 v[28:31], v8 offset:3072
    ds_read_b128 v[32:35], v8 offset:4096
    s_waitcnt lgkmcnt(3)
    v_mfma_f32_16x16x32_bf16 v[68:71], v[120:123], v[244:247], v[68:71]
    ds_read_b128 v[36:39], v8 offset:5120
    ds_read_b128 v[40:43], v8 offset:6144
    v_rcp_f32 v48, v48
    v_rcp_f32 v49, v49
    v_rcp_f32 v52, v52
    v_mfma_f32_16x16x32_bf16 v[72:75], v[124:127], v[244:247], v[72:75]
    v_rcp_f32 v53, v53
    v_add_f32 v50, v50, v54
    v_add_f32 v51, v51, v55
    s_waitcnt lgkmcnt(4)
    v_mfma_f32_16x16x32_bf16 v[68:71], v[128:131], v[248:251], v[68:71]
    ds_read_b128 v[44:47], v8 offset:7168
    v_cndmask_b32 v54, v48, v49, s[98:99]
    v_cndmask_b32 v55, v52, v53, s[98:99]
    v_cndmask_b32 v54, v54, v55, s[100:101]
    v_mfma_f32_16x16x32_bf16 v[72:75], v[132:135], v[248:251], v[72:75]
    v_mul_f32 v50, v50, v54
    v_mul_f32 v51, v51, v54
    v_cvt_pk_bf16_f32 v88, v50, v51
    s_waitcnt lgkmcnt(4)
    v_mfma_f32_16x16x32_bf16 v[68:71], v[136:139], v[28:31], v[68:71]
    ds_read_b128 v[16:19], v8 offset:8192
    ds_write_b32 v11, v88 offset:36864
    v_mul_f32 v4, v4, v48
    v_mul_f32 v5, v5, v48
    v_mfma_f32_16x16x32_bf16 v[72:75], v[140:143], v[28:31], v[72:75]
    v_mul_f32 v6, v6, v48
    v_mul_f32 v7, v7, v48
    v_mul_f32 v84, v84, v49
    s_waitcnt lgkmcnt(5)
    v_mfma_f32_16x16x32_bf16 v[68:71], v[144:147], v[32:35], v[68:71]
    ds_read_b128 v[20:23], v8 offset:9216
    v_mul_f32 v85, v85, v49
    v_mul_f32 v86, v86, v49
    v_mul_f32 v87, v87, v49
    v_mfma_f32_16x16x32_bf16 v[72:75], v[148:151], v[32:35], v[72:75]
    v_mul_f32 v90, v90, v52
    v_mul_f32 v91, v91, v52
    v_mul_f32 v92, v92, v52
    s_waitcnt lgkmcnt(5)
    v_mfma_f32_16x16x32_bf16 v[68:71], v[152:155], v[36:39], v[68:71]
    ds_read_b128 v[24:27], v8 offset:10240
    v_mul_f32 v93, v93, v52
    v_mul_f32 v94, v94, v53
    v_mul_f32 v95, v95, v53
    v_mfma_f32_16x16x32_bf16 v[72:75], v[156:159], v[36:39], v[72:75]
    v_mul_f32 v96, v96, v53
    v_mul_f32 v97, v97, v53
    v_cvt_pk_bf16_f32 v4, v4, v5
    s_waitcnt lgkmcnt(5)
    v_mfma_f32_16x16x32_bf16 v[68:71], v[160:163], v[40:43], v[68:71]
    ds_read_b128 v[28:31], v8 offset:11264
    v_cvt_pk_bf16_f32 v5, v6, v7
    v_cvt_pk_bf16_f32 v6, v84, v85
    v_cvt_pk_bf16_f32 v7, v86, v87
    v_mfma_f32_16x16x32_bf16 v[72:75], v[164:167], v[40:43], v[72:75]
    ds_write_b128 v10, v[4:7] offset:36864
    v_cvt_pk_bf16_f32 v90, v90, v91
    v_cvt_pk_bf16_f32 v91, v92, v93
    s_waitcnt lgkmcnt(6)
    v_mfma_f32_16x16x32_bf16 v[68:71], v[168:171], v[44:47], v[68:71]
    ds_read_b128 v[32:35], v8 offset:12288
    v_cvt_pk_bf16_f32 v92, v94, v95
    v_cvt_pk_bf16_f32 v93, v96, v97
    ds_write_b128 v10, v[90:93] offset:37888
    v_mfma_f32_16x16x32_bf16 v[72:75], v[172:175], v[44:47], v[72:75]
    ds_read_b64_tr_b16 v[240:241], v0 offset:16384
    ds_read_b64_tr_b16 v[242:243], v0 offset:20480
    ds_read_b64_tr_b16 v[244:245], v1 offset:16384
    s_waitcnt lgkmcnt(10)
    v_mfma_f32_16x16x32_bf16 v[68:71], v[176:179], v[16:19], v[68:71]
    ds_read_b128 v[36:39], v8 offset:13312
    ds_read_b64_tr_b16 v[246:247], v1 offset:20480
    ds_read_b64_tr_b16 v[248:249], v0 offset:24576
    ds_read_b64_tr_b16 v[250:251], v0 offset:28672
    v_mfma_f32_16x16x32_bf16 v[72:75], v[180:183], v[16:19], v[72:75]
    ds_read_b64_tr_b16 v[252:253], v1 offset:24576
    ds_read_b64_tr_b16 v[254:255], v1 offset:28672
    v_rcp_f32 v56, v56
    s_waitcnt lgkmcnt(14)
    v_mfma_f32_16x16x32_bf16 v[68:71], v[184:187], v[20:23], v[68:71]
    ds_read_b128 v[40:43], v8 offset:14336
    v_rcp_f32 v57, v57
    v_rcp_f32 v60, v60
    v_rcp_f32 v61, v61
    v_mfma_f32_16x16x32_bf16 v[72:75], v[188:191], v[20:23], v[72:75]
    v_add_f32 v58, v58, v62
    v_add_f32 v59, v59, v63
    v_cndmask_b32 v62, v56, v57, s[98:99]
    s_waitcnt lgkmcnt(14)
    v_mfma_f32_16x16x32_bf16 v[68:71], v[192:195], v[24:27], v[68:71]
    ds_read_b128 v[44:47], v8 offset:15360
    v_cndmask_b32 v63, v60, v61, s[98:99]
    v_cndmask_b32 v62, v62, v63, s[100:101]
    v_mul_f32 v58, v58, v62
    v_mfma_f32_16x16x32_bf16 v[72:75], v[196:199], v[24:27], v[72:75]
    v_mul_f32 v59, v59, v62
    v_cvt_pk_bf16_f32 v102, v58, v59
    ds_write_b32 v11, v102 offset:55296
    s_waitcnt lgkmcnt(15)
    v_mfma_f32_16x16x32_bf16 v[68:71], v[200:203], v[28:31], v[68:71]
    ds_read_b128 v[16:19], v8 offset:16384
    v_mul_f32 v64, v64, v56
    v_mul_f32 v65, v65, v56
    v_mul_f32 v66, v66, v56
    v_mfma_f32_16x16x32_bf16 v[72:75], v[204:207], v[28:31], v[72:75]
    v_mul_f32 v67, v67, v56
    v_mul_f32 v98, v98, v57
    v_mul_f32 v99, v99, v57
    s_waitcnt lgkmcnt(14)
    v_mfma_f32_16x16x32_bf16 v[68:71], v[208:211], v[32:35], v[68:71]
    ds_read_b128 v[20:23], v8 offset:17408
    v_mul_f32 v100, v100, v57
    v_mul_f32 v101, v101, v57
    v_mul_f32 v104, v104, v60
    v_mfma_f32_16x16x32_bf16 v[72:75], v[212:215], v[32:35], v[72:75]
    v_mul_f32 v105, v105, v60
    v_mul_f32 v106, v106, v60
    v_mul_f32 v107, v107, v60
    s_waitcnt lgkmcnt(10)
    v_mfma_f32_16x16x32_bf16 v[68:71], v[216:219], v[36:39], v[68:71]
    v_mul_f32 v108, v108, v61
    v_mul_f32 v109, v109, v61
    v_mul_f32 v110, v110, v61
    v_mfma_f32_16x16x32_bf16 v[72:75], v[220:223], v[36:39], v[72:75]
    v_mul_f32 v111, v111, v61
    v_cvt_pk_bf16_f32 v64, v64, v65
    v_cvt_pk_bf16_f32 v65, v66, v67
    s_waitcnt lgkmcnt(4)
    v_mfma_f32_16x16x32_bf16 v[68:71], v[224:227], v[40:43], v[68:71]
    v_cvt_pk_bf16_f32 v66, v98, v99
    v_cvt_pk_bf16_f32 v67, v100, v101
    ds_write_b128 v10, v[64:67] offset:55296
    v_mfma_f32_16x16x32_bf16 v[72:75], v[228:231], v[40:43], v[72:75]
    v_cvt_pk_bf16_f32 v104, v104, v105
    v_cvt_pk_bf16_f32 v105, v106, v107
    v_cvt_pk_bf16_f32 v106, v108, v109
    s_waitcnt lgkmcnt(4)
    v_mfma_f32_16x16x32_bf16 v[68:71], v[232:235], v[44:47], v[68:71]
    v_cvt_pk_bf16_f32 v107, v110, v111
    ds_write_b128 v10, v[104:107] offset:56320
    v_mfma_f32_16x16x32_bf16 v[72:75], v[236:239], v[44:47], v[72:75]
    s_waitcnt lgkmcnt(3)
    v_mfma_f32_16x16x32_bf16 v[68:71], v[240:243], v[16:19], v[68:71]
    v_mfma_f32_16x16x32_bf16 v[72:75], v[244:247], v[16:19], v[72:75]
    s_waitcnt lgkmcnt(2)
    v_mfma_f32_16x16x32_bf16 v[68:71], v[248:251], v[20:23], v[68:71]
    v_mfma_f32_16x16x32_bf16 v[72:75], v[252:255], v[20:23], v[72:75]
    s_waitcnt lgkmcnt(0)
    s_barrier
    s_cmp_ge_u32 s50, 1152
    s_cbranch_scc1 L_narrow
    ds_read_b128 v[16:19], v8 offset:36864
    ds_read_b128 v[20:23], v8 offset:37888
    ds_read_b128 v[24:27], v8 offset:38912
    ds_read_b128 v[28:31], v8 offset:39936
    ds_read_b128 v[32:35], v8 offset:40960
    s_waitcnt lgkmcnt(4)
    v_mfma_f32_16x16x32_bf16 v[76:79], v[112:115], v[16:19], 0
    ds_read_b128 v[36:39], v8 offset:41984
    s_nop 0
    s_nop 0
    v_mfma_f32_16x16x32_bf16 v[80:83], v[116:119], v[16:19], 0
    s_nop 0
    s_nop 0
    s_waitcnt lgkmcnt(4)
    v_mfma_f32_16x16x32_bf16 v[76:79], v[120:123], v[20:23], v[76:79]
    ds_read_b128 v[40:43], v8 offset:43008
    v_cvt_pk_bf16_f32 v84, v68, v69
    v_cvt_pk_bf16_f32 v85, v70, v71
    v_mfma_f32_16x16x32_bf16 v[80:83], v[124:127], v[20:23], v[80:83]
    v_cvt_pk_bf16_f32 v86, v72, v73
    v_cvt_pk_bf16_f32 v87, v74, v75
    s_waitcnt lgkmcnt(4)
    v_mfma_f32_16x16x32_bf16 v[76:79], v[128:131], v[24:27], v[76:79]
    ds_read_b128 v[44:47], v8 offset:44032
    v_nop
    v_permlane16_swap_b32 v84, v86
    v_mfma_f32_16x16x32_bf16 v[80:83], v[132:135], v[24:27], v[80:83]
    v_permlane16_swap_b32 v85, v87
    ds_write_b128 v2, v[84:87] offset:0
    s_waitcnt lgkmcnt(5)
    v_mfma_f32_16x16x32_bf16 v[76:79], v[136:139], v[28:31], v[76:79]
    ds_read_b128 v[16:19], v8 offset:45056
    v_mfma_f32_16x16x32_bf16 v[80:83], v[140:143], v[28:31], v[80:83]
    s_waitcnt lgkmcnt(5)
    v_mfma_f32_16x16x32_bf16 v[76:79], v[144:147], v[32:35], v[76:79]
    ds_read_b128 v[20:23], v8 offset:46080
    v_mfma_f32_16x16x32_bf16 v[80:83], v[148:151], v[32:35], v[80:83]
    s_waitcnt lgkmcnt(5)
    v_mfma_f32_16x16x32_bf16 v[76:79], v[152:155], v[36:39], v[76:79]
    ds_read_b128 v[24:27], v8 offset:47104
    v_mfma_f32_16x16x32_bf16 v[80:83], v[156:159], v[36:39], v[80:83]
    s_waitcnt lgkmcnt(5)
    v_mfma_f32_16x16x32_bf16 v[76:79], v[160:163], v[40:43], v[76:79]
    ds_read_b128 v[28:31], v8 offset:48128
    v_mfma_f32_16x16x32_bf16 v[80:83], v[164:167], v[40:43], v[80:83]
    s_waitcnt lgkmcnt(5)
    v_mfma_f32_16x16x32_bf16 v[76:79], v[168:171], v[44:47], v[76:79]
    ds_read_b128 v[32:35], v8 offset:49152
    v_mfma_f32_16x16x32_bf16 v[80:83], v[172:175], v[44:47], v[80:83]
    s_waitcnt lgkmcnt(5)
    s_barrier
    ds_read_b128 v[92:95], v9 offset:0
    s_waitcnt lgkmcnt(5)
    v_mfma_f32_16x16x32_bf16 v[76:79], v[176:179], v[16:19], v[76:79]
    ds_read_b128 v[36:39], v8 offset:50176
    v_mfma_f32_16x16x32_bf16 v[80:83], v[180:183], v[16:19], v[80:83]
    s_waitcnt lgkmcnt(5)
    v_mfma_f32_16x16x32_bf16 v[76:79], v[184:187], v[20:23], v[76:79]
    ds_read_b128 v[40:43], v8 offset:51200
    v_mfma_f32_16x16x32_bf16 v[80:83], v[188:191], v[20:23], v[80:83]
    s_waitcnt lgkmcnt(5)
    v_mfma_f32_16x16x32_bf16 v[76:79], v[192:195], v[24:27], v[76:79]
    ds_read_b128 v[44:47], v8 offset:52224
    v_mfma_f32_16x16x32_bf16 v[80:83], v[196:199], v[24:27], v[80:83]
    s_waitcnt lgkmcnt(5)
    v_mfma_f32_16x16x32_bf16 v[76:79], v[200:203], v[28:31], v[76:79]
    ds_read_b128 v[16:19], v8 offset:53248
    v_mfma_f32_16x16x32_bf16 v[80:83], v[204:207], v[28:31], v[80:83]
    s_waitcnt lgkmcnt(4)
    s_mov_b64 exec, s[60:61]
    global_store_dwordx4 v3, v[92:95], s[24:25] sc1
    s_mov_b64 exec, -1
    v_mfma_f32_16x16x32_bf16 v[76:79], v[208:211], v[32:35], v[76:79]
    ds_read_b128 v[20:23], v8 offset:54272
    v_mfma_f32_16x16x32_bf16 v[80:83], v[212:215], v[32:35], v[80:83]
    s_waitcnt lgkmcnt(4)
    v_mfma_f32_16x16x32_bf16 v[76:79], v[216:219], v[36:39], v[76:79]
    v_mfma_f32_16x16x32_bf16 v[80:83], v[220:223], v[36:39], v[80:83]
    s_waitcnt lgkmcnt(3)
    v_mfma_f32_16x16x32_bf16 v[76:79], v[224:227], v[40:43], v[76:79]
    v_mfma_f32_16x16x32_bf16 v[80:83], v[228:231], v[40:43], v[80:83]
    s_waitcnt lgkmcnt(2)
    v_mfma_f32_16x16x32_bf16 v[76:79], v[232:235], v[44:47], v[76:79]
    v_mfma_f32_16x16x32_bf16 v[80:83], v[236:239], v[44:47], v[80:83]
    s_waitcnt lgkmcnt(1)
    v_mfma_f32_16x16x32_bf16 v[76:79], v[240:243], v[16:19], v[76:79]
    v_mfma_f32_16x16x32_bf16 v[80:83], v[244:247], v[16:19], v[80:83]
    s_waitcnt lgkmcnt(0)
    v_mfma_f32_16x16x32_bf16 v[76:79], v[248:251], v[20:23], v[76:79]
    v_mfma_f32_16x16x32_bf16 v[80:83], v[252:255], v[20:23], v[80:83]
    s_nop 6
    v_cvt_pk_bf16_f32 v88, v76, v77
    v_cvt_pk_bf16_f32 v89, v78, v79
    v_cvt_pk_bf16_f32 v90, v80, v81
    v_cvt_pk_bf16_f32 v91, v82, v83
    v_nop
    v_permlane16_swap_b32 v88, v90
    v_permlane16_swap_b32 v89, v91
    ds_write_b128 v2, v[88:91] offset:8192
    s_waitcnt lgkmcnt(0)
    s_barrier
    ds_read_b128 v[96:99], v9 offset:8192
    s_waitcnt lgkmcnt(0)
    v_add_u32 v3, s37, v3
    s_mov_b64 exec, s[60:61]
    global_store_dwordx4 v3, v[96:99], s[24:25] sc1
    s_mov_b64 exec, -1
    s_branch L_fin
L_narrow:
    s_barrier
    ds_read_b128 v[92:95], v9 offset:0
    s_waitcnt lgkmcnt(0)
    s_mov_b64 exec, s[60:61]
    global_store_dwordx4 v3, v[92:95], s[24:25] sc1
    s_mov_b64 exec, -1
    s_barrier
    ds_read_b128 v[96:99], v9 offset:8192
    s_waitcnt lgkmcnt(0)
    v_add_u32 v3, s37, v3
    s_mov_b64 exec, s[60:61]
    global_store_dwordx4 v3, v[96:99], s[24:25] sc1
    s_mov_b64 exec, -1
    s_branch L_fin
L_spare:
    s_cmp_lg_u32 s42, 0
    s_cbranch_scc1 L_end
    v_lshlrev_b32 v2, 4, v0
    v_mov_b32 v4, 0
    v_mov_b32 v5, 0
    v_mov_b32 v6, 0
    v_mov_b32 v7, 0
    s_mov_b32 s33, 0
    s_waitcnt lgkmcnt(0)
    s_mov_b32 s56, s28
    s_mov_b32 s57, s29
    s_mov_b32 s58, 4194304
    s_mov_b32 s59, 0x20000
    s_mov_b32 s60, s26
    s_mov_b32 s61, s27
    s_mov_b32 s62, 256
    s_mov_b32 s63, 0x20000
    buffer_store_dwordx4 v[4:7], v2, s[56:59], s33 offen sc1
    s_add_u32 s33, s33, 8192
    buffer_store_dwordx4 v[4:7], v2, s[56:59], s33 offen sc1
    s_add_u32 s33, s33, 8192
    buffer_store_dwordx4 v[4:7], v2, s[56:59], s33 offen sc1
    s_add_u32 s33, s33, 8192
    buffer_store_dwordx4 v[4:7], v2, s[56:59], s33 offen sc1
    s_add_u32 s33, s33, 8192
    buffer_store_dwordx4 v[4:7], v2, s[56:59], s33 offen sc1
    s_add_u32 s33, s33, 8192
    buffer_store_dwordx4 v[4:7], v2, s[56:59], s33 offen sc1
    s_add_u32 s33, s33, 8192
    buffer_store_dwordx4 v[4:7], v2, s[56:59], s33 offen sc1
    s_add_u32 s33, s33, 8192
    buffer_store_dwordx4 v[4:7], v2, s[56:59], s33 offen sc1
    s_add_u32 s33, s33, 8192
    buffer_store_dwordx4 v[4:7], v2, s[56:59], s33 offen sc1
    s_add_u32 s33, s33, 8192
    s_waitcnt vmcnt(0)
    s_barrier
    s_cmp_lg_u32 s31, 0
    s_cbranch_scc1 L_fin
    v_mov_b32 v8, 1
    s_mov_b64 exec, 1
    buffer_atomic_add v8, v4, s[60:63], 0 offen
    s_mov_b64 exec, -1
    s_branch L_fin
L_rolea:
    s_lshl_b32 s30, s42, 3
    s_add_u32 s30, s30, s43
    s_sub_u32 s30, s30, 23
    s_add_u32 s33, s42, 64
    s_cmp_eq_u32 s43, 31
    s_cselect_b32 s30, s33, s30
    s_lshl_b32 s32, s30, 3
    s_add_u32 s32, s32, s31
    s_lshl_b32 s33, s32, 8
    v_lshl_add_u32 v2, v1, 2, s33
    s_lshl_b32 s33, s32, 1
    v_mov_b32 v3, s33
    s_waitcnt lgkmcnt(0)
    global_load_dword v10, v2, s[6:7]
    global_load_ushort v14, v3, s[14:15]
    global_load_dword v11, v2, s[8:9]
    global_load_dword v12, v2, s[10:11]
    global_load_dword v13, v2, s[12:13]
    global_load_ushort v15, v3, s[16:17]
    v_mul_u32_u24 v252, 1152, v0
    s_lshl_b32 s33, s30, 4
    v_add_u32 v252, s33, v252
    s_mov_b64 s[44:45], s[4:5]
    s_mov_b32 s46, 2359296
    s_mov_b32 s47, 0x20000
    s_lshl_b32 s48, s31, 10
    s_add_u32 s48, s48, 107136
    s_and_b32 s49, s30, 1
    s_mov_b32 s57, s30
    v_and_b32 v5, 15, v1
    v_lshrrev_b32 v6, 4, v1
    s_mul_i32 s34, s31, 8768
    s_add_u32 s34, s34, 36992
    s_mul_i32 s35, s31, 4624
    v_lshl_add_u32 v7, v1, 3, s34
    v_mul_u32_u24 v8, 544, v5
    v_lshl_add_u32 v8, v6, 4, v8
    v_add_u32 v8, s34, v8
    v_mov_b32 v16, 0
    v_mov_b32 v17, 0
    v_lshl_add_u32 v9, v1, 3, s35
    ds_write_b64 v9, v[16:17]
    s_mov_b32 s36, 0x3fb8aa3b
    s_mov_b32 s37, 0x32a57060
    s_mov_b32 s38, 0x3f317218
    s_mov_b32 s39, 0xffff0000
    v_lshlrev_b32 v20, 3, v6
    v_sub_u32 v20, v20, v5
    v_add_u32 v21, 1, v20
    s_mov_b32 s40, 0x05040100
    v_perm_b32 v20, v21, v20, s40
    s_mov_b32 s41, 0x3f803f80
    s_mov_b32 s50, 0x00010001
    s_lshl_b32 s3, s31, 2
    s_lshr_b32 s52, 0xcc5436b6, s3
    s_and_b32 s52, s52, 15
    s_mul_i32 s52, s52, s50
    s_lshr_b32 s51, 0x22793535, s3
    s_and_b32 s51, s51, 15
    s_mul_i32 s51, s51, s50
    s_cmp_lt_u32 s31, 6
    s_cselect_b32 s41, s41, s50
    v_pk_sub_u16 v20, v20, s52
    v_pk_sub_u16 v224, s51, v20 clamp
    v_pk_min_u16 v224, v224, s50
    v_pk_mul_lo_u16 v224, v224, s41
    s_mov_b32 s52, 0x20002
    v_pk_add_u16 v225, v20, s52
    v_pk_sub_u16 v225, s51, v225 clamp
    v_pk_min_u16 v225, v225, s50
    v_pk_mul_lo_u16 v225, v225, s41
    s_mov_b32 s52, 0x40004
    v_pk_add_u16 v226, v20, s52
    v_pk_sub_u16 v226, s51, v226 clamp
    v_pk_min_u16 v226, v226, s50
    v_pk_mul_lo_u16 v226, v226, s41
    s_mov_b32 s52, 0x60006
    v_pk_add_u16 v227, v20, s52
    v_pk_sub_u16 v227, s51, v227 clamp
    v_pk_min_u16 v227, v227, s50
    v_pk_mul_lo_u16 v227, v227, s41
    v_lshlrev_b32 v222, 4, v1
    v_add_u32 v222, 139904, v222
    s_lshl_b32 s3, s31, 10
    v_add_u32 v21, s3, v222
    ds_write_b128 v21, v[224:227]
    s_and_b32 s58, s30, 7
    s_lshl_b32 s3, s31, 3
    s_add_u32 s58, s58, s3
    s_lshl_b32 s3, s58, 13
    v_lshl_add_u32 v220, v1, 7, s3
    v_min_u32 v216, 14, v5
    v_mul_u32_u24 v217, 52, v216
    v_lshrrev_b32 v217, 8, v217
    v_mul_u32_u24 v217, 512, v217
    v_lshl_add_u32 v216, v216, 7, v217
    v_mul_u32_u24 v217, 3456, v6
    s_mul_i32 s59, s58, 13824
    s_and_b32 s3, s2, 4
    s_lshl_b32 s3, s3, 7
    s_add_u32 s59, s59, s3
    s_add_u32 s59, s59, 1769472
    v_add3_u32 v216, v216, v217, s59
    s_and_b32 s3, s2, 3
    s_lshl_b32 s3, s3, 9
    s_lshl_b32 s59, s58, 6
    s_add_u32 s3, s3, s59
    s_sub_u32 s3, s3, 1088
    v_add_u32 v217, s3, v1
    v_max_i32 v217, 0, v217
    v_min_i32 v217, 2047, v217
    v_mul_u32_u24 v217, 1152, v217
    v_add_u32 v217, 1024, v217
    v_add_u32 v221, 311296, v220
    v_min_u32 v221, 663548, v221
    s_cmp_lt_u32 s58, 26
    s_cselect_b64 vcc, -1, 0
    s_cselect_b64 s[54:55], s[18:19], s[22:23]
    v_cndmask_b32 v221, v221, v217, vcc
    s_cmp_lt_u32 s58, 16
    s_cselect_b64 vcc, -1, 0
    s_cselect_b64 s[54:55], s[20:21], s[54:55]
    v_cndmask_b32 v221, v221, v216, vcc
    s_movk_i32 s56, 128
    s_cselect_b32 s56, 221184, s56
    s_waitcnt vmcnt(4)
    v_lshlrev_b32 v20, 16, v10
    v_and_b32 v21, s39, v10
    v_lshlrev_b32 v14, 16, v14
    v_mul_f32 v22, s36, v14
    v_fma_f32 v23, v14, s36, -v22
    v_fmac_f32 v23, s37, v14
    v_exp_f32 v22, v22
    v_mul_f32 v23, s38, v23
    v_fma_f32 v22, v22, v23, v22
    v_cvt_pk_bf16_f32 v22, v22, v22
    v_and_b32 v18, s39, v22
    v_mul_f32 v22, s36, v20
    v_fma_f32 v23, v20, s36, -v22
    v_fmac_f32 v23, s37, v20
    v_exp_f32 v22, v22
    v_mul_f32 v23, s38, v23
    v_fma_f32 v22, v22, v23, v22
    v_cvt_pk_bf16_f32 v22, v22, v22
    v_and_b32 v20, s39, v22
    v_mul_f32 v24, s36, v21
    v_fma_f32 v25, v21, s36, -v24
    v_fmac_f32 v25, s37, v21
    v_exp_f32 v24, v24
    v_mul_f32 v25, s38, v25
    v_fma_f32 v24, v24, v25, v24
    v_cvt_pk_bf16_f32 v24, v24, v24
    v_and_b32 v21, s39, v24
    v_mul_f32 v20, v20, v18
    v_mul_f32 v21, v21, v18
    v_mul_f32 v20, s36, v20
    v_mul_f32 v21, s36, v21
    s_waitcnt vmcnt(0)
    v_lshlrev_b32 v22, 16, v11
    v_and_b32 v23, s39, v11
    v_mul_f32 v22, v22, v18
    v_mul_f32 v23, v23, v18
    v_mul_f32 v22, 0.15915494, v22
    v_mul_f32 v23, 0.15915494, v23
    v_add_f32 v19, v18, v18
    v_lshlrev_b32 v24, 16, v12
    v_and_b32 v25, s39, v12
    v_lshlrev_b32 v26, 16, v13
    v_and_b32 v27, s39, v13
    v_mul_f32 v24, v24, v19
    v_mul_f32 v25, v25, v19
    v_mul_f32_e64 v26, v26, -v19
    v_mul_f32_e64 v27, v27, -v19
    v_lshlrev_b32 v15, 16, v15
    v_mul_f32 v60, 0xc1800000, v20
    v_mul_f32 v62, 0x41800000, v22
    v_mul_f32 v61, 0xc1800000, v21
    v_mul_f32 v63, 0x41800000, v23
    v_exp_f32 v60, v60
    v_fract_f32 v62, v62
    v_exp_f32 v61, v61
    v_fract_f32 v63, v63
    v_cos_f32 v28, v62
    v_sin_f32 v30, v62
    v_cos_f32 v29, v63
    v_sin_f32 v31, v63
    v_pk_mul_f32 v[28:29], v[28:29], v[60:61]
    v_pk_mul_f32 v[30:31], v[30:31], v[60:61]
    v_mov_b32 v72, 0x3f80
    v_mov_b32 v73, 0x3f80
    ds_write_b64 v7, v[72:73]
    v_cvt_pk_bf16_f32 v74, v28, v30
    v_cvt_pk_bf16_f32 v75, v29, v31
    ds_write_b64 v7, v[74:75] offset:544
    v_pk_mul_f32 v[64:65], v[30:31], v[30:31]
    v_pk_mul_f32 v[66:67], v[30:31], v[28:29]
    v_pk_fma_f32 v[52:53], v[28:29], v[28:29], v[64:65] neg_lo:[0,0,1] neg_hi:[0,0,1]
    v_pk_fma_f32 v[54:55], v[28:29], v[30:31], v[66:67]
    v_cvt_pk_bf16_f32 v76, v52, v54
    v_cvt_pk_bf16_f32 v77, v53, v55
    ds_write_b64 v7, v[76:77] offset:1088
    v_pk_mul_f32 v[68:69], v[54:55], v[30:31]
    v_pk_mul_f32 v[70:71], v[54:55], v[28:29]
    v_pk_fma_f32 v[56:57], v[52:53], v[28:29], v[68:69] neg_lo:[0,0,1] neg_hi:[0,0,1]
    v_pk_fma_f32 v[58:59], v[52:53], v[30:31], v[70:71]
    v_cvt_pk_bf16_f32 v78, v56, v58
    v_cvt_pk_bf16_f32 v79, v57, v59
    ds_write_b64 v7, v[78:79] offset:1632
    v_pk_mul_f32 v[64:65], v[58:59], v[30:31]
    v_pk_mul_f32 v[66:67], v[58:59], v[28:29]
    v_pk_fma_f32 v[52:53], v[56:57], v[28:29], v[64:65] neg_lo:[0,0,1] neg_hi:[0,0,1]
    v_pk_fma_f32 v[54:55], v[56:57], v[30:31], v[66:67]
    v_cvt_pk_bf16_f32 v72, v52, v54
    v_cvt_pk_bf16_f32 v73, v53, v55
    ds_write_b64 v7, v[72:73] offset:2176
    v_pk_mul_f32 v[68:69], v[54:55], v[30:31]
    v_pk_mul_f32 v[70:71], v[54:55], v[28:29]
    v_pk_fma_f32 v[56:57], v[52:53], v[28:29], v[68:69] neg_lo:[0,0,1] neg_hi:[0,0,1]
    v_pk_fma_f32 v[58:59], v[52:53], v[30:31], v[70:71]
    v_cvt_pk_bf16_f32 v74, v56, v58
    v_cvt_pk_bf16_f32 v75, v57, v59
    ds_write_b64 v7, v[74:75] offset:2720
    v_pk_mul_f32 v[64:65], v[58:59], v[30:31]
    v_pk_mul_f32 v[66:67], v[58:59], v[28:29]
    v_pk_fma_f32 v[52:53], v[56:57], v[28:29], v[64:65] neg_lo:[0,0,1] neg_hi:[0,0,1]
    v_pk_fma_f32 v[54:55], v[56:57], v[30:31], v[66:67]
    v_cvt_pk_bf16_f32 v76, v52, v54
    v_cvt_pk_bf16_f32 v77, v53, v55
    ds_write_b64 v7, v[76:77] offset:3264
    v_pk_mul_f32 v[68:69], v[54:55], v[30:31]
    v_pk_mul_f32 v[70:71], v[54:55], v[28:29]
    v_pk_fma_f32 v[56:57], v[52:53], v[28:29], v[68:69] neg_lo:[0,0,1] neg_hi:[0,0,1]
    v_pk_fma_f32 v[58:59], v[52:53], v[30:31], v[70:71]
    v_cvt_pk_bf16_f32 v78, v56, v58
    v_cvt_pk_bf16_f32 v79, v57, v59
    ds_write_b64 v7, v[78:79] offset:3808
    v_pk_mul_f32 v[64:65], v[58:59], v[30:31]
    v_pk_mul_f32 v[66:67], v[58:59], v[28:29]
    v_pk_fma_f32 v[52:53], v[56:57], v[28:29], v[64:65] neg_lo:[0,0,1] neg_hi:[0,0,1]
    v_pk_fma_f32 v[54:55], v[56:57], v[30:31], v[66:67]
    v_cvt_pk_bf16_f32 v72, v52, v54
    v_cvt_pk_bf16_f32 v73, v53, v55
    ds_write_b64 v7, v[72:73] offset:4352
    v_pk_mul_f32 v[68:69], v[54:55], v[30:31]
    v_pk_mul_f32 v[70:71], v[54:55], v[28:29]
    v_pk_fma_f32 v[56:57], v[52:53], v[28:29], v[68:69] neg_lo:[0,0,1] neg_hi:[0,0,1]
    v_pk_fma_f32 v[58:59], v[52:53], v[30:31], v[70:71]
    v_cvt_pk_bf16_f32 v74, v56, v58
    v_cvt_pk_bf16_f32 v75, v57, v59
    ds_write_b64 v7, v[74:75] offset:4896
    v_pk_mul_f32 v[64:65], v[58:59], v[30:31]
    v_pk_mul_f32 v[66:67], v[58:59], v[28:29]
    v_pk_fma_f32 v[52:53], v[56:57], v[28:29], v[64:65] neg_lo:[0,0,1] neg_hi:[0,0,1]
    v_pk_fma_f32 v[54:55], v[56:57], v[30:31], v[66:67]
    v_cvt_pk_bf16_f32 v76, v52, v54
    v_cvt_pk_bf16_f32 v77, v53, v55
    ds_write_b64 v7, v[76:77] offset:5440
    v_pk_mul_f32 v[68:69], v[54:55], v[30:31]
    v_pk_mul_f32 v[70:71], v[54:55], v[28:29]
    v_pk_fma_f32 v[56:57], v[52:53], v[28:29], v[68:69] neg_lo:[0,0,1] neg_hi:[0,0,1]
    v_pk_fma_f32 v[58:59], v[52:53], v[30:31], v[70:71]
    v_cvt_pk_bf16_f32 v78, v56, v58
    v_cvt_pk_bf16_f32 v79, v57, v59
    ds_write_b64 v7, v[78:79] offset:5984
    v_pk_mul_f32 v[64:65], v[58:59], v[30:31]
    v_pk_mul_f32 v[66:67], v[58:59], v[28:29]
    v_pk_fma_f32 v[52:53], v[56:57], v[28:29], v[64:65] neg_lo:[0,0,1] neg_hi:[0,0,1]
    v_pk_fma_f32 v[54:55], v[56:57], v[30:31], v[66:67]
    v_cvt_pk_bf16_f32 v72, v52, v54
    v_cvt_pk_bf16_f32 v73, v53, v55
    ds_write_b64 v7, v[72:73] offset:6528
    v_pk_mul_f32 v[68:69], v[54:55], v[30:31]
    v_pk_mul_f32 v[70:71], v[54:55], v[28:29]
    v_pk_fma_f32 v[56:57], v[52:53], v[28:29], v[68:69] neg_lo:[0,0,1] neg_hi:[0,0,1]
    v_pk_fma_f32 v[58:59], v[52:53], v[30:31], v[70:71]
    v_cvt_pk_bf16_f32 v74, v56, v58
    v_cvt_pk_bf16_f32 v75, v57, v59
    ds_write_b64 v7, v[74:75] offset:7072
    v_pk_mul_f32 v[64:65], v[58:59], v[30:31]
    v_pk_mul_f32 v[66:67], v[58:59], v[28:29]
    v_pk_fma_f32 v[52:53], v[56:57], v[28:29], v[64:65] neg_lo:[0,0,1] neg_hi:[0,0,1]
    v_pk_fma_f32 v[54:55], v[56:57], v[30:31], v[66:67]
    v_cvt_pk_bf16_f32 v76, v52, v54
    v_cvt_pk_bf16_f32 v77, v53, v55
    ds_write_b64 v7, v[76:77] offset:7616
    v_pk_mul_f32 v[68:69], v[54:55], v[30:31]
    v_pk_mul_f32 v[70:71], v[54:55], v[28:29]
    v_pk_fma_f32 v[56:57], v[52:53], v[28:29], v[68:69] neg_lo:[0,0,1] neg_hi:[0,0,1]
    v_pk_fma_f32 v[58:59], v[52:53], v[30:31], v[70:71]
    v_cvt_pk_bf16_f32 v78, v56, v58
    v_cvt_pk_bf16_f32 v79, v57, v59
    ds_write_b64 v7, v[78:79] offset:8160
    ds_read_b128 v[96:99], v8 offset:0
    ds_read_b128 v[100:103], v8 offset:64
    ds_read_b128 v[104:107], v8 offset:128
    ds_read_b128 v[108:111], v8 offset:192
    ds_read_b128 v[112:115], v8 offset:256
    ds_read_b128 v[116:119], v8 offset:320
    ds_read_b128 v[120:123], v8 offset:384
    ds_read_b128 v[124:127], v8 offset:448
    v_mul_f32 v60, 0xbf800000, v20
    v_mul_f32 v62, 0xbf800000, v22
    v_mul_f32 v61, 0xbf800000, v21
    v_mul_f32 v63, 0xbf800000, v23
    v_exp_f32 v60, v60
    v_fract_f32 v62, v62
    v_exp_f32 v61, v61
    v_fract_f32 v63, v63
    v_cos_f32 v32, v62
    v_sin_f32 v34, v62
    v_cos_f32 v33, v63
    v_sin_f32 v35, v63
    v_pk_mul_f32 v[32:33], v[32:33], v[60:61]
    v_pk_mul_f32 v[34:35], v[34:35], v[60:61]
    s_lshl_b32 s3, s49, 13
    s_add_u32 s3, s48, s3
    s_add_u32 m0, s3, 0
    s_mul_i32 s3, s49, 589824
    s_xor_b32 s49, s49, 1
    buffer_load_dwordx4 v252, s[44:47], s3 offen lds
    v_mul_f32 v60, 0xc3800000, v20
    v_mul_f32 v62, 0xc3800000, v22
    v_mul_f32 v61, 0xc3800000, v21
    v_mul_f32 v63, 0xc3800000, v23
    v_exp_f32 v60, v60
    v_fract_f32 v62, v62
    v_exp_f32 v61, v61
    v_fract_f32 v63, v63
    v_cos_f32 v36, v62
    v_sin_f32 v38, v62
    v_cos_f32 v37, v63
    v_sin_f32 v39, v63
    v_pk_mul_f32 v[36:37], v[36:37], v[60:61]
    v_pk_mul_f32 v[38:39], v[38:39], v[60:61]
    v_cvt_pk_bf16_f32 v72, v24, v26
    v_cvt_pk_bf16_f32 v73, v25, v27
    ds_write_b64 v7, v[72:73] offset:0
    v_pk_mul_f32 v[64:65], v[26:27], v[34:35]
    v_pk_mul_f32 v[66:67], v[26:27], v[32:33]
    v_pk_fma_f32 v[52:53], v[24:25], v[32:33], v[64:65] neg_lo:[0,0,1] neg_hi:[0,0,1]
    v_pk_fma_f32 v[54:55], v[24:25], v[34:35], v[66:67]
    v_cvt_pk_bf16_f32 v74, v52, v54
    v_cvt_pk_bf16_f32 v75, v53, v55
    ds_write_b64 v7, v[74:75] offset:544
    v_pk_mul_f32 v[68:69], v[54:55], v[34:35]
    v_pk_mul_f32 v[70:71], v[54:55], v[32:33]
    v_pk_fma_f32 v[56:57], v[52:53], v[32:33], v[68:69] neg_lo:[0,0,1] neg_hi:[0,0,1]
    v_pk_fma_f32 v[58:59], v[52:53], v[34:35], v[70:71]
    v_cvt_pk_bf16_f32 v76, v56, v58
    v_cvt_pk_bf16_f32 v77, v57, v59
    ds_write_b64 v7, v[76:77] offset:1088
    v_pk_mul_f32 v[64:65], v[58:59], v[34:35]
    v_pk_mul_f32 v[66:67], v[58:59], v[32:33]
    v_pk_fma_f32 v[52:53], v[56:57], v[32:33], v[64:65] neg_lo:[0,0,1] neg_hi:[0,0,1]
    v_pk_fma_f32 v[54:55], v[56:57], v[34:35], v[66:67]
    v_cvt_pk_bf16_f32 v78, v52, v54
    v_cvt_pk_bf16_f32 v79, v53, v55
    ds_write_b64 v7, v[78:79] offset:1632
    v_pk_mul_f32 v[68:69], v[54:55], v[34:35]
    v_pk_mul_f32 v[70:71], v[54:55], v[32:33]
    v_pk_fma_f32 v[56:57], v[52:53], v[32:33], v[68:69] neg_lo:[0,0,1] neg_hi:[0,0,1]
    v_pk_fma_f32 v[58:59], v[52:53], v[34:35], v[70:71]
    v_cvt_pk_bf16_f32 v72, v56, v58
    v_cvt_pk_bf16_f32 v73, v57, v59
    ds_write_b64 v7, v[72:73] offset:2176
    v_pk_mul_f32 v[64:65], v[58:59], v[34:35]
    v_pk_mul_f32 v[66:67], v[58:59], v[32:33]
    v_pk_fma_f32 v[52:53], v[56:57], v[32:33], v[64:65] neg_lo:[0,0,1] neg_hi:[0,0,1]
    v_pk_fma_f32 v[54:55], v[56:57], v[34:35], v[66:67]
    v_cvt_pk_bf16_f32 v74, v52, v54
    v_cvt_pk_bf16_f32 v75, v53, v55
    ds_write_b64 v7, v[74:75] offset:2720
    v_pk_mul_f32 v[68:69], v[54:55], v[34:35]
    v_pk_mul_f32 v[70:71], v[54:55], v[32:33]
    v_pk_fma_f32 v[56:57], v[52:53], v[32:33], v[68:69] neg_lo:[0,0,1] neg_hi:[0,0,1]
    v_pk_fma_f32 v[58:59], v[52:53], v[34:35], v[70:71]
    v_cvt_pk_bf16_f32 v76, v56, v58
    v_cvt_pk_bf16_f32 v77, v57, v59
    ds_write_b64 v7, v[76:77] offset:3264
    v_pk_mul_f32 v[64:65], v[58:59], v[34:35]
    v_pk_mul_f32 v[66:67], v[58:59], v[32:33]
    v_pk_fma_f32 v[52:53], v[56:57], v[32:33], v[64:65] neg_lo:[0,0,1] neg_hi:[0,0,1]
    v_pk_fma_f32 v[54:55], v[56:57], v[34:35], v[66:67]
    v_cvt_pk_bf16_f32 v78, v52, v54
    v_cvt_pk_bf16_f32 v79, v53, v55
    ds_write_b64 v7, v[78:79] offset:3808
    v_pk_mul_f32 v[68:69], v[54:55], v[34:35]
    v_pk_mul_f32 v[70:71], v[54:55], v[32:33]
    v_pk_fma_f32 v[56:57], v[52:53], v[32:33], v[68:69] neg_lo:[0,0,1] neg_hi:[0,0,1]
    v_pk_fma_f32 v[58:59], v[52:53], v[34:35], v[70:71]
    v_cvt_pk_bf16_f32 v72, v56, v58
    v_cvt_pk_bf16_f32 v73, v57, v59
    ds_write_b64 v7, v[72:73] offset:4352
    s_lshl_b32 s3, s49, 13
    s_add_u32 s3, s48, s3
    s_add_u32 m0, s3, 0
    s_mul_i32 s3, s49, 589824
    s_xor_b32 s49, s49, 1
    buffer_load_dwordx4 v252, s[44:47], s3 offen lds
    v_pk_mul_f32 v[64:65], v[58:59], v[34:35]
    v_pk_mul_f32 v[66:67], v[58:59], v[32:33]
    v_pk_fma_f32 v[52:53], v[56:57], v[32:33], v[64:65] neg_lo:[0,0,1] neg_hi:[0,0,1]
    v_pk_fma_f32 v[54:55], v[56:57], v[34:35], v[66:67]
    v_cvt_pk_bf16_f32 v74, v52, v54
    v_cvt_pk_bf16_f32 v75, v53, v55
    ds_write_b64 v7, v[74:75] offset:4896
    v_pk_mul_f32 v[68:69], v[54:55], v[34:35]
    v_pk_mul_f32 v[70:71], v[54:55], v[32:33]
    v_pk_fma_f32 v[56:57], v[52:53], v[32:33], v[68:69] neg_lo:[0,0,1] neg_hi:[0,0,1]
    v_pk_fma_f32 v[58:59], v[52:53], v[34:35], v[70:71]
    v_cvt_pk_bf16_f32 v76, v56, v58
    v_cvt_pk_bf16_f32 v77, v57, v59
    ds_write_b64 v7, v[76:77] offset:5440
    v_pk_mul_f32 v[64:65], v[58:59], v[34:35]
    v_pk_mul_f32 v[66:67], v[58:59], v[32:33]
    v_pk_fma_f32 v[52:53], v[56:57], v[32:33], v[64:65] neg_lo:[0,0,1] neg_hi:[0,0,1]
    v_pk_fma_f32 v[54:55], v[56:57], v[34:35], v[66:67]
    v_cvt_pk_bf16_f32 v78, v52, v54
    v_cvt_pk_bf16_f32 v79, v53, v55
    ds_write_b64 v7, v[78:79] offset:5984
    v_pk_mul_f32 v[68:69], v[54:55], v[34:35]
    v_pk_mul_f32 v[70:71], v[54:55], v[32:33]
    v_pk_fma_f32 v[56:57], v[52:53], v[32:33], v[68:69] neg_lo:[0,0,1] neg_hi:[0,0,1]
    v_pk_fma_f32 v[58:59], v[52:53], v[34:35], v[70:71]
    v_cvt_pk_bf16_f32 v72, v56, v58
    v_cvt_pk_bf16_f32 v73, v57, v59
    ds_write_b64 v7, v[72:73] offset:6528
    v_pk_mul_f32 v[64:65], v[58:59], v[34:35]
    v_pk_mul_f32 v[66:67], v[58:59], v[32:33]
    v_pk_fma_f32 v[52:53], v[56:57], v[32:33], v[64:65] neg_lo:[0,0,1] neg_hi:[0,0,1]
    v_pk_fma_f32 v[54:55], v[56:57], v[34:35], v[66:67]
    v_cvt_pk_bf16_f32 v74, v52, v54
    v_cvt_pk_bf16_f32 v75, v53, v55
    ds_write_b64 v7, v[74:75] offset:7072
    v_pk_mul_f32 v[68:69], v[54:55], v[34:35]
    v_pk_mul_f32 v[70:71], v[54:55], v[32:33]
    v_pk_fma_f32 v[56:57], v[52:53], v[32:33], v[68:69] neg_lo:[0,0,1] neg_hi:[0,0,1]
    v_pk_fma_f32 v[58:59], v[52:53], v[34:35], v[70:71]
    v_cvt_pk_bf16_f32 v76, v56, v58
    v_cvt_pk_bf16_f32 v77, v57, v59
    ds_write_b64 v7, v[76:77] offset:7616
    v_pk_mul_f32 v[64:65], v[58:59], v[34:35]
    v_pk_mul_f32 v[66:67], v[58:59], v[32:33]
    v_pk_fma_f32 v[52:53], v[56:57], v[32:33], v[64:65] neg_lo:[0,0,1] neg_hi:[0,0,1]
    v_pk_fma_f32 v[54:55], v[56:57], v[34:35], v[66:67]
    v_cvt_pk_bf16_f32 v78, v52, v54
    v_cvt_pk_bf16_f32 v79, v53, v55
    ds_write_b64 v7, v[78:79] offset:8160
    ds_read_b128 v[128:131], v8 offset:0
    ds_read_b128 v[132:135], v8 offset:64
    ds_read_b128 v[136:139], v8 offset:128
    ds_read_b128 v[140:143], v8 offset:192
    ds_read_b128 v[144:147], v8 offset:256
    ds_read_b128 v[148:151], v8 offset:320
    ds_read_b128 v[152:155], v8 offset:384
    ds_read_b128 v[156:159], v8 offset:448
    v_pk_mul_f32 v[68:69], v[34:35], v[34:35]
    v_pk_mul_f32 v[70:71], v[34:35], v[32:33]
    v_pk_fma_f32 v[40:41], v[32:33], v[32:33], v[68:69] neg_lo:[0,0,1] neg_hi:[0,0,1]
    v_pk_fma_f32 v[42:43], v[32:33], v[34:35], v[70:71]
    v_pk_mul_f32 v[64:65], v[26:27], v[38:39]
    v_pk_mul_f32 v[66:67], v[26:27], v[36:37]
    v_pk_fma_f32 v[80:81], v[24:25], v[36:37], v[64:65] neg_lo:[0,0,1] neg_hi:[0,0,1]
    v_pk_fma_f32 v[82:83], v[24:25], v[38:39], v[66:67]
    v_pk_mul_f32 v[68:69], v[42:43], v[42:43]
    v_pk_mul_f32 v[70:71], v[42:43], v[40:41]
    v_pk_fma_f32 v[44:45], v[40:41], v[40:41], v[68:69] neg_lo:[0,0,1] neg_hi:[0,0,1]
    v_pk_fma_f32 v[46:47], v[40:41], v[42:43], v[70:71]
    v_pk_mul_f32 v[64:65], v[82:83], v[42:43]
    v_pk_mul_f32 v[66:67], v[82:83], v[40:41]
    v_pk_fma_f32 v[52:53], v[80:81], v[40:41], v[64:65] neg_lo:[0,0,1] neg_hi:[0,0,1]
    v_pk_fma_f32 v[54:55], v[80:81], v[42:43], v[66:67]
    v_pk_mul_f32 v[68:69], v[46:47], v[46:47]
    v_pk_mul_f32 v[70:71], v[46:47], v[44:45]
    v_pk_fma_f32 v[48:49], v[44:45], v[44:45], v[68:69] neg_lo:[0,0,1] neg_hi:[0,0,1]
    v_pk_fma_f32 v[50:51], v[44:45], v[46:47], v[70:71]
    s_waitcnt lgkmcnt(0)
    v_mfma_f32_16x16x32_bf16 v[160:163], v[128:131], v[96:99], 0
    v_mfma_f32_16x16x32_bf16 v[160:163], v[132:135], v[100:103], v[160:163]
    v_mfma_f32_16x16x32_bf16 v[160:163], v[136:139], v[104:107], v[160:163]
    v_mfma_f32_16x16x32_bf16 v[160:163], v[140:143], v[108:111], v[160:163]
    v_mfma_f32_16x16x32_bf16 v[160:163], v[144:147], v[112:115], v[160:163]
    v_mfma_f32_16x16x32_bf16 v[160:163], v[148:151], v[116:119], v[160:163]
    v_mfma_f32_16x16x32_bf16 v[160:163], v[152:155], v[120:123], v[160:163]
    v_mfma_f32_16x16x32_bf16 v[160:163], v[156:159], v[124:127], v[160:163]
    v_cvt_pk_bf16_f32 v72, v80, v82
    v_cvt_pk_bf16_f32 v73, v81, v83
    ds_write_b64 v7, v[72:73] offset:0
    v_cvt_pk_bf16_f32 v74, v52, v54
    v_cvt_pk_bf16_f32 v75, v53, v55
    ds_write_b64 v7, v[74:75] offset:544
    v_pk_mul_f32 v[64:65], v[82:83], v[38:39]
    v_pk_mul_f32 v[66:67], v[82:83], v[36:37]
    v_pk_fma_f32 v[84:85], v[80:81], v[36:37], v[64:65] neg_lo:[0,0,1] neg_hi:[0,0,1]
    v_pk_fma_f32 v[86:87], v[80:81], v[38:39], v[66:67]
    v_pk_mul_f32 v[68:69], v[54:55], v[42:43]
    v_pk_mul_f32 v[70:71], v[54:55], v[40:41]
    v_pk_fma_f32 v[56:57], v[52:53], v[40:41], v[68:69] neg_lo:[0,0,1] neg_hi:[0,0,1]
    v_pk_fma_f32 v[58:59], v[52:53], v[42:43], v[70:71]
    v_cvt_pk_bf16_f32 v76, v56, v58
    v_cvt_pk_bf16_f32 v77, v57, v59
    ds_write_b64 v7, v[76:77] offset:1088
    v_pk_mul_f32 v[64:65], v[58:59], v[42:43]
    v_pk_mul_f32 v[66:67], v[58:59], v[40:41]
    v_pk_fma_f32 v[52:53], v[56:57], v[40:41], v[64:65] neg_lo:[0,0,1] neg_hi:[0,0,1]
    v_pk_fma_f32 v[54:55], v[56:57], v[42:43], v[66:67]
    v_cvt_pk_bf16_f32 v78, v52, v54
    v_cvt_pk_bf16_f32 v79, v53, v55
    ds_write_b64 v7, v[78:79] offset:1632
    v_pk_mul_f32 v[68:69], v[54:55], v[42:43]
    v_pk_mul_f32 v[70:71], v[54:55], v[40:41]
    v_pk_fma_f32 v[56:57], v[52:53], v[40:41], v[68:69] neg_lo:[0,0,1] neg_hi:[0,0,1]
    v_pk_fma_f32 v[58:59], v[52:53], v[42:43], v[70:71]
    v_cvt_pk_bf16_f32 v72, v56, v58
    v_cvt_pk_bf16_f32 v73, v57, v59
    ds_write_b64 v7, v[72:73] offset:2176
    v_pk_mul_f32 v[64:65], v[58:59], v[42:43]
    v_pk_mul_f32 v[66:67], v[58:59], v[40:41]
    v_pk_fma_f32 v[52:53], v[56:57], v[40:41], v[64:65] neg_lo:[0,0,1] neg_hi:[0,0,1]
    v_pk_fma_f32 v[54:55], v[56:57], v[42:43], v[66:67]
    v_cvt_pk_bf16_f32 v74, v52, v54
    v_cvt_pk_bf16_f32 v75, v53, v55
    ds_write_b64 v7, v[74:75] offset:2720
    v_pk_mul_f32 v[68:69], v[54:55], v[42:43]
    v_pk_mul_f32 v[70:71], v[54:55], v[40:41]
    v_pk_fma_f32 v[56:57], v[52:53], v[40:41], v[68:69] neg_lo:[0,0,1] neg_hi:[0,0,1]
    v_pk_fma_f32 v[58:59], v[52:53], v[42:43], v[70:71]
    v_cvt_pk_bf16_f32 v76, v56, v58
    v_cvt_pk_bf16_f32 v77, v57, v59
    ds_write_b64 v7, v[76:77] offset:3264
    v_pk_mul_f32 v[64:65], v[58:59], v[42:43]
    v_pk_mul_f32 v[66:67], v[58:59], v[40:41]
    v_pk_fma_f32 v[52:53], v[56:57], v[40:41], v[64:65] neg_lo:[0,0,1] neg_hi:[0,0,1]
    v_pk_fma_f32 v[54:55], v[56:57], v[42:43], v[66:67]
    v_cvt_pk_bf16_f32 v78, v52, v54
    v_cvt_pk_bf16_f32 v79, v53, v55
    ds_write_b64 v7, v[78:79] offset:3808
    v_cvt_pk_bf16_f32 v72, v84, v86
    v_cvt_pk_bf16_f32 v73, v85, v87
    ds_write_b64 v7, v[72:73] offset:4352
    global_load_dword v221, v221, s[54:55]
    global_load_dword v220, v220, s[22:23]
    ds_read_b128 v[128:131], v8 offset:0
    ds_read_b128 v[132:135], v8 offset:64
    ds_read_b128 v[136:139], v8 offset:128
    ds_read_b128 v[140:143], v8 offset:192
    ds_read_b128 v[144:147], v8 offset:256
    ds_read_b128 v[148:151], v8 offset:320
    ds_read_b128 v[152:155], v8 offset:384
    ds_read_b128 v[156:159], v8 offset:448
    v_pk_mul_f32 v[68:69], v[86:87], v[38:39]
    v_pk_mul_f32 v[70:71], v[86:87], v[36:37]
    v_pk_fma_f32 v[80:81], v[84:85], v[36:37], v[68:69] neg_lo:[0,0,1] neg_hi:[0,0,1]
    v_pk_fma_f32 v[82:83], v[84:85], v[38:39], v[70:71]
    v_pk_mul_f32 v[64:65], v[86:87], v[46:47]
    v_pk_mul_f32 v[66:67], v[86:87], v[44:45]
    v_pk_fma_f32 v[52:53], v[84:85], v[44:45], v[64:65] neg_lo:[0,0,1] neg_hi:[0,0,1]
    v_pk_fma_f32 v[54:55], v[84:85], v[46:47], v[66:67]
    v_pk_mul_f32 v[68:69], v[54:55], v[46:47]
    v_pk_mul_f32 v[70:71], v[54:55], v[44:45]
    v_pk_fma_f32 v[56:57], v[52:53], v[44:45], v[68:69] neg_lo:[0,0,1] neg_hi:[0,0,1]
    v_pk_fma_f32 v[58:59], v[52:53], v[46:47], v[70:71]
    s_waitcnt lgkmcnt(0)
    v_mfma_f32_16x16x32_bf16 v[164:167], v[128:131], v[96:99], 0
    v_mfma_f32_16x16x32_bf16 v[164:167], v[132:135], v[100:103], v[164:167]
    v_mfma_f32_16x16x32_bf16 v[164:167], v[136:139], v[104:107], v[164:167]
    v_mfma_f32_16x16x32_bf16 v[164:167], v[140:143], v[108:111], v[164:167]
    v_mfma_f32_16x16x32_bf16 v[164:167], v[144:147], v[112:115], v[164:167]
    v_mfma_f32_16x16x32_bf16 v[164:167], v[148:151], v[116:119], v[164:167]
    v_mfma_f32_16x16x32_bf16 v[164:167], v[152:155], v[120:123], v[164:167]
    v_mfma_f32_16x16x32_bf16 v[164:167], v[156:159], v[124:127], v[164:167]
    v_cvt_pk_bf16_f32 v74, v52, v54
    v_cvt_pk_bf16_f32 v75, v53, v55
    ds_write_b64 v7, v[74:75] offset:544
    v_cvt_pk_bf16_f32 v76, v56, v58
    v_cvt_pk_bf16_f32 v77, v57, v59
    ds_write_b64 v7, v[76:77] offset:1088
    v_pk_mul_f32 v[64:65], v[58:59], v[46:47]
    v_pk_mul_f32 v[66:67], v[58:59], v[44:45]
    v_pk_fma_f32 v[52:53], v[56:57], v[44:45], v[64:65] neg_lo:[0,0,1] neg_hi:[0,0,1]
    v_pk_fma_f32 v[54:55], v[56:57], v[46:47], v[66:67]
    v_cvt_pk_bf16_f32 v78, v52, v54
    v_cvt_pk_bf16_f32 v79, v53, v55
    ds_write_b64 v7, v[78:79] offset:1632
    v_pk_mul_f32 v[68:69], v[54:55], v[46:47]
    v_pk_mul_f32 v[70:71], v[54:55], v[44:45]
    v_pk_fma_f32 v[56:57], v[52:53], v[44:45], v[68:69] neg_lo:[0,0,1] neg_hi:[0,0,1]
    v_pk_fma_f32 v[58:59], v[52:53], v[46:47], v[70:71]
    v_cvt_pk_bf16_f32 v72, v56, v58
    v_cvt_pk_bf16_f32 v73, v57, v59
    ds_write_b64 v7, v[72:73] offset:0
    v_pk_mul_f32 v[64:65], v[82:83], v[38:39]
    v_pk_mul_f32 v[66:67], v[82:83], v[36:37]
    v_pk_fma_f32 v[84:85], v[80:81], v[36:37], v[64:65] neg_lo:[0,0,1] neg_hi:[0,0,1]
    v_pk_fma_f32 v[86:87], v[80:81], v[38:39], v[66:67]
    v_pk_mul_f32 v[68:69], v[82:83], v[46:47]
    v_pk_mul_f32 v[70:71], v[82:83], v[44:45]
    v_pk_fma_f32 v[52:53], v[80:81], v[44:45], v[68:69] neg_lo:[0,0,1] neg_hi:[0,0,1]
    v_pk_fma_f32 v[54:55], v[80:81], v[46:47], v[70:71]
    v_cvt_pk_bf16_f32 v74, v52, v54
    v_cvt_pk_bf16_f32 v75, v53, v55
    ds_write_b64 v7, v[74:75] offset:2720
    v_pk_mul_f32 v[64:65], v[54:55], v[46:47]
    v_pk_mul_f32 v[66:67], v[54:55], v[44:45]
    v_pk_fma_f32 v[56:57], v[52:53], v[44:45], v[64:65] neg_lo:[0,0,1] neg_hi:[0,0,1]
    v_pk_fma_f32 v[58:59], v[52:53], v[46:47], v[66:67]
    v_cvt_pk_bf16_f32 v76, v56, v58
    v_cvt_pk_bf16_f32 v77, v57, v59
    ds_write_b64 v7, v[76:77] offset:3264
    v_pk_mul_f32 v[68:69], v[58:59], v[46:47]
    v_pk_mul_f32 v[70:71], v[58:59], v[44:45]
    v_pk_fma_f32 v[52:53], v[56:57], v[44:45], v[68:69] neg_lo:[0,0,1] neg_hi:[0,0,1]
    v_pk_fma_f32 v[54:55], v[56:57], v[46:47], v[70:71]
    v_cvt_pk_bf16_f32 v78, v52, v54
    v_cvt_pk_bf16_f32 v79, v53, v55
    ds_write_b64 v7, v[78:79] offset:3808
    v_pk_mul_f32 v[64:65], v[54:55], v[46:47]
    v_pk_mul_f32 v[66:67], v[54:55], v[44:45]
    v_pk_fma_f32 v[56:57], v[52:53], v[44:45], v[64:65] neg_lo:[0,0,1] neg_hi:[0,0,1]
    v_pk_fma_f32 v[58:59], v[52:53], v[46:47], v[66:67]
    v_cvt_pk_bf16_f32 v72, v56, v58
    v_cvt_pk_bf16_f32 v73, v57, v59
    ds_write_b64 v7, v[72:73] offset:2176
    v_pk_mul_f32 v[68:69], v[86:87], v[50:51]
    v_pk_mul_f32 v[70:71], v[86:87], v[48:49]
    v_pk_fma_f32 v[52:53], v[84:85], v[48:49], v[68:69] neg_lo:[0,0,1] neg_hi:[0,0,1]
    v_pk_fma_f32 v[54:55], v[84:85], v[50:51], v[70:71]
    v_pk_mul_f32 v[64:65], v[86:87], v[38:39]
    v_pk_mul_f32 v[66:67], v[86:87], v[36:37]
    v_pk_fma_f32 v[80:81], v[84:85], v[36:37], v[64:65] neg_lo:[0,0,1] neg_hi:[0,0,1]
    v_pk_fma_f32 v[82:83], v[84:85], v[38:39], v[66:67]
    v_cvt_pk_bf16_f32 v74, v52, v54
    v_cvt_pk_bf16_f32 v75, v53, v55
    ds_write_b64 v7, v[74:75] offset:4896
    v_pk_mul_f32 v[68:69], v[54:55], v[50:51]
    v_pk_mul_f32 v[70:71], v[54:55], v[48:49]
    v_pk_fma_f32 v[56:57], v[52:53], v[48:49], v[68:69] neg_lo:[0,0,1] neg_hi:[0,0,1]
    v_pk_fma_f32 v[58:59], v[52:53], v[50:51], v[70:71]
    v_cvt_pk_bf16_f32 v76, v56, v58
    v_cvt_pk_bf16_f32 v77, v57, v59
    ds_write_b64 v7, v[76:77] offset:4352
    v_pk_mul_f32 v[64:65], v[82:83], v[50:51]
    v_pk_mul_f32 v[66:67], v[82:83], v[48:49]
    v_pk_fma_f32 v[52:53], v[80:81], v[48:49], v[64:65] neg_lo:[0,0,1] neg_hi:[0,0,1]
    v_pk_fma_f32 v[54:55], v[80:81], v[50:51], v[66:67]
    v_pk_mul_f32 v[68:69], v[82:83], v[38:39]
    v_pk_mul_f32 v[70:71], v[82:83], v[36:37]
    v_pk_fma_f32 v[84:85], v[80:81], v[36:37], v[68:69] neg_lo:[0,0,1] neg_hi:[0,0,1]
    v_pk_fma_f32 v[86:87], v[80:81], v[38:39], v[70:71]
    v_cvt_pk_bf16_f32 v78, v52, v54
    v_cvt_pk_bf16_f32 v79, v53, v55
    ds_write_b64 v7, v[78:79] offset:5984
    v_pk_mul_f32 v[64:65], v[54:55], v[50:51]
    v_pk_mul_f32 v[66:67], v[54:55], v[48:49]
    v_pk_fma_f32 v[56:57], v[52:53], v[48:49], v[64:65] neg_lo:[0,0,1] neg_hi:[0,0,1]
    v_pk_fma_f32 v[58:59], v[52:53], v[50:51], v[66:67]
    v_cvt_pk_bf16_f32 v72, v56, v58
    v_cvt_pk_bf16_f32 v73, v57, v59
    ds_write_b64 v7, v[72:73] offset:5440
    v_pk_mul_f32 v[68:69], v[86:87], v[50:51]
    v_pk_mul_f32 v[70:71], v[86:87], v[48:49]
    v_pk_fma_f32 v[52:53], v[84:85], v[48:49], v[68:69] neg_lo:[0,0,1] neg_hi:[0,0,1]
    v_pk_fma_f32 v[54:55], v[84:85], v[50:51], v[70:71]
    v_pk_mul_f32 v[64:65], v[86:87], v[38:39]
    v_pk_mul_f32 v[66:67], v[86:87], v[36:37]
    v_pk_fma_f32 v[80:81], v[84:85], v[36:37], v[64:65] neg_lo:[0,0,1] neg_hi:[0,0,1]
    v_pk_fma_f32 v[82:83], v[84:85], v[38:39], v[66:67]
    v_cvt_pk_bf16_f32 v74, v52, v54
    v_cvt_pk_bf16_f32 v75, v53, v55
    ds_write_b64 v7, v[74:75] offset:7072
    v_pk_mul_f32 v[68:69], v[54:55], v[50:51]
    v_pk_mul_f32 v[70:71], v[54:55], v[48:49]
    v_pk_fma_f32 v[56:57], v[52:53], v[48:49], v[68:69] neg_lo:[0,0,1] neg_hi:[0,0,1]
    v_pk_fma_f32 v[58:59], v[52:53], v[50:51], v[70:71]
    v_cvt_pk_bf16_f32 v76, v56, v58
    v_cvt_pk_bf16_f32 v77, v57, v59
    ds_write_b64 v7, v[76:77] offset:6528
    v_pk_mul_f32 v[64:65], v[82:83], v[50:51]
    v_pk_mul_f32 v[66:67], v[82:83], v[48:49]
    v_pk_fma_f32 v[52:53], v[80:81], v[48:49], v[64:65] neg_lo:[0,0,1] neg_hi:[0,0,1]
    v_pk_fma_f32 v[54:55], v[80:81], v[50:51], v[66:67]
    v_cvt_pk_bf16_f32 v78, v52, v54
    v_cvt_pk_bf16_f32 v79, v53, v55
    ds_write_b64 v7, v[78:79] offset:8160
    v_pk_mul_f32 v[68:69], v[54:55], v[50:51]
    v_pk_mul_f32 v[70:71], v[54:55], v[48:49]
    v_pk_fma_f32 v[56:57], v[52:53], v[48:49], v[68:69] neg_lo:[0,0,1] neg_hi:[0,0,1]
    v_pk_fma_f32 v[58:59], v[52:53], v[50:51], v[70:71]
    v_cvt_pk_bf16_f32 v72, v56, v58
    v_cvt_pk_bf16_f32 v73, v57, v59
    ds_write_b64 v7, v[72:73] offset:7616
    v_bfe_u32 v200, v1, 2, 2
    v_lshl_add_u32 v200, v6, 3, v200
    v_bfe_u32 v201, v1, 1, 1
    v_lshl_add_u32 v200, v201, 2, v200
    v_lshlrev_b32 v200, 4, v200
    v_and_b32 v201, 1, v1
    v_lshl_add_u32 v200, v201, 3, v200
    s_lshl_b32 s3, s31, 11
    s_add_u32 s3, s3, 107136
    v_add_u32 v253, s3, v200
    v_and_b32 v201, 7, v1
    v_mul_u32_u24 v201, 4624, v201
    v_lshrrev_b32 v202, 3, v1
    v_lshl_add_u32 v201, v202, 3, v201
    s_lshl_b32 s3, s31, 8
    v_add_u32 v254, s3, v201
    s_waitcnt vmcnt(2) lgkmcnt(0)
    s_barrier
    ds_read_b64_tr_b16 v[204:205], v253 offset:0
    ds_read_b64_tr_b16 v[206:207], v253 offset:512
    ds_read_b64_tr_b16 v[208:209], v253 offset:1024
    ds_read_b64_tr_b16 v[210:211], v253 offset:1536
    s_waitcnt lgkmcnt(3)
    ds_write_b64 v254, v[204:205] offset:512
    s_waitcnt lgkmcnt(3)
    ds_write_b64 v254, v[206:207] offset:576
    s_waitcnt lgkmcnt(3)
    ds_write_b64 v254, v[208:209] offset:640
    s_waitcnt lgkmcnt(3)
    ds_write_b64 v254, v[210:211] offset:704
    ds_read_b128 v[224:227], v222 offset:0
    ds_read_b128 v[228:231], v222 offset:1024
    ds_read_b128 v[232:235], v222 offset:2048
    ds_read_b128 v[236:239], v222 offset:3072
    ds_read_b128 v[240:243], v222 offset:4096
    ds_read_b128 v[244:247], v222 offset:5120
    ds_read_b128 v[248:251], v222 offset:6144
    ds_read_b128 v[128:131], v8 offset:0
    ds_read_b128 v[132:135], v8 offset:64
    ds_read_b128 v[136:139], v8 offset:128
    ds_read_b128 v[140:143], v8 offset:192
    ds_read_b128 v[144:147], v8 offset:256
    ds_read_b128 v[148:151], v8 offset:320
    ds_read_b128 v[152:155], v8 offset:384
    ds_read_b128 v[156:159], v8 offset:448
    v_lshl_add_u32 v25, v1, 4, s34
    v_mov_b64 v[18:19], v[16:17]
    ds_write_b128 v25, v[16:19]
    ds_write_b128 v25, v[16:19] offset:1024
    ds_write_b128 v25, v[16:19] offset:2048
    v_cmp_eq_u32 vcc, 0, v1
    s_nop 1
    v_cndmask_b32 v15, 0, v15, vcc
    v_add_f32 v160, v160, v15
    v_lshlrev_b32 v20, 5, v5
    v_sub_u32 v20, s34, v20
    v_cvt_pk_bf16_f32 v64, v167, v167
    v_cvt_pk_bf16_f32 v66, v166, v166
    v_cvt_pk_bf16_f32 v69, v164, v164
    v_cvt_pk_bf16_f32 v70, v166, v165
    v_lshlrev_b32 v23, 4, v6
    v_sub_u32 v23, v20, v23
    v_lshlrev_b32 v24, 3, v6
    v_sub_u32 v26, s34, v24
    v_sub_u32 v24, v20, v24
    v_cvt_pk_bf16_f32 v72, v163, v162
    v_cvt_pk_bf16_f32 v73, v161, v160
    s_mov_b32 exec_lo, 0
    s_mov_b32 exec_hi, 1
    ds_write_b16 v20, v69 offset:58
    ds_write_b32 v20, v69 offset:60
    ds_write_b16 v20, v69 offset:64
    s_mov_b32 exec_lo, -1
    s_mov_b32 exec_hi, 0
    ds_write_b16 v23, v64 offset:562
    ds_write2_b32 v23, v66, v70 offset0:141 offset1:142
    ds_write_b32 v23, v69 offset:572
    ds_write_b16 v23, v69 offset:576
    s_mov_b64 exec, -1
    ds_write_b64 v24, v[72:73] offset:1080
    v_and_b32 v27, 3, v5
    v_mul_u32_u24 v27, 96, v27
    v_bfe_u32 v28, v5, 2, 1
    v_lshlrev_b32 v28, 5, v28
    v_sub_u32 v27, v27, v28
    v_and_b32 v28, 1, v5
    v_mul_u32_u24 v28, 160, v28
    v_bfe_u32 v29, v5, 1, 2
    v_lshlrev_b32 v29, 5, v29
    v_sub_u32 v28, v28, v29
    v_add_u32 v28, 448, v28
    v_cmp_gt_u32 vcc, 8, v5
    s_nop 1
    v_cndmask_b32 v27, v28, v27, vcc
    v_add_u32 v27, v27, v26
    s_waitcnt lgkmcnt(11)
    v_mfma_f32_16x16x32_bf16 v[168:171], v[96:99], v[128:131], 0
    v_mfma_f32_16x16x32_bf16 v[168:171], v[100:103], v[132:135], v[168:171]
    v_mfma_f32_16x16x32_bf16 v[168:171], v[104:107], v[136:139], v[168:171]
    v_mfma_f32_16x16x32_bf16 v[168:171], v[108:111], v[140:143], v[168:171]
    v_mfma_f32_16x16x32_bf16 v[168:171], v[112:115], v[144:147], v[168:171]
    v_mfma_f32_16x16x32_bf16 v[168:171], v[116:119], v[148:151], v[168:171]
    v_mfma_f32_16x16x32_bf16 v[168:171], v[120:123], v[152:155], v[168:171]
    v_mfma_f32_16x16x32_bf16 v[168:171], v[124:127], v[156:159], v[168:171]
    s_barrier
    v_and_b32 v28, 1, v5
    v_mul_u32_u24 v28, 2112, v28
    v_lshrrev_b32 v29, 1, v5
    v_lshlrev_b32 v29, 2, v29
    v_add_u32 v28, v28, v29
    v_sub_u32 v28, s34, v28
    v_add_u32 v28, 2112, v28
    v_lshl_add_u32 v10, v6, 4, v28
    v_add_u32 v11, 512, v10
    v_lshl_add_u32 v12, v6, 3, v28
    v_add_u32 v12, 1024, v12
    v_lshlrev_b32 v13, 5, v5
    v_lshl_add_u32 v14, v6, 3, v13
    v_lshl_add_u32 v13, v6, 4, v13
    v_add_u32 v13, s35, v13
    s_add_u32 s3, s34, 4352
    v_add_u32 v14, s3, v14
    v_cvt_pk_bf16_f32 v72, v171, v170
    v_cvt_pk_bf16_f32 v73, v169, v168
    ds_write_b64 v27, v[72:73] offset:1176
    ds_read_b128 v[96:99], v25 offset:0
    ds_read_b32 v100, v25 offset:16
    ds_read_b128 v[104:107], v25 offset:1024
    ds_read_b32 v108, v25 offset:1040
    v_readlane_b32 s53, v72, 52
    s_nop 0
    s_and_b32 s53, s53, 0xffff
    s_mul_i32 s53, s53, 0x10001
    v_pk_mul_lo_u16 v248, v248, s53
    v_pk_mul_lo_u16 v249, v249, s53
    v_pk_mul_lo_u16 v250, v250, s53
    v_pk_mul_lo_u16 v251, v251, s53
    v_lshrrev_b32 v3, 2, v5
    v_mul_u32_u24 v3, 8768, v3
    v_and_b32 v4, 3, v5
    v_lshl_add_u32 v3, v4, 3, v3
    v_lshl_add_u32 v3, v6, 5, v3
    v_add_u32 v3, 41344, v3
    v_mul_u32_u24 v4, 2304, v1
    s_lshl_b32 s33, s30, 4
    v_add_u32 v4, s33, v4
    s_waitcnt lgkmcnt(2)
    v_alignbit_b32 v128, v97, v96, 16
    v_alignbit_b32 v129, v98, v97, 16
    v_alignbit_b32 v130, v99, v98, 16
    v_alignbit_b32 v131, v100, v99, 16
    ds_write_b128 v25, v[128:131] offset:2112
    s_waitcnt lgkmcnt(0)
    v_alignbit_b32 v132, v105, v104, 16
    v_alignbit_b32 v133, v106, v105, 16
    v_alignbit_b32 v134, v107, v106, 16
    v_alignbit_b32 v135, v108, v107, 16
    ds_write_b128 v25, v[132:135] offset:3136
    s_lshl_b32 s3, s49, 13
    s_add_u32 s3, s48, s3
    s_add_u32 m0, s3, 16384
    s_mul_i32 s3, s49, 589824
    s_add_u32 s3, s3, 1179648
    s_xor_b32 s49, s49, 1
    buffer_load_dwordx4 v252, s[44:47], s3 offen lds
    s_lshl_b32 s3, s49, 13
    s_add_u32 s3, s48, s3
    s_add_u32 m0, s3, 16384
    s_mul_i32 s3, s49, 589824
    s_add_u32 s3, s3, 1179648
    s_xor_b32 s49, s49, 1
    buffer_load_dwordx4 v252, s[44:47], s3 offen lds
    ds_read_b128 v[156:159], v13 offset:464
    ds_read_b128 v[160:163], v13 offset:480
    ds_read2_b32 v[48:49], v11 offset0:135 offset1:136
    ds_read2_b32 v[50:51], v11 offset0:137 offset1:138
    ds_read2_b32 v[80:81], v11 offset0:7 offset1:8
    ds_read2_b32 v[82:83], v11 offset0:9 offset1:10
    ds_read2_b32 v[112:113], v10 offset0:7 offset1:8
    ds_read2_b32 v[114:115], v10 offset0:9 offset1:10
    ds_read_b128 v[164:167], v13 offset:416
    ds_read_b128 v[168:171], v13 offset:352
    ds_read_b128 v[172:175], v13 offset:288
    ds_read2_b32 v[52:53], v11 offset0:119 offset1:120
    ds_read2_b32 v[54:55], v11 offset0:121 offset1:122
    ds_read2_b32 v[84:85], v10 offset0:119 offset1:120
    ds_read2_b32 v[86:87], v10 offset0:121 offset1:122
    ds_read2_b32 v[56:57], v11 offset0:103 offset1:104
    ds_read2_b32 v[58:59], v11 offset0:105 offset1:106
    ds_read2_b32 v[88:89], v10 offset0:103 offset1:104
    ds_read2_b32 v[90:91], v10 offset0:105 offset1:106
    s_waitcnt lgkmcnt(15)
    v_mfma_f32_16x16x32_bf16 v[188:191], v[156:159], v[224:227], 0
    ds_read2_b32 v[60:61], v11 offset0:87 offset1:88
    ds_read2_b32 v[62:63], v11 offset0:89 offset1:90
    ds_read2_b32 v[92:93], v10 offset0:87 offset1:88
    ds_read2_b32 v[94:95], v10 offset0:89 offset1:90
    v_mfma_f32_16x16x32_bf16 v[192:195], v[160:163], v[228:231], 0
    ds_read2_b32 v[64:65], v11 offset0:71 offset1:72
    ds_read2_b32 v[66:67], v11 offset0:73 offset1:74
    ds_read2_b32 v[96:97], v10 offset0:71 offset1:72
    ds_read2_b32 v[98:99], v10 offset0:73 offset1:74
    v_mfma_f32_16x16x32_bf16 v[196:199], v[160:163], v[232:235], 0
    ds_read2_b32 v[68:69], v11 offset0:55 offset1:56
    ds_read2_b32 v[70:71], v11 offset0:57 offset1:58
    ds_read2_b32 v[100:101], v10 offset0:55 offset1:56
    ds_read2_b32 v[102:103], v10 offset0:57 offset1:58
    v_mfma_f32_16x16x32_bf16 v[200:203], v[160:163], v[236:239], 0
    ds_read2_b32 v[72:73], v11 offset0:39 offset1:40
    ds_read2_b32 v[74:75], v11 offset0:41 offset1:42
    ds_read2_b32 v[104:105], v10 offset0:39 offset1:40
    ds_read2_b32 v[106:107], v10 offset0:41 offset1:42
    v_mfma_f32_16x16x32_bf16 v[204:207], v[156:159], v[240:243], 0
    ds_read2_b32 v[76:77], v11 offset0:23 offset1:24
    ds_read2_b32 v[78:79], v11 offset0:25 offset1:26
    ds_read2_b32 v[108:109], v10 offset0:23 offset1:24
    ds_read2_b32 v[110:111], v10 offset0:25 offset1:26
    v_mfma_f32_16x16x32_bf16 v[208:211], v[160:163], v[244:247], 0
    ds_read2_b32 v[116:117], v12 offset0:39 offset1:40
    ds_read2_b32 v[118:119], v12 offset0:63 offset1:64
    ds_read_b128 v[176:179], v13 offset:224
    v_mfma_f32_16x16x32_bf16 v[16:19], v[48:51], v[160:163], 0
    ds_read2_b32 v[120:121], v12 offset0:31 offset1:32
    ds_read2_b32 v[122:123], v12 offset0:55 offset1:56
    s_waitcnt lgkmcnt(15)
    v_mfma_f32_16x16x32_bf16 v[20:23], v[80:83], v[160:163], 0
    v_mfma_f32_16x16x32_bf16 v[24:27], v[112:115], v[160:163], 0
    v_mfma_f32_16x16x32_bf16 v[32:35], v[248:251], v[160:163], 0
    ds_read_b128 v[180:183], v13 offset:160
    ds_read2_b32 v[124:125], v12 offset0:23 offset1:24
    ds_read2_b32 v[126:127], v12 offset0:47 offset1:48
    v_mfma_f32_16x16x32_bf16 v[16:19], v[52:55], v[164:167], v[16:19]
    ds_read2_b32 v[128:129], v12 offset0:87 offset1:88
    ds_read2_b32 v[130:131], v12 offset0:111 offset1:112
    v_mfma_f32_16x16x32_bf16 v[20:23], v[84:87], v[164:167], v[20:23]
    ds_read_b128 v[184:187], v13 offset:96
    ds_read2_b32 v[132:133], v12 offset0:79 offset1:80
    ds_read2_b32 v[134:135], v12 offset0:103 offset1:104
    v_mfma_f32_16x16x32_bf16 v[16:19], v[56:59], v[168:171], v[16:19]
    ds_read2_b32 v[136:137], v12 offset0:71 offset1:72
    ds_read2_b32 v[138:139], v12 offset0:95 offset1:96
    v_mfma_f32_16x16x32_bf16 v[20:23], v[88:91], v[168:171], v[20:23]
    ds_read_b128 v[156:159], v13 offset:32
    ds_read2_b32 v[140:141], v12 offset0:151 offset1:152
    ds_read2_b32 v[142:143], v12 offset0:191 offset1:192
    v_cvt_pk_bf16_f32 v188, v188, v189
    v_cvt_pk_bf16_f32 v189, v190, v191
    v_cvt_pk_bf16_f32 v190, v192, v193
    v_cvt_pk_bf16_f32 v191, v194, v195
    v_mfma_f32_16x16x32_bf16 v[16:19], v[60:63], v[172:175], v[16:19]
    ds_read2_b32 v[144:145], v12 offset0:143 offset1:144
    ds_read2_b32 v[146:147], v12 offset0:183 offset1:184
    v_mfma_f32_16x16x32_bf16 v[20:23], v[92:95], v[172:175], v[20:23]
    ds_read_b128 v[160:163], v13 offset:976
    ds_read2_b32 v[148:149], v12 offset0:135 offset1:136
    ds_read2_b32 v[150:151], v12 offset0:175 offset1:176
    v_cvt_pk_bf16_f32 v196, v196, v197
    v_cvt_pk_bf16_f32 v197, v198, v199
    v_cvt_pk_bf16_f32 v198, v200, v201
    v_cvt_pk_bf16_f32 v199, v202, v203
    s_waitcnt lgkmcnt(15)
    v_mfma_f32_16x16x32_bf16 v[24:27], v[188:191], v[116:119], v[24:27]
    v_mfma_f32_16x16x32_bf16 v[28:31], v[188:191], v[120:123], 0
    v_mfma_f32_16x16x32_bf16 v[32:35], v[188:191], v[124:127], v[32:35]
    v_mfma_f32_16x16x32_bf16 v[16:19], v[64:67], v[176:179], v[16:19]
    ds_read2_b32 v[152:153], v12 offset0:127 offset1:128
    ds_read2_b32 v[154:155], v12 offset0:167 offset1:168
    v_mfma_f32_16x16x32_bf16 v[20:23], v[96:99], v[176:179], v[20:23]
    ds_read_b128 v[164:167], v13 offset:992
    v_cvt_pk_bf16_f32 v204, v204, v205
    v_cvt_pk_bf16_f32 v205, v206, v207
    v_cvt_pk_bf16_f32 v206, v208, v209
    v_cvt_pk_bf16_f32 v207, v210, v211
    s_waitcnt lgkmcnt(15)
    v_mfma_f32_16x16x32_bf16 v[24:27], v[196:199], v[128:131], v[24:27]
    s_waitcnt lgkmcnt(13)
    v_mfma_f32_16x16x32_bf16 v[28:31], v[196:199], v[132:135], v[28:31]
    s_waitcnt lgkmcnt(11)
    v_mfma_f32_16x16x32_bf16 v[32:35], v[196:199], v[136:139], v[32:35]
    v_mfma_f32_16x16x32_bf16 v[16:19], v[68:71], v[180:183], v[16:19]
    v_mfma_f32_16x16x32_bf16 v[20:23], v[100:103], v[180:183], v[20:23]
    ds_read_b128 v[168:171], v13 offset:928
    s_waitcnt lgkmcnt(9)
    v_mfma_f32_16x16x32_bf16 v[32:35], v[204:207], v[140:143], v[32:35]
    s_waitcnt lgkmcnt(7)
    v_mfma_f32_16x16x32_bf16 v[36:39], v[204:207], v[144:147], 0
    s_waitcnt lgkmcnt(4)
    v_mfma_f32_16x16x32_bf16 v[40:43], v[204:207], v[148:151], 0
    v_mfma_f32_16x16x32_bf16 v[16:19], v[72:75], v[184:187], v[16:19]
    v_mfma_f32_16x16x32_bf16 v[20:23], v[104:107], v[184:187], v[20:23]
    ds_read_b128 v[172:175], v13 offset:864
    s_waitcnt lgkmcnt(3)
    v_mfma_f32_16x16x32_bf16 v[44:47], v[204:207], v[152:155], 0
    v_mfma_f32_16x16x32_bf16 v[16:19], v[76:79], v[156:159], v[16:19]
    v_mfma_f32_16x16x32_bf16 v[20:23], v[108:111], v[156:159], v[20:23]
    ds_read_b128 v[176:179], v13 offset:800
    v_mfma_f32_16x16x32_bf16 v[188:191], v[160:163], v[224:227], 0
    s_waitcnt lgkmcnt(3)
    v_mfma_f32_16x16x32_bf16 v[192:195], v[164:167], v[228:231], 0
    v_mfma_f32_16x16x32_bf16 v[196:199], v[164:167], v[232:235], 0
    v_mfma_f32_16x16x32_bf16 v[200:203], v[164:167], v[236:239], 0
    v_mfma_f32_16x16x32_bf16 v[204:207], v[160:163], v[240:243], 0
    v_mfma_f32_16x16x32_bf16 v[208:211], v[164:167], v[244:247], 0
    ds_read_b128 v[180:183], v13 offset:736
    v_mfma_f32_16x16x32_bf16 v[20:23], v[48:51], v[164:167], v[20:23]
    v_mfma_f32_16x16x32_bf16 v[24:27], v[80:83], v[164:167], v[24:27]
    v_mfma_f32_16x16x32_bf16 v[28:31], v[112:115], v[164:167], v[28:31]
    v_mfma_f32_16x16x32_bf16 v[36:39], v[248:251], v[164:167], v[36:39]
    ds_read_b128 v[184:187], v13 offset:672
    s_waitcnt lgkmcnt(4)
    v_mfma_f32_16x16x32_bf16 v[20:23], v[52:55], v[168:171], v[20:23]
    v_mfma_f32_16x16x32_bf16 v[24:27], v[84:87], v[168:171], v[24:27]
    ds_read_b128 v[156:159], v13 offset:608
    v_cvt_pk_bf16_f32 v212, v16, v17
    v_cvt_pk_bf16_f32 v213, v18, v19
    ds_write_b64 v14, v[212:213] offset:0
    s_cmp_lt_u32 s31, 4
    s_cbranch_scc1 L_a_not_1
    s_waitcnt vmcnt(0) lgkmcnt(0)
    s_barrier
    ds_read_b64_tr_b16 v[216:217], v253 offset:16384
    ds_read_b64_tr_b16 v[218:219], v253 offset:16896
    ds_read_b64_tr_b16 v[220:221], v253 offset:17408
    ds_read_b64_tr_b16 v[222:223], v253 offset:17920
    s_waitcnt lgkmcnt(3)
    ds_write_b64 v254, v[216:217] offset:2560
    s_waitcnt lgkmcnt(3)
    ds_write_b64 v254, v[218:219] offset:2624
    s_waitcnt lgkmcnt(3)
    ds_write_b64 v254, v[220:221] offset:2688
    s_waitcnt lgkmcnt(3)
    ds_write_b64 v254, v[222:223] offset:2752
    s_waitcnt lgkmcnt(0)
    s_barrier
L_a_not_1:
    s_waitcnt lgkmcnt(5)
    v_mfma_f32_16x16x32_bf16 v[20:23], v[56:59], v[172:175], v[20:23]
    v_mfma_f32_16x16x32_bf16 v[24:27], v[88:91], v[172:175], v[24:27]
    ds_read_b128 v[160:163], v13 offset:544
    v_cvt_pk_bf16_f32 v188, v188, v189
    v_cvt_pk_bf16_f32 v189, v190, v191
    v_cvt_pk_bf16_f32 v190, v192, v193
    v_cvt_pk_bf16_f32 v191, v194, v195
    s_waitcnt lgkmcnt(5)
    v_mfma_f32_16x16x32_bf16 v[20:23], v[60:63], v[176:179], v[20:23]
    v_mfma_f32_16x16x32_bf16 v[24:27], v[92:95], v[176:179], v[24:27]
    ds_read_b128 v[164:167], v13 offset:1488
    v_cvt_pk_bf16_f32 v196, v196, v197
    v_cvt_pk_bf16_f32 v197, v198, v199
    v_cvt_pk_bf16_f32 v198, v200, v201
    v_cvt_pk_bf16_f32 v199, v202, v203
    v_mfma_f32_16x16x32_bf16 v[28:31], v[188:191], v[116:119], v[28:31]
    v_mfma_f32_16x16x32_bf16 v[32:35], v[188:191], v[120:123], v[32:35]
    v_mfma_f32_16x16x32_bf16 v[36:39], v[188:191], v[124:127], v[36:39]
    s_waitcnt lgkmcnt(5)
    v_mfma_f32_16x16x32_bf16 v[20:23], v[64:67], v[180:183], v[20:23]
    v_mfma_f32_16x16x32_bf16 v[24:27], v[96:99], v[180:183], v[24:27]
    ds_read_b128 v[168:171], v13 offset:1504
    v_cvt_pk_bf16_f32 v204, v204, v205
    v_cvt_pk_bf16_f32 v205, v206, v207
    v_cvt_pk_bf16_f32 v206, v208, v209
    v_cvt_pk_bf16_f32 v207, v210, v211
    v_mfma_f32_16x16x32_bf16 v[28:31], v[196:199], v[128:131], v[28:31]
    v_mfma_f32_16x16x32_bf16 v[32:35], v[196:199], v[132:135], v[32:35]
    v_mfma_f32_16x16x32_bf16 v[36:39], v[196:199], v[136:139], v[36:39]
    s_waitcnt lgkmcnt(5)
    v_mfma_f32_16x16x32_bf16 v[20:23], v[68:71], v[184:187], v[20:23]
    v_mfma_f32_16x16x32_bf16 v[24:27], v[100:103], v[184:187], v[24:27]
    ds_read_b128 v[172:175], v13 offset:1440
    v_mfma_f32_16x16x32_bf16 v[36:39], v[204:207], v[140:143], v[36:39]
    v_mfma_f32_16x16x32_bf16 v[40:43], v[204:207], v[144:147], v[40:43]
    v_mfma_f32_16x16x32_bf16 v[44:47], v[204:207], v[148:151], v[44:47]
    s_waitcnt lgkmcnt(5)
    v_mfma_f32_16x16x32_bf16 v[20:23], v[72:75], v[156:159], v[20:23]
    v_mfma_f32_16x16x32_bf16 v[24:27], v[104:107], v[156:159], v[24:27]
    ds_read_b128 v[176:179], v13 offset:1376
    s_waitcnt lgkmcnt(4)
    v_mfma_f32_16x16x32_bf16 v[20:23], v[76:79], v[160:163], v[20:23]
    v_mfma_f32_16x16x32_bf16 v[24:27], v[108:111], v[160:163], v[24:27]
    ds_read_b128 v[180:183], v13 offset:1312
    s_waitcnt lgkmcnt(4)
    v_mfma_f32_16x16x32_bf16 v[188:191], v[164:167], v[224:227], 0
    s_waitcnt lgkmcnt(3)
    v_mfma_f32_16x16x32_bf16 v[192:195], v[168:171], v[228:231], 0
    v_mfma_f32_16x16x32_bf16 v[196:199], v[168:171], v[232:235], 0
    v_mfma_f32_16x16x32_bf16 v[200:203], v[168:171], v[236:239], 0
    v_mfma_f32_16x16x32_bf16 v[204:207], v[164:167], v[240:243], 0
    v_mfma_f32_16x16x32_bf16 v[208:211], v[168:171], v[244:247], 0
    ds_read_b128 v[184:187], v13 offset:1248
    v_mfma_f32_16x16x32_bf16 v[24:27], v[48:51], v[168:171], v[24:27]
    v_mfma_f32_16x16x32_bf16 v[28:31], v[80:83], v[168:171], v[28:31]
    v_mfma_f32_16x16x32_bf16 v[32:35], v[112:115], v[168:171], v[32:35]
    v_mfma_f32_16x16x32_bf16 v[40:43], v[248:251], v[168:171], v[40:43]
    ds_read_b128 v[156:159], v13 offset:1184
    s_waitcnt lgkmcnt(4)
    v_mfma_f32_16x16x32_bf16 v[24:27], v[52:55], v[172:175], v[24:27]
    v_mfma_f32_16x16x32_bf16 v[28:31], v[84:87], v[172:175], v[28:31]
    ds_read_b128 v[160:163], v13 offset:1120
    v_cvt_pk_bf16_f32 v214, v20, v21
    v_cvt_pk_bf16_f32 v215, v22, v23
    ds_write_b64 v14, v[214:215] offset:512
    s_waitcnt lgkmcnt(5)
    v_mfma_f32_16x16x32_bf16 v[24:27], v[56:59], v[176:179], v[24:27]
    v_mfma_f32_16x16x32_bf16 v[28:31], v[88:91], v[176:179], v[28:31]
    ds_read_b128 v[164:167], v13 offset:1056
    v_cvt_pk_bf16_f32 v188, v188, v189
    v_cvt_pk_bf16_f32 v189, v190, v191
    v_cvt_pk_bf16_f32 v190, v192, v193
    v_cvt_pk_bf16_f32 v191, v194, v195
    s_waitcnt lgkmcnt(5)
    v_mfma_f32_16x16x32_bf16 v[24:27], v[60:63], v[180:183], v[24:27]
    v_mfma_f32_16x16x32_bf16 v[28:31], v[92:95], v[180:183], v[28:31]
    ds_read_b128 v[168:171], v13 offset:2000
    v_cvt_pk_bf16_f32 v196, v196, v197
    v_cvt_pk_bf16_f32 v197, v198, v199
    v_cvt_pk_bf16_f32 v198, v200, v201
    v_cvt_pk_bf16_f32 v199, v202, v203
    v_mfma_f32_16x16x32_bf16 v[32:35], v[188:191], v[116:119], v[32:35]
    v_mfma_f32_16x16x32_bf16 v[36:39], v[188:191], v[120:123], v[36:39]
    v_mfma_f32_16x16x32_bf16 v[40:43], v[188:191], v[124:127], v[40:43]
    s_waitcnt lgkmcnt(5)
    v_mfma_f32_16x16x32_bf16 v[24:27], v[64:67], v[184:187], v[24:27]
    v_mfma_f32_16x16x32_bf16 v[28:31], v[96:99], v[184:187], v[28:31]
    ds_read_b128 v[172:175], v13 offset:2016
    v_cvt_pk_bf16_f32 v204, v204, v205
    v_cvt_pk_bf16_f32 v205, v206, v207
    v_cvt_pk_bf16_f32 v206, v208, v209
    v_cvt_pk_bf16_f32 v207, v210, v211
    v_mfma_f32_16x16x32_bf16 v[32:35], v[196:199], v[128:131], v[32:35]
    v_mfma_f32_16x16x32_bf16 v[36:39], v[196:199], v[132:135], v[36:39]
    v_mfma_f32_16x16x32_bf16 v[40:43], v[196:199], v[136:139], v[40:43]
    s_waitcnt lgkmcnt(5)
    v_mfma_f32_16x16x32_bf16 v[24:27], v[68:71], v[156:159], v[24:27]
    v_mfma_f32_16x16x32_bf16 v[28:31], v[100:103], v[156:159], v[28:31]
    ds_read_b128 v[176:179], v13 offset:1952
    v_mfma_f32_16x16x32_bf16 v[40:43], v[204:207], v[140:143], v[40:43]
    v_mfma_f32_16x16x32_bf16 v[44:47], v[204:207], v[144:147], v[44:47]
    s_waitcnt lgkmcnt(5)
    v_mfma_f32_16x16x32_bf16 v[24:27], v[72:75], v[160:163], v[24:27]
    v_mfma_f32_16x16x32_bf16 v[28:31], v[104:107], v[160:163], v[28:31]
    ds_read_b128 v[180:183], v13 offset:1888
    s_waitcnt lgkmcnt(4)
    v_mfma_f32_16x16x32_bf16 v[24:27], v[76:79], v[164:167], v[24:27]
    v_mfma_f32_16x16x32_bf16 v[28:31], v[108:111], v[164:167], v[28:31]
    ds_read_b128 v[184:187], v13 offset:1824
    s_waitcnt lgkmcnt(4)
    v_mfma_f32_16x16x32_bf16 v[188:191], v[168:171], v[224:227], 0
    s_waitcnt lgkmcnt(3)
    v_mfma_f32_16x16x32_bf16 v[192:195], v[172:175], v[228:231], 0
    v_mfma_f32_16x16x32_bf16 v[196:199], v[172:175], v[232:235], 0
    v_mfma_f32_16x16x32_bf16 v[200:203], v[172:175], v[236:239], 0
    v_mfma_f32_16x16x32_bf16 v[204:207], v[168:171], v[240:243], 0
    v_mfma_f32_16x16x32_bf16 v[208:211], v[172:175], v[244:247], 0
    ds_read_b128 v[156:159], v13 offset:1760
    v_mfma_f32_16x16x32_bf16 v[28:31], v[48:51], v[172:175], v[28:31]
    v_mfma_f32_16x16x32_bf16 v[32:35], v[80:83], v[172:175], v[32:35]
    v_mfma_f32_16x16x32_bf16 v[36:39], v[112:115], v[172:175], v[36:39]
    v_mfma_f32_16x16x32_bf16 v[44:47], v[248:251], v[172:175], v[44:47]
    ds_read_b128 v[160:163], v13 offset:1696
    s_waitcnt lgkmcnt(4)
    v_mfma_f32_16x16x32_bf16 v[28:31], v[52:55], v[176:179], v[28:31]
    v_mfma_f32_16x16x32_bf16 v[32:35], v[84:87], v[176:179], v[32:35]
    ds_read_b128 v[164:167], v13 offset:1632
    v_cvt_pk_bf16_f32 v212, v24, v25
    v_cvt_pk_bf16_f32 v213, v26, v27
    ds_write_b64 v14, v[212:213] offset:1024
    s_cmp_ge_u32 s31, 4
    s_cbranch_scc1 L_a_not_2
    s_waitcnt vmcnt(0) lgkmcnt(0)
    s_barrier
    ds_read_b64_tr_b16 v[216:217], v253 offset:16384
    ds_read_b64_tr_b16 v[218:219], v253 offset:16896
    ds_read_b64_tr_b16 v[220:221], v253 offset:17408
    ds_read_b64_tr_b16 v[222:223], v253 offset:17920
    s_waitcnt lgkmcnt(3)
    ds_write_b64 v254, v[216:217] offset:2560
    s_waitcnt lgkmcnt(3)
    ds_write_b64 v254, v[218:219] offset:2624
    s_waitcnt lgkmcnt(3)
    ds_write_b64 v254, v[220:221] offset:2688
    s_waitcnt lgkmcnt(3)
    ds_write_b64 v254, v[222:223] offset:2752
    s_waitcnt lgkmcnt(0)
    s_barrier
L_a_not_2:
    s_waitcnt lgkmcnt(5)
    v_mfma_f32_16x16x32_bf16 v[28:31], v[56:59], v[180:183], v[28:31]
    v_mfma_f32_16x16x32_bf16 v[32:35], v[88:91], v[180:183], v[32:35]
    ds_read_b128 v[168:171], v13 offset:1568
    v_cvt_pk_bf16_f32 v188, v188, v189
    v_cvt_pk_bf16_f32 v189, v190, v191
    v_cvt_pk_bf16_f32 v190, v192, v193
    v_cvt_pk_bf16_f32 v191, v194, v195
    s_cmp_lt_u32 s31, 4
    s_cbranch_scc1 L_a_noy_3
    s_waitcnt lgkmcnt(1)
    s_barrier
L_a_noy_3:
    s_waitcnt lgkmcnt(5)
    v_mfma_f32_16x16x32_bf16 v[28:31], v[60:63], v[184:187], v[28:31]
    v_mfma_f32_16x16x32_bf16 v[32:35], v[92:95], v[184:187], v[32:35]
    ds_read_b128 v[172:175], v13 offset:2512
    v_cvt_pk_bf16_f32 v196, v196, v197
    v_cvt_pk_bf16_f32 v197, v198, v199
    v_cvt_pk_bf16_f32 v198, v200, v201
    v_cvt_pk_bf16_f32 v199, v202, v203
    v_mfma_f32_16x16x32_bf16 v[36:39], v[188:191], v[116:119], v[36:39]
    v_mfma_f32_16x16x32_bf16 v[40:43], v[188:191], v[120:123], v[40:43]
    v_mfma_f32_16x16x32_bf16 v[44:47], v[188:191], v[124:127], v[44:47]
    s_waitcnt lgkmcnt(5)
    v_mfma_f32_16x16x32_bf16 v[28:31], v[64:67], v[156:159], v[28:31]
    v_mfma_f32_16x16x32_bf16 v[32:35], v[96:99], v[156:159], v[32:35]
    ds_read_b128 v[176:179], v13 offset:2528
    v_cvt_pk_bf16_f32 v204, v204, v205
    v_cvt_pk_bf16_f32 v205, v206, v207
    v_cvt_pk_bf16_f32 v206, v208, v209
    v_cvt_pk_bf16_f32 v207, v210, v211
    v_mfma_f32_16x16x32_bf16 v[36:39], v[196:199], v[128:131], v[36:39]
    v_mfma_f32_16x16x32_bf16 v[40:43], v[196:199], v[132:135], v[40:43]
    v_mfma_f32_16x16x32_bf16 v[44:47], v[196:199], v[136:139], v[44:47]
    s_waitcnt lgkmcnt(5)
    v_mfma_f32_16x16x32_bf16 v[28:31], v[68:71], v[160:163], v[28:31]
    v_mfma_f32_16x16x32_bf16 v[32:35], v[100:103], v[160:163], v[32:35]
    ds_read_b128 v[180:183], v13 offset:2464
    v_mfma_f32_16x16x32_bf16 v[44:47], v[204:207], v[140:143], v[44:47]
    s_waitcnt lgkmcnt(5)
    v_mfma_f32_16x16x32_bf16 v[28:31], v[72:75], v[164:167], v[28:31]
    v_mfma_f32_16x16x32_bf16 v[32:35], v[104:107], v[164:167], v[32:35]
    ds_read_b128 v[184:187], v13 offset:2400
    s_waitcnt lgkmcnt(4)
    v_mfma_f32_16x16x32_bf16 v[28:31], v[76:79], v[168:171], v[28:31]
    v_mfma_f32_16x16x32_bf16 v[32:35], v[108:111], v[168:171], v[32:35]
    ds_read_b128 v[156:159], v13 offset:2336
    s_waitcnt lgkmcnt(4)
    v_mfma_f32_16x16x32_bf16 v[188:191], v[172:175], v[224:227], 0
    s_waitcnt lgkmcnt(3)
    v_mfma_f32_16x16x32_bf16 v[192:195], v[176:179], v[228:231], 0
    v_mfma_f32_16x16x32_bf16 v[196:199], v[176:179], v[232:235], 0
    v_mfma_f32_16x16x32_bf16 v[200:203], v[176:179], v[236:239], 0
    ds_read_b128 v[160:163], v13 offset:2272
    v_mfma_f32_16x16x32_bf16 v[32:35], v[48:51], v[176:179], v[32:35]
    v_mfma_f32_16x16x32_bf16 v[36:39], v[80:83], v[176:179], v[36:39]
    v_mfma_f32_16x16x32_bf16 v[40:43], v[112:115], v[176:179], v[40:43]
    ds_read_b128 v[164:167], v13 offset:2208
    s_waitcnt lgkmcnt(4)
    v_mfma_f32_16x16x32_bf16 v[32:35], v[52:55], v[180:183], v[32:35]
    v_mfma_f32_16x16x32_bf16 v[36:39], v[84:87], v[180:183], v[36:39]
    ds_read_b128 v[168:171], v13 offset:2144
    v_cvt_pk_bf16_f32 v214, v28, v29
    v_cvt_pk_bf16_f32 v215, v30, v31
    ds_write_b64 v14, v[214:215] offset:1536
    s_waitcnt lgkmcnt(5)
    v_mfma_f32_16x16x32_bf16 v[32:35], v[56:59], v[184:187], v[32:35]
    v_mfma_f32_16x16x32_bf16 v[36:39], v[88:91], v[184:187], v[36:39]
    ds_read_b128 v[172:175], v13 offset:2080
    v_cvt_pk_bf16_f32 v188, v188, v189
    v_cvt_pk_bf16_f32 v189, v190, v191
    v_cvt_pk_bf16_f32 v190, v192, v193
    v_cvt_pk_bf16_f32 v191, v194, v195
    s_waitcnt lgkmcnt(5)
    v_mfma_f32_16x16x32_bf16 v[32:35], v[60:63], v[156:159], v[32:35]
    v_mfma_f32_16x16x32_bf16 v[36:39], v[92:95], v[156:159], v[36:39]
    ds_read_b128 v[176:179], v13 offset:3024
    v_cvt_pk_bf16_f32 v196, v196, v197
    v_cvt_pk_bf16_f32 v197, v198, v199
    v_cvt_pk_bf16_f32 v198, v200, v201
    v_cvt_pk_bf16_f32 v199, v202, v203
    v_mfma_f32_16x16x32_bf16 v[40:43], v[188:191], v[116:119], v[40:43]
    v_mfma_f32_16x16x32_bf16 v[44:47], v[188:191], v[120:123], v[44:47]
    s_waitcnt lgkmcnt(5)
    v_mfma_f32_16x16x32_bf16 v[32:35], v[64:67], v[160:163], v[32:35]
    v_mfma_f32_16x16x32_bf16 v[36:39], v[96:99], v[160:163], v[36:39]
    ds_read_b128 v[180:183], v13 offset:3040
    v_mfma_f32_16x16x32_bf16 v[40:43], v[196:199], v[128:131], v[40:43]
    v_mfma_f32_16x16x32_bf16 v[44:47], v[196:199], v[132:135], v[44:47]
    s_waitcnt lgkmcnt(5)
    v_mfma_f32_16x16x32_bf16 v[32:35], v[68:71], v[164:167], v[32:35]
    v_mfma_f32_16x16x32_bf16 v[36:39], v[100:103], v[164:167], v[36:39]
    ds_read_b128 v[184:187], v13 offset:2976
    s_waitcnt lgkmcnt(5)
    v_mfma_f32_16x16x32_bf16 v[32:35], v[72:75], v[168:171], v[32:35]
    v_mfma_f32_16x16x32_bf16 v[36:39], v[104:107], v[168:171], v[36:39]
    ds_read_b128 v[156:159], v13 offset:2912
    s_waitcnt lgkmcnt(4)
    v_mfma_f32_16x16x32_bf16 v[32:35], v[76:79], v[172:175], v[32:35]
    v_mfma_f32_16x16x32_bf16 v[36:39], v[108:111], v[172:175], v[36:39]
    ds_read_b128 v[160:163], v13 offset:2848
    s_waitcnt lgkmcnt(4)
    v_mfma_f32_16x16x32_bf16 v[188:191], v[176:179], v[224:227], 0
    s_waitcnt lgkmcnt(3)
    v_mfma_f32_16x16x32_bf16 v[192:195], v[180:183], v[228:231], 0
    v_mfma_f32_16x16x32_bf16 v[196:199], v[180:183], v[232:235], 0
    v_mfma_f32_16x16x32_bf16 v[200:203], v[180:183], v[236:239], 0
    ds_read_b128 v[164:167], v13 offset:2784
    v_mfma_f32_16x16x32_bf16 v[36:39], v[48:51], v[180:183], v[36:39]
    v_mfma_f32_16x16x32_bf16 v[40:43], v[80:83], v[180:183], v[40:43]
    v_mfma_f32_16x16x32_bf16 v[44:47], v[112:115], v[180:183], v[44:47]
    ds_read_b128 v[168:171], v13 offset:2720
    s_waitcnt lgkmcnt(4)
    v_mfma_f32_16x16x32_bf16 v[36:39], v[52:55], v[184:187], v[36:39]
    v_mfma_f32_16x16x32_bf16 v[40:43], v[84:87], v[184:187], v[40:43]
    ds_read_b128 v[172:175], v13 offset:2656
    v_cvt_pk_bf16_f32 v212, v32, v33
    v_cvt_pk_bf16_f32 v213, v34, v35
    ds_write_b64 v14, v[212:213] offset:2048
    s_waitcnt lgkmcnt(5)
    v_mfma_f32_16x16x32_bf16 v[36:39], v[56:59], v[156:159], v[36:39]
    v_mfma_f32_16x16x32_bf16 v[40:43], v[88:91], v[156:159], v[40:43]
    ds_read_b128 v[176:179], v13 offset:2592
    v_cvt_pk_bf16_f32 v188, v188, v189
    v_cvt_pk_bf16_f32 v189, v190, v191
    v_cvt_pk_bf16_f32 v190, v192, v193
    v_cvt_pk_bf16_f32 v191, v194, v195
    s_waitcnt lgkmcnt(5)
    v_mfma_f32_16x16x32_bf16 v[36:39], v[60:63], v[160:163], v[36:39]
    v_mfma_f32_16x16x32_bf16 v[40:43], v[92:95], v[160:163], v[40:43]
    ds_read_b128 v[180:183], v13 offset:3552
    v_cvt_pk_bf16_f32 v196, v196, v197
    v_cvt_pk_bf16_f32 v197, v198, v199
    v_cvt_pk_bf16_f32 v198, v200, v201
    v_cvt_pk_bf16_f32 v199, v202, v203
    v_mfma_f32_16x16x32_bf16 v[44:47], v[188:191], v[116:119], v[44:47]
    s_waitcnt lgkmcnt(5)
    v_mfma_f32_16x16x32_bf16 v[36:39], v[64:67], v[164:167], v[36:39]
    v_mfma_f32_16x16x32_bf16 v[40:43], v[96:99], v[164:167], v[40:43]
    ds_read_b128 v[184:187], v13 offset:3488
    v_mfma_f32_16x16x32_bf16 v[44:47], v[196:199], v[128:131], v[44:47]
    s_waitcnt lgkmcnt(5)
    v_mfma_f32_16x16x32_bf16 v[36:39], v[68:71], v[168:171], v[36:39]
    v_mfma_f32_16x16x32_bf16 v[40:43], v[100:103], v[168:171], v[40:43]
    ds_read_b128 v[156:159], v13 offset:3424
    s_waitcnt lgkmcnt(5)
    v_mfma_f32_16x16x32_bf16 v[36:39], v[72:75], v[172:175], v[36:39]
    v_mfma_f32_16x16x32_bf16 v[40:43], v[104:107], v[172:175], v[40:43]
    ds_read_b128 v[160:163], v13 offset:3360
    s_waitcnt lgkmcnt(4)
    v_mfma_f32_16x16x32_bf16 v[36:39], v[76:79], v[176:179], v[36:39]
    v_mfma_f32_16x16x32_bf16 v[40:43], v[108:111], v[176:179], v[40:43]
    ds_read_b128 v[164:167], v13 offset:3296
    s_waitcnt lgkmcnt(4)
    v_mfma_f32_16x16x32_bf16 v[40:43], v[48:51], v[180:183], v[40:43]
    v_mfma_f32_16x16x32_bf16 v[44:47], v[80:83], v[180:183], v[44:47]
    ds_read_b128 v[168:171], v13 offset:3232
    s_waitcnt lgkmcnt(4)
    v_mfma_f32_16x16x32_bf16 v[40:43], v[52:55], v[184:187], v[40:43]
    v_mfma_f32_16x16x32_bf16 v[44:47], v[84:87], v[184:187], v[44:47]
    ds_read_b128 v[172:175], v13 offset:3168
    v_cvt_pk_bf16_f32 v214, v36, v37
    v_cvt_pk_bf16_f32 v215, v38, v39
    ds_write_b64 v14, v[214:215] offset:2560
    s_waitcnt lgkmcnt(5)
    v_mfma_f32_16x16x32_bf16 v[40:43], v[56:59], v[156:159], v[40:43]
    v_mfma_f32_16x16x32_bf16 v[44:47], v[88:91], v[156:159], v[44:47]
    ds_read_b128 v[176:179], v13 offset:3104
    s_cmp_lt_u32 s31, 4
    s_cbranch_scc1 L_a_noy_4
    s_waitcnt lgkmcnt(1)
    s_barrier
L_a_noy_4:
    s_waitcnt lgkmcnt(5)
    v_mfma_f32_16x16x32_bf16 v[40:43], v[60:63], v[160:163], v[40:43]
    v_mfma_f32_16x16x32_bf16 v[44:47], v[92:95], v[160:163], v[44:47]
    ds_read_b128 v[180:183], v13 offset:4064
    s_waitcnt lgkmcnt(5)
    v_mfma_f32_16x16x32_bf16 v[40:43], v[64:67], v[164:167], v[40:43]
    v_mfma_f32_16x16x32_bf16 v[44:47], v[96:99], v[164:167], v[44:47]
    ds_read_b128 v[184:187], v13 offset:4000
    s_waitcnt lgkmcnt(5)
    v_mfma_f32_16x16x32_bf16 v[40:43], v[68:71], v[168:171], v[40:43]
    v_mfma_f32_16x16x32_bf16 v[44:47], v[100:103], v[168:171], v[44:47]
    ds_read_b128 v[156:159], v13 offset:3936
    s_waitcnt lgkmcnt(5)
    v_mfma_f32_16x16x32_bf16 v[40:43], v[72:75], v[172:175], v[40:43]
    v_mfma_f32_16x16x32_bf16 v[44:47], v[104:107], v[172:175], v[44:47]
    ds_read_b128 v[160:163], v13 offset:3872
    s_waitcnt lgkmcnt(4)
    v_mfma_f32_16x16x32_bf16 v[40:43], v[76:79], v[176:179], v[40:43]
    v_mfma_f32_16x16x32_bf16 v[44:47], v[108:111], v[176:179], v[44:47]
    ds_read_b128 v[164:167], v13 offset:3808
    s_waitcnt lgkmcnt(4)
    v_mfma_f32_16x16x32_bf16 v[44:47], v[48:51], v[180:183], v[44:47]
    ds_read_b128 v[168:171], v13 offset:3744
    s_waitcnt lgkmcnt(4)
    v_mfma_f32_16x16x32_bf16 v[44:47], v[52:55], v[184:187], v[44:47]
    ds_read_b128 v[172:175], v13 offset:3680
    v_cvt_pk_bf16_f32 v212, v40, v41
    v_cvt_pk_bf16_f32 v213, v42, v43
    ds_write_b64 v14, v[212:213] offset:3072
    s_waitcnt lgkmcnt(5)
    v_mfma_f32_16x16x32_bf16 v[44:47], v[56:59], v[156:159], v[44:47]
    ds_read_b128 v[176:179], v13 offset:3616
    s_waitcnt lgkmcnt(5)
    v_mfma_f32_16x16x32_bf16 v[44:47], v[60:63], v[160:163], v[44:47]
    s_waitcnt lgkmcnt(4)
    v_mfma_f32_16x16x32_bf16 v[44:47], v[64:67], v[164:167], v[44:47]
    s_waitcnt lgkmcnt(3)
    v_mfma_f32_16x16x32_bf16 v[44:47], v[68:71], v[168:171], v[44:47]
    s_waitcnt lgkmcnt(2)
    v_mfma_f32_16x16x32_bf16 v[44:47], v[72:75], v[172:175], v[44:47]
    s_waitcnt lgkmcnt(0)
    v_mfma_f32_16x16x32_bf16 v[44:47], v[76:79], v[176:179], v[44:47]
    s_nop 7
    v_cvt_pk_bf16_f32 v214, v44, v45
    v_cvt_pk_bf16_f32 v215, v46, v47
    ds_write_b64 v14, v[214:215] offset:3584
    s_waitcnt lgkmcnt(0)
    s_cmp_ge_u32 s31, 4
    s_cbranch_scc1 L_a_y2
    s_barrier
    s_mul_i32 s33, s31, 192
    s_add_u32 s33, s33, 0
    s_lshl_b32 s3, s33, 1
    v_add_u32 v7, s3, v3
    s_mul_i32 s3, s33, 2304
    v_add_u32 v8, s3, v4
    ds_read_b64_tr_b16 v[60:61], v7 offset:0
    ds_read_b64_tr_b16 v[62:63], v7 offset:35072
    ds_read_b64_tr_b16 v[64:65], v7 offset:128
    ds_read_b64_tr_b16 v[66:67], v7 offset:35200
    ds_read_b64_tr_b16 v[68:69], v7 offset:256
    ds_read_b64_tr_b16 v[70:71], v7 offset:35328
    s_waitcnt lgkmcnt(4)
    global_store_dwordx4 v8, v[60:63], s[24:25]
    v_add_u32 v8, 147456, v8
    s_waitcnt lgkmcnt(2)
    global_store_dwordx4 v8, v[64:67], s[24:25]
    v_add_u32 v8, 147456, v8
    s_waitcnt lgkmcnt(0)
    global_store_dwordx4 v8, v[68:71], s[24:25]
    s_nop 1
    s_barrier
    s_mul_i32 s33, s31, 192
    s_add_u32 s33, s33, 768
    s_lshl_b32 s3, s33, 1
    v_add_u32 v7, s3, v3
    s_mul_i32 s3, s33, 2304
    v_add_u32 v8, s3, v4
    ds_read_b64_tr_b16 v[60:61], v7 offset:0
    ds_read_b64_tr_b16 v[62:63], v7 offset:35072
    ds_read_b64_tr_b16 v[64:65], v7 offset:128
    ds_read_b64_tr_b16 v[66:67], v7 offset:35200
    ds_read_b64_tr_b16 v[68:69], v7 offset:256
    ds_read_b64_tr_b16 v[70:71], v7 offset:35328
    s_waitcnt lgkmcnt(4)
    global_store_dwordx4 v8, v[60:63], s[24:25]
    v_add_u32 v8, 147456, v8
    s_waitcnt lgkmcnt(2)
    global_store_dwordx4 v8, v[64:67], s[24:25]
    v_add_u32 v8, 147456, v8
    s_waitcnt lgkmcnt(0)
    global_store_dwordx4 v8, v[68:71], s[24:25]
    s_nop 1
L_a_y2:
    s_barrier
    s_mul_i32 s33, s31, 64
    s_add_u32 s33, s33, 1536
    s_lshl_b32 s3, s33, 1
    v_add_u32 v7, s3, v3
    s_mul_i32 s3, s33, 2304
    v_add_u32 v8, s3, v4
    ds_read_b64_tr_b16 v[60:61], v7 offset:0
    ds_read_b64_tr_b16 v[62:63], v7 offset:35072
    s_waitcnt lgkmcnt(0)
    global_store_dwordx4 v8, v[60:63], s[24:25]
    s_waitcnt vmcnt(0)
    s_barrier
    s_cmp_lg_u32 s31, 0
    s_cbranch_scc1 L_fin
    s_and_b32 s33, s2, 7
    s_lshl_b32 s3, s33, 2
    v_mov_b32 v2, s3
    v_mov_b32 v3, 1
    s_mov_b64 exec, 1
    global_atomic_add v4, v2, v3, s[26:27] offset:128 sc0
    s_waitcnt vmcnt(0)
    v_readfirstlane_b32 s3, v4
    s_mov_b64 exec, -1
    s_cmp_eq_u32 s33, 0
    s_cselect_b32 s33, 15, 7
    s_cmp_lg_u32 s3, s33
    s_cbranch_scc1 L_fin
    buffer_wbl2 sc1
L_fin:
L_end:
    s_endpgm
L_code_end:
.section .rodata,"a"
.p2align 6
.amdhsa_kernel concat_heads__ssm_conv_s4d__linear_attn_block__prompt_kernel
  .amdhsa_next_free_vgpr 256
  .amdhsa_next_free_sgpr 102
  .amdhsa_accum_offset 256
  .amdhsa_group_segment_fixed_size 0
  .amdhsa_kernarg_size 104
  .amdhsa_user_sgpr_count 2
  .amdhsa_user_sgpr_kernarg_segment_ptr 1
  .amdhsa_system_sgpr_workgroup_id_x 1
  .amdhsa_float_denorm_mode_32 3
.end_amdhsa_kernel
```
